```python
import torch

def _softmax(x, axis=-1):
    return torch.softmax(x, dim=axis)
def _gelu(x):
    return torch.nn.functional.gelu(x, approximate="tanh")
def _silu(x):
    return torch.nn.functional.silu(x)
def _sigmoid(x):
    return torch.sigmoid(x)
def _layernorm(x, axis=-1, eps=1e-5):
    m = x.mean(dim=axis, keepdim=True)
    v = x.var(dim=axis, keepdim=True, unbiased=False)
    return (x - m) / torch.sqrt(v + eps)
def _scatter_add(tgt, idx, src, axis=0):
    return tgt.clone().index_add_(axis, idx, src)
def _segment_sum(src, seg, n):
    out = torch.zeros((n,) + src.shape[1:], dtype=src.dtype)
    return out.index_add_(0, seg, src)
def _pad(x, pw):
    flat = tuple(v for pair in reversed(pw) for v in pair)
    return torch.nn.functional.pad(x, flat)

kernel_name = 'recurrent_scan__ssm_conv_s5__glu_gated_bilinear__prompt'

def setup_inputs():

    _w = (lambda a: (lambda t: t.to(torch.bfloat16) if t.is_floating_point() else t)(torch.as_tensor(a)))
    def _A_setup():
        B, S, D = 1, 2048, 576
        P = D
        Lambda_re = -0.5 * (lambda _x: torch.exp(torch.as_tensor(_x)))((lambda *s: torch.randn(*s, dtype=torch.bfloat16) * 0.8)(P))
        Lambda_im = (lambda *s: torch.randn(*s, dtype=torch.bfloat16) * 0.8)(P) * 1.0
        B_re = (lambda *s: torch.randn(*s, dtype=torch.bfloat16) * 1.6)(P, D) * (D ** -0.5)
        B_im = (lambda *s: torch.randn(*s, dtype=torch.bfloat16) * 1.6)(P, D) * (D ** -0.5)
        C_re = (lambda *s: torch.randn(*s, dtype=torch.bfloat16) * 1.6)(D, P) * (P ** -0.5)
        C_im = (lambda *s: torch.randn(*s, dtype=torch.bfloat16) * 1.6)(D, P) * (P ** -0.5)
        log_dt = (lambda *s: torch.randn(*s, dtype=torch.bfloat16) * 0.8)(P) * 0.3 - 2.0
        Dskip = (lambda *s: torch.randn(*s, dtype=torch.bfloat16) * 0.8)(D)
        return {
            "x": _w((lambda *s: torch.randn(*s, dtype=torch.bfloat16) * 0.05)(B, S, D)),
            "Lambda_re": _w(Lambda_re),
            "Lambda_im": _w(Lambda_im),
            "B_re": _w(B_re),
            "B_im": _w(B_im),
            "C_re": _w(C_re),
            "C_im": _w(C_im),
            "log_dt": _w(log_dt),
            "Dskip": _w(Dskip),
        }
    _A_in = _A_setup()

    def _B_setup():
        B, S, D, F = 1, 2048, 576, 4608
        return {
            "x": _w((lambda *s: torch.randn(*s, dtype=torch.bfloat16) * 0.05)(B, S, D)),
            "w_gate": _w((lambda *s: torch.randn(*s, dtype=torch.bfloat16) * 0.2)(D, F) * (D ** -0.5)),
            "w_up": _w((lambda *s: torch.randn(*s, dtype=torch.bfloat16) * 0.2)(D, F) * (D ** -0.5)),
            "w_down": _w((lambda *s: torch.randn(*s, dtype=torch.bfloat16) * 0.2)(F, D) * (F ** -0.5)),
        }
    _B_in = _B_setup()

    return {
        "A_x": _A_in["x"],
        "A_Lambda_re": _A_in["Lambda_re"],
        "A_Lambda_im": _A_in["Lambda_im"],
        "A_B_re": _A_in["B_re"],
        "A_B_im": _A_in["B_im"],
        "A_C_re": _A_in["C_re"],
        "A_C_im": _A_in["C_im"],
        "A_log_dt": _A_in["log_dt"],
        "A_Dskip": _A_in["Dskip"],
        "B_x": _B_in["x"],
        "B_w_gate": _B_in["w_gate"],
        "B_w_up": _B_in["w_up"],
        "B_w_down": _B_in["w_down"],
    }

def reference(A_x, A_Lambda_re, A_Lambda_im, A_B_re, A_B_im, A_C_re, A_C_im, A_log_dt, A_Dskip, B_x, B_w_gate, B_w_up, B_w_down):
    def _A_ref(x, Lambda_re, Lambda_im, B_re, B_im, C_re, C_im, log_dt, Dskip):
        Bsz, L, H = x.shape
        Lam = Lambda_re + 1j * Lambda_im
        Bmat = B_re + 1j * B_im
        Cmat = C_re + 1j * C_im
        dt = torch.exp(log_dt)
        Lam_bar = torch.exp(dt * Lam)
        B_bar = ((Lam_bar - 1.0) / Lam)[:, None] * Bmat
        Bu = torch.einsum("bld,pd->blp", x + 0j, B_bar)
        h = torch.zeros_like(Bu[:, 0, :])
        hs = []
        for t in range(L):
            h = Lam_bar[None, :] * h + Bu[:, t, :]
            hs.append(h)
        hseq = torch.stack(hs, 1)
        y = 2.0 * torch.einsum("blp,dp->bld", hseq, Cmat).real + x * Dskip[None, None, :]
        return y

    def _B_ref(x, w_gate, w_up, w_down):
        g = torch.einsum("bsd,df->bsf", x, w_gate)
        u = torch.einsum("bsd,df->bsf", x, w_up)
        h = g * u
        return torch.einsum("bsf,fd->bsd", h, w_down)

    x = A_x
    xn = _layernorm(x, axis=-1)
    s = _A_ref(xn, A_Lambda_re, A_Lambda_im, A_B_re, A_B_im, A_C_re, A_C_im, A_log_dt, A_Dskip)
    g = _silu(_B_ref(xn, B_w_gate, B_w_up, B_w_down))
    return x + s * g
```

```asm
; @launch grid=(256,1,1) block=(256,1,1) lds=163840
.amdgcn_target "amdgcn-amd-amdhsa--gfx950"
.text
.globl recurrent_scan__ssm_conv_s5__glu_gated_bilinear__prompt_kernel
.p2align 8
.type recurrent_scan__ssm_conv_s5__glu_gated_bilinear__prompt_kernel,@function
recurrent_scan__ssm_conv_s5__glu_gated_bilinear__prompt_kernel:
  s_cmp_ge_u32 s2, 0x100
  s_cbranch_scc1 L_end
  s_load_dwordx16 s[4:19], s[0:1], 0
  s_load_dwordx16 s[20:35], s[0:1], 64
  s_getpc_b64 s[40:41]
L_pc:
  s_mov_b32 s42, L_fin-L_pc
  s_mov_b32 s43, 0x20000
  s_lshl_b32 s3, s2, 4
  s_and_b32 s3, s3, 0xf80
  v_lshl_add_u32 v2, v0, 12, s3
  buffer_load_dword v1, v2, s[40:43], 0 offen offset:0
  v_lshrrev_b32 v2, 6, v0
  v_and_b32 v3, 63, v0
  v_readfirstlane_b32 s3, v2
  s_bfe_u32 s40, s2, 0x20003
  s_bfe_u32 s41, s2, 0x10002
  s_lshr_b32 s42, s2, 5
  s_lshl3_add_u32 s41, s41, s42
  s_and_b32 s42, s3, 1
  s_lshr_b32 s43, s3, 1
  s_and_b32 s44, s40, 1
  s_lshr_b32 s45, s40, 1
  v_and_b32 v2, 7, v3
  v_lshrrev_b32 v4, 5, v3
  v_lshrrev_b32 v5, 4, v3
  v_bfe_u32 v6, v3, 3, 2
  v_xor_b32 v7, v2, v5
  v_lshlrev_b32 v7, 4, v7
  v_lshl_add_u32 v8, v4, 4, v6
  s_lshl_b32 s46, s43, 6
  s_lshl3_add_u32 s46, s42, s46
  s_lshl_b32 s47, s41, 7
  s_add_u32 s47, s47, s46
  s_mul_i32 s47, s47, 0x480
  v_mul_u32_u24 v9, 0x480, v8
  v_add_u32 v9, v9, v7
  s_lshl_b32 s48, s44, 6
  s_mul_i32 s49, s44, 0x9000
  s_mul_i32 s50, s45, 0x1200
  v_xor_b32 v9, s48, v9
  v_add_u32 v10, s49, v9
  v_add_u32 v11, s50, v10
  s_waitcnt lgkmcnt(0)
  s_mov_b64 s[0:1], s[6:7]
  s_mov_b32 s6, 0x240000
  s_mov_b32 s7, 0x20000
  buffer_load_dwordx4 v[12:15], v11, s[4:7], s47 offen offset:0
  buffer_load_dwordx4 v[16:19], v11, s[4:7], s47 offen offset:128
  buffer_load_dwordx4 v[20:23], v11, s[4:7], s47 offen offset:256
  buffer_load_dwordx4 v[24:27], v11, s[4:7], s47 offen offset:384
  buffer_load_dwordx4 v[28:31], v11, s[4:7], s47 offen offset:512
  buffer_load_dwordx4 v[32:35], v11, s[4:7], s47 offen offset:640
  buffer_load_dwordx4 v[36:39], v11, s[4:7], s47 offen offset:768
  buffer_load_dwordx4 v[40:43], v11, s[4:7], s47 offen offset:896
  buffer_load_dwordx4 v[44:47], v11, s[4:7], s47 offen offset:1024
  s_and_b32 s51, s2, 3
  s_lshl2_add_u32 s52, s51, s40
  v_xor_b32 v9, 64, v9
  s_sub_u32 s49, 0x9000, s49
  v_add_u32 v9, s49, v9
  v_add_u32 v11, s50, v9
  s_sub_u32 s49, 0x1200, s50
  v_add_u32 v10, s49, v10
  v_add_u32 v9, s49, v9
  s_lshl1_add_u32 s49, s52, s42
  s_lshl2_add_u32 s50, s51, s45
  s_lshl_b32 s50, s50, 2
  s_add_u32 s50, s50, 0x200
  v_and_b32 v48, 4, v3
  v_add_u32 v48, v48, v2
  s_lshl_b32 s53, s49, 4
  v_lshl_add_u32 v49, v5, 2, s53
  v_mul_u32_u24 v50, s50, v4
  v_max_u32 v49, v49, v50
  v_add_lshl_u32 v48, v49, v48, 1
  s_lshr_b32 s53, s2, 3
  s_lshl1_add_u32 s53, s53, s43
  s_lshl_b32 s54, s51, 6
  s_add_u32 s54, s54, s53
  s_mul_i32 s54, s54, 0x900
  s_bfe_u32 s55, s2, 0x10002
  s_mul_i32 s55, s55, 0x480
  s_add_u32 s54, s54, s55
  v_min_u32 v49, 8, v3
  v_lshl_add_u32 v49, v49, 7, s54
  s_mul_i32 s54, s53, 3
  s_sub_u32 s54, s54, 32
  v_min_u32 v50, 34, v3
  v_add_u32 v50, s54, v50
  v_min_u32 v50, 0x8f, v50
  s_mul_i32 s54, s51, 0x4800
  s_add_u32 s54, s54, 0x90000
  v_lshl_add_u32 v50, v50, 7, s54
  v_cmp_gt_u32 vcc, 32, v3
  s_nop 1
  v_cndmask_b32 v49, v50, v49, vcc
  v_min_u32 v50, 8, v3
  v_mul_u32_u24 v50, 0x2400, v50
  s_mul_i32 s54, s53, 0x14400
  s_mul_i32 s56, s51, 0x900
  s_add_u32 s54, s54, s56
  v_bfe_u32 v51, v3, 2, 3
  v_bfe_u32 v52, v3, 4, 1
  v_bfe_u32 v53, v3, 1, 1
  v_xor_b32 v54, v53, v52
  v_and_b32 v55, 1, v3
  v_lshlrev_b32 v54, 5, v54
  v_lshl_add_u32 v54, v55, 4, v54
  v_lshl_add_u32 v56, v4, 6, v54
  v_lshl_add_u32 v57, v52, 2, v51
  s_lshl_b32 s56, s43, 2
  v_add_u32 v57, s56, v57
  v_lshl_add_u32 v58, v4, 4, v57
  v_mul_u32_u24 v58, 0x2400, v58
  v_add_u32 v54, v58, v54
  v_add_u32 v58, 0x47c00, v54
  v_lshl_add_u32 v6, v4, 3, v6
  v_mul_u32_u24 v6, 0x480, v6
  s_lshl_b32 s56, s42, 6
  v_xad_u32 v59, v7, s56, v6
  v_add_u32 v6, 0xe00, v59
  global_load_ushort v7, v48, s[0:1]
  global_load_ushort v60, v48, s[8:9]
  global_load_ushort v61, v48, s[18:19]
  s_cmp_eq_u32 s42, 0
  s_cselect_b64 s[8:9], s[10:11], s[12:13]
  s_cselect_b64 s[12:13], s[14:15], s[16:17]
  s_cselect_b64 s[24:25], s[24:25], s[26:27]
  s_mov_b64 s[16:17], s[30:31]
  s_mov_b64 s[36:37], s[34:35]
  s_mov_b32 s10, 0xa2000
  s_mov_b32 s11, 0x20000
  s_mov_b32 s26, 0x510000
  s_mov_b32 s27, 0x20000
  s_mov_b32 s38, 0x8000000
  s_mov_b32 s39, 0x20000
  s_mov_b32 s14, 0xa2000
  s_mov_b32 s15, 0x20000
  s_mov_b32 s22, 0x480
  s_mov_b32 s23, 0x20000
  s_mov_b32 s30, 0x510000
  s_mov_b32 s31, 0x20000
  s_mov_b32 s18, 0x480000
  s_mov_b32 s19, 0x20000
  s_mov_b32 s34, 0x100
  s_mov_b32 s35, 0x20000
  s_add_u32 s55, s54, s55
  s_mul_i32 s0, s3, 0xa000
  s_mul_i32 s1, s52, 0x240
  s_add_u32 s48, s1, s48
  s_lshl_b32 s56, s44, 9
  s_add_u32 s1, s1, 0x200
  s_sub_u32 s1, s1, s56
  s_lshl1_add_u32 s56, s52, s43
  s_mul_i32 s56, s56, 0x4800
  s_mul_i32 s50, s50, 0x480
  s_lshl_b32 s57, s43, 7
  s_add_u32 s57, s50, s57
  s_lshl_b32 s58, s43, 30
  s_add_u32 s50, s50, s58
  v_and_b32 v48, 15, v3
  v_lshlrev_b32 v62, 4, v3
  v_mov_b32 v63, 0x7ff00000
  v_cmp_ne_u32 vcc, 0, v0
  s_nop 1
  v_cndmask_b32 v0, 0, v63, vcc
  v_mul_u32_u24 v57, 0x2400, v57
  v_add_u32 v63, v57, v56
  v_add_u32 v56, 0x23c00, v63
  v_add_u32 v57, 0x47800, v63
  v_add_u32 v64, 0x6b400, v63
  s_lshr_b32 s58, s51, 1
  s_lshl2_add_u32 s58, s58, s3
  s_and_b32 s59, s51, 1
  s_lshl1_add_u32 s58, s58, s59
  s_lshl_b32 s58, s58, 3
  s_lshl_b32 s59, s41, 7
  s_add_u32 s58, s59, s58
  s_mul_i32 s58, s58, 0x480
  s_lshl2_add_u32 s60, s40, s51
  s_lshl_b32 s60, s60, 6
  s_lshl_b32 s61, s40, 5
  s_add_u32 s61, s61, 0x400
  s_add_u32 s58, s58, s61
  s_add_u32 s59, s59, s46
  s_mul_i32 s59, s59, 0x480
  s_add_u32 s59, s59, s60
  s_add_u32 s60, s59, 0x1200
  v_lshrrev_b32 v65, 3, v48
  v_and_b32 v66, 3, v48
  v_lshl_add_u32 v65, v65, 2, v66
  v_and_b32 v67, 1, v5
  v_lshrrev_b32 v68, 2, v48
  v_mul_u32_u24 v65, 0x480, v65
  v_lshl_add_u32 v65, v67, 4, v65
  v_lshl_add_u32 v66, v68, 4, v66
  v_mul_u32_u24 v66, 0x480, v66
  v_lshl_add_u32 v66, v5, 4, v66
  s_lshl2_add_u32 s61, s41, s40
  s_lshl2_add_u32 s62, s61, s3
  s_lshl2_add_u32 s62, s62, s51
  s_mul_i32 s62, s62, 0x1400
  s_add_u32 s62, s62, 0x1300000
  s_xor_b32 s63, s51, 3
  s_lshl2_add_u32 s61, s61, s63
  s_xor_b32 s64, s61, 0
  s_lshl2_add_u32 s64, s64, s3
  s_mul_i32 s64, s64, 0x3000
  s_add_u32 s64, s64, 0x600000
  s_xor_b32 s65, s61, 1
  s_lshl2_add_u32 s65, s65, s3
  s_mul_i32 s65, s65, 0x3000
  s_add_u32 s65, s65, 0x601000
  s_xor_b32 s61, s61, 2
  s_lshl2_add_u32 s61, s61, s3
  s_mul_i32 s61, s61, 0x3000
  s_add_u32 s61, s61, 0x602000
  s_lshl2_add_u32 s66, s41, s3
  v_lshlrev_b32 v51, 6, v51
  v_and_b32 v67, 3, v3
  v_lshl_add_u32 v51, v67, 3, v51
  v_lshl_add_u32 v51, v52, 5, v51
  s_lshl_b32 s67, s42, 9
  v_lshl_add_u32 v52, v4, 10, v51
  v_add_u32 v52, s67, v52
  v_xor_b32 v67, 32, v52
  s_lshl_b32 s68, s42, 5
  v_lshl_add_u32 v4, v4, 9, v51
  v_xor_b32 v4, s68, v4
  v_add_u32 v51, 0x10000, v52
  v_add_u32 v68, 0x20000, v52
  v_add_u32 v69, 0x10000, v67
  v_add_u32 v70, 0x20000, v67
  v_add_u32 v71, 0x10000, v4
  v_add_u32 v72, 0x20000, v4
  v_bfe_u32 v73, v3, 3, 1
  v_bfe_u32 v74, v3, 1, 3
  v_xor_b32 v74, v5, v74
  v_lshlrev_b32 v74, 4, v74
  v_lshl_add_u32 v2, v2, 7, v74
  v_lshl_add_u32 v74, v73, 10, v2
  s_mul_i32 s68, s43, 0x14000
  v_add_u32 v75, s68, v74
  v_add_u32 v76, 0xa000, v75
  s_lshl1_add_u32 s68, s44, s43
  s_mul_i32 s68, s68, 0xa000
  s_lshl2_add_u32 s68, s67, s68
  v_add_u32 v74, s68, v74
  v_mul_u32_u24 v77, 0xa000, v73
  v_add_u32 v2, v77, v2
  v_add_u32 v77, 0x14000, v2
  s_mul_i32 s68, s42, 0x14000
  v_add_u32 v78, s68, v2
  v_xor_b32 v79, 64, v75
  v_xor_b32 v80, 64, v76
  v_xor_b32 v81, 64, v74
  v_xor_b32 v82, 64, v2
  v_xor_b32 v83, 64, v77
  v_xor_b32 v84, 64, v78
  v_add_u32 v85, s0, v62
  s_lshl_b32 s68, s40, 10
  v_add_u32 v86, s68, v85
  v_xor_b32 v87, 0x400, v86
  v_xor_b32 v88, 0x800, v86
  v_xor_b32 v89, 0xc00, v86
  v_lshlrev_b32 v90, 4, v55
  v_mov_b32 v91, 0x3f80
  v_lshlrev_b32 v90, v90, v91
  v_cmp_eq_u32 vcc, 0, v53
  s_nop 1
  v_cndmask_b32 v92, 0, v90, vcc
  v_xor_b32 v93, v92, v90
  v_bfe_u32 v90, v3, 2, 2
  v_mov_b32 v91, 0x3f803f80
  v_cmp_eq_u32 vcc, v90, v5
  s_nop 1
  v_cndmask_b32 v96, 0, v91, vcc
  v_cndmask_b32 v97, 0, v91, vcc
  v_cndmask_b32 v98, 0, v91, vcc
  v_cndmask_b32 v99, 0, v91, vcc
  v_cmp_ne_u32 s[68:69], 0, v55
  v_cmp_ne_u32 s[70:71], 0, v53
  s_mov_b32 s72, 0x4e20
  buffer_load_dwordx4 v[100:103], v11, s[4:7], s47 offen offset:0
  buffer_load_dword v1, v49, s[8:11], 0 offen offset:0
  buffer_load_dword v1, v50, s[24:27], s55 offen offset:512
  s_waitcnt vmcnt(14)
  v_mfma_f32_4x4x4_16b_bf16 v[104:107], v[12:13], v[12:13], 0
  v_mfma_f32_16x16x32_bf16 v[108:111], v[96:99], v[12:15], 0
  buffer_load_dwordx4 v[112:115], v11, s[4:7], s47 offen offset:128
  v_mfma_f32_4x4x4_16b_bf16 v[104:107], v[14:15], v[14:15], v[104:107]
  s_waitcnt vmcnt(14)
  s_nop 0
  v_mfma_f32_4x4x4_16b_bf16 v[104:107], v[16:17], v[16:17], v[104:107]
  v_mfma_f32_16x16x32_bf16 v[108:111], v[96:99], v[16:19], v[108:111]
  buffer_load_dwordx4 v[116:119], v11, s[4:7], s47 offen offset:256
  v_mfma_f32_4x4x4_16b_bf16 v[104:107], v[18:19], v[18:19], v[104:107]
  s_waitcnt vmcnt(14)
  s_nop 0
  v_mfma_f32_4x4x4_16b_bf16 v[104:107], v[20:21], v[20:21], v[104:107]
  v_mfma_f32_16x16x32_bf16 v[108:111], v[96:99], v[20:23], v[108:111]
  buffer_load_dwordx4 v[120:123], v11, s[4:7], s47 offen offset:384
  v_mfma_f32_4x4x4_16b_bf16 v[104:107], v[22:23], v[22:23], v[104:107]
  s_waitcnt vmcnt(14)
  s_nop 0
  v_mfma_f32_4x4x4_16b_bf16 v[104:107], v[24:25], v[24:25], v[104:107]
  v_mfma_f32_16x16x32_bf16 v[108:111], v[96:99], v[24:27], v[108:111]
  buffer_load_dwordx4 v[124:127], v11, s[4:7], s47 offen offset:512
  v_mfma_f32_4x4x4_16b_bf16 v[104:107], v[26:27], v[26:27], v[104:107]
  s_waitcnt vmcnt(14)
  s_nop 0
  v_mfma_f32_4x4x4_16b_bf16 v[104:107], v[28:29], v[28:29], v[104:107]
  v_mfma_f32_16x16x32_bf16 v[108:111], v[96:99], v[28:31], v[108:111]
  buffer_load_dwordx4 v[128:131], v11, s[4:7], s47 offen offset:640
  v_mfma_f32_4x4x4_16b_bf16 v[104:107], v[30:31], v[30:31], v[104:107]
  s_waitcnt vmcnt(14)
  s_nop 0
  v_mfma_f32_4x4x4_16b_bf16 v[104:107], v[32:33], v[32:33], v[104:107]
  v_mfma_f32_16x16x32_bf16 v[108:111], v[96:99], v[32:35], v[108:111]
  buffer_load_dwordx4 v[132:135], v11, s[4:7], s47 offen offset:768
  v_mfma_f32_4x4x4_16b_bf16 v[104:107], v[34:35], v[34:35], v[104:107]
  s_waitcnt vmcnt(14)
  s_nop 0
  v_mfma_f32_4x4x4_16b_bf16 v[104:107], v[36:37], v[36:37], v[104:107]
  v_mfma_f32_16x16x32_bf16 v[108:111], v[96:99], v[36:39], v[108:111]
  buffer_load_dwordx4 v[136:139], v11, s[4:7], s47 offen offset:896
  v_mfma_f32_4x4x4_16b_bf16 v[104:107], v[38:39], v[38:39], v[104:107]
  s_waitcnt vmcnt(14)
  s_nop 0
  v_mfma_f32_4x4x4_16b_bf16 v[104:107], v[40:41], v[40:41], v[104:107]
  v_mfma_f32_16x16x32_bf16 v[108:111], v[96:99], v[40:43], v[108:111]
  buffer_load_dwordx4 v[140:143], v11, s[4:7], s47 offen offset:1024
  v_mfma_f32_4x4x4_16b_bf16 v[104:107], v[42:43], v[42:43], v[104:107]
  s_waitcnt vmcnt(14)
  s_nop 0
  v_mfma_f32_4x4x4_16b_bf16 v[104:107], v[44:45], v[44:45], v[104:107]
  v_mfma_f32_16x16x32_bf16 v[108:111], v[96:99], v[44:47], v[108:111]
  buffer_load_dwordx4 v[144:147], v10, s[4:7], s47 offen offset:0
  v_mfma_f32_4x4x4_16b_bf16 v[104:107], v[46:47], v[46:47], v[104:107]
  v_lshlrev_b32 v11, 31, v73
  v_lshl_add_u32 v3, v3, 3, s0
  s_waitcnt vmcnt(14)
  v_lshlrev_b32 v7, 16, v7
  s_waitcnt vmcnt(13)
  v_lshlrev_b32 v49, 16, v60
  s_waitcnt vmcnt(12)
  v_lshlrev_b32 v73, 16, v61
  v_mul_f32 v73, 1.4426950408889634, v73
  v_exp_f32 v73, v73
  v_mul_f32 v53, v7, v7
  v_fmac_f32 v53, v49, v49
  v_rcp_f32 v53, v53
  v_cvt_pk_bf16_f32 v55, v73, v73
  v_and_b32 v55, 0xffff0000, v55
  v_mul_f32 v73, v55, v7
  v_mul_f32 v55, v55, v49
  v_mul_f32 v73, 1.4426950408889634, v73
  v_exp_f32 v73, v73
  v_mul_f32 v55, 0.15915494309189535, v55
  v_fract_f32 v55, v55
  v_cos_f32 v60, v55
  v_sin_f32 v55, v55
  v_add_f32 v53, v53, v53
  v_mul_f32 v90, v73, v60
  v_mul_f32 v55, v73, v55
  v_add_f32 v73, -1.0, v90
  v_mul_f32 v60, v73, v7
  v_fmac_f32 v60, v55, v49
  v_mul_f32 v7, v55, v7
  v_fma_f32 v7, -v73, v49, v7
  v_mul_f32 v49, v60, v53
  v_mul_f32_e64 v61, -v7, v53
  v_xor_b32 v60, v11, v49
  v_xor_b32 v91, v11, v55
  ds_write_b64 v3, v[60:61] offset:36864
  ds_write_b64 v3, v[90:91] offset:37376
  v_mul_f32 v7, v90, v90
  v_add_f32 v11, v90, v90
  v_fma_f32 v60, -v91, v91, v7
  v_mul_f32 v61, v11, v91
  v_mul_f32 v7, v60, v60
  v_add_f32 v11, v60, v60
  v_fma_f32 v90, -v61, v61, v7
  v_mul_f32 v91, v11, v61
  v_mul_f32 v7, v90, v90
  v_add_f32 v11, v90, v90
  v_fma_f32 v60, -v91, v91, v7
  v_mul_f32 v61, v11, v91
  v_mul_f32 v7, v60, v60
  v_add_f32 v11, v60, v60
  v_fma_f32 v90, -v61, v61, v7
  v_mul_f32 v91, v11, v61
  ds_write_b64 v3, v[90:91] offset:37888
  v_mul_f32 v7, v90, v90
  v_add_f32 v11, v90, v90
  v_fma_f32 v60, -v91, v91, v7
  v_mul_f32 v61, v11, v91
  v_mul_f32 v7, v60, v60
  v_add_f32 v11, v60, v60
  v_fma_f32 v90, -v61, v61, v7
  v_mul_f32 v91, v11, v61
  ds_write_b64 v3, v[90:91] offset:38400
  v_mul_f32 v7, v90, v90
  v_add_f32 v11, v90, v90
  v_fma_f32 v60, -v91, v91, v7
  v_mul_f32 v61, v11, v91
  v_mul_f32 v7, v60, v60
  v_add_f32 v11, v60, v60
  v_fma_f32 v90, -v61, v61, v7
  v_mul_f32 v91, v11, v61
  v_mul_f32 v7, v90, v90
  v_add_f32 v11, v90, v90
  v_fma_f32 v60, -v91, v91, v7
  v_mul_f32 v61, v11, v91
  ds_write_b64 v3, v[60:61] offset:38912
  s_waitcnt vmcnt(11)
  v_mfma_f32_4x4x4_16b_bf16 v[148:151], v[100:101], v[100:101], 0
  v_mfma_f32_16x16x32_bf16 v[152:155], v[96:99], v[100:103], 0
  buffer_load_dwordx4 v[156:159], v10, s[4:7], s47 offen offset:128
  v_add_f32_dpp v3, v108, v108 quad_perm:[1,0,3,2] row_mask:0xf bank_mask:0xf
  v_mov_b32_dpp v7, v104 quad_perm:[0,0,0,0] row_mask:0xf bank_mask:0xf
  v_mfma_f32_4x4x4_16b_bf16 v[148:151], v[102:103], v[102:103], v[148:151]
  v_add_f32_dpp v11, v3, v3 quad_perm:[2,3,0,1] row_mask:0xf bank_mask:0xf
  v_add_f32_dpp v3, v105, v7 quad_perm:[1,1,1,1] row_mask:0xf bank_mask:0xf
  s_waitcnt vmcnt(9)
  v_mfma_f32_4x4x4_16b_bf16 v[148:151], v[112:113], v[112:113], v[148:151]
  v_mfma_f32_16x16x32_bf16 v[152:155], v[96:99], v[112:115], v[152:155]
  buffer_load_dwordx4 v[160:163], v10, s[4:7], s47 offen offset:256
  v_add_f32_dpp v7, v11, v11 row_half_mirror row_mask:0xf bank_mask:0xf
  v_add_f32_dpp v11, v106, v3 quad_perm:[2,2,2,2] row_mask:0xf bank_mask:0xf
  v_mfma_f32_4x4x4_16b_bf16 v[148:151], v[114:115], v[114:115], v[148:151]
  v_mul_f32 v3, -0.001736111111111111, v7
  v_add_f32_dpp v7, v107, v11 quad_perm:[3,3,3,3] row_mask:0xf bank_mask:0xf
  s_waitcnt vmcnt(9)
  v_mfma_f32_4x4x4_16b_bf16 v[148:151], v[116:117], v[116:117], v[148:151]
  v_mfma_f32_16x16x32_bf16 v[152:155], v[96:99], v[116:119], v[152:155]
  buffer_load_dwordx4 v[108:111], v10, s[4:7], s47 offen offset:384
  v_cvt_pk_bf16_f32 v11, v3, v3
  v_add_f32_dpp v49, v7, v7 row_half_mirror row_mask:0xf bank_mask:0xf
  v_mfma_f32_4x4x4_16b_bf16 v[148:151], v[118:119], v[118:119], v[148:151]
  v_and_b32 v164, 0xffff0000, v11
  v_and_b32 v165, 0xffff0000, v11
  s_waitcnt vmcnt(9)
  v_mfma_f32_4x4x4_16b_bf16 v[148:151], v[120:121], v[120:121], v[148:151]
  v_mfma_f32_16x16x32_bf16 v[152:155], v[96:99], v[120:123], v[152:155]
  buffer_load_dwordx4 v[168:171], v10, s[4:7], s47 offen offset:512
  v_and_b32 v166, 0xffff0000, v11
  v_and_b32 v167, 0xffff0000, v11
  v_mfma_f32_4x4x4_16b_bf16 v[148:151], v[122:123], v[122:123], v[148:151]
  s_nop 0
  v_mfma_f32_4x4x4_16b_bf16 v[104:107], v[92:93], v[12:13], v[164:167]
  v_mfma_f32_4x4x4_16b_bf16 v[172:175], v[92:93], v[14:15], v[164:167]
  s_waitcnt vmcnt(9)
  v_mfma_f32_4x4x4_16b_bf16 v[148:151], v[124:125], v[124:125], v[148:151]
  v_mfma_f32_16x16x32_bf16 v[152:155], v[96:99], v[124:127], v[152:155]
  buffer_load_dwordx4 v[176:179], v10, s[4:7], s47 offen offset:640
  v_mfma_f32_4x4x4_16b_bf16 v[180:183], v[92:93], v[16:17], v[164:167]
  v_mfma_f32_4x4x4_16b_bf16 v[184:187], v[92:93], v[18:19], v[164:167]
  v_mfma_f32_4x4x4_16b_bf16 v[148:151], v[126:127], v[126:127], v[148:151]
  v_cvt_pk_bf16_f32 v12, v104, v105
  v_cvt_pk_bf16_f32 v13, v106, v107
  s_waitcnt vmcnt(9)
  v_mfma_f32_4x4x4_16b_bf16 v[148:151], v[128:129], v[128:129], v[148:151]
  v_mfma_f32_16x16x32_bf16 v[152:155], v[96:99], v[128:131], v[152:155]
  buffer_load_dwordx4 v[188:191], v10, s[4:7], s47 offen offset:768
  v_cvt_pk_bf16_f32 v14, v172, v173
  v_cvt_pk_bf16_f32 v15, v174, v175
  v_mfma_f32_4x4x4_16b_bf16 v[148:151], v[130:131], v[130:131], v[148:151]
  ds_write_b128 v86, v[12:15] offset:0
  v_mfma_f32_4x4x4_16b_bf16 v[192:195], v[92:93], v[20:21], v[164:167]
  s_waitcnt vmcnt(9)
  v_mfma_f32_4x4x4_16b_bf16 v[148:151], v[132:133], v[132:133], v[148:151]
  v_mfma_f32_16x16x32_bf16 v[152:155], v[96:99], v[132:135], v[152:155]
  buffer_load_dwordx4 v[196:199], v10, s[4:7], s47 offen offset:896
  v_mfma_f32_4x4x4_16b_bf16 v[104:107], v[92:93], v[22:23], v[164:167]
  v_cvt_pk_bf16_f32 v16, v180, v181
  v_mfma_f32_4x4x4_16b_bf16 v[148:151], v[134:135], v[134:135], v[148:151]
  v_cvt_pk_bf16_f32 v17, v182, v183
  v_cvt_pk_bf16_f32 v18, v184, v185
  s_waitcnt vmcnt(9)
  v_mfma_f32_4x4x4_16b_bf16 v[148:151], v[136:137], v[136:137], v[148:151]
  v_mfma_f32_16x16x32_bf16 v[152:155], v[96:99], v[136:139], v[152:155]
  buffer_load_dwordx4 v[12:15], v10, s[4:7], s47 offen offset:1024
  v_cvt_pk_bf16_f32 v19, v186, v187
  ds_write_b128 v86, v[16:19] offset:4096
  v_mfma_f32_4x4x4_16b_bf16 v[148:151], v[138:139], v[138:139], v[148:151]
  v_cvt_pk_bf16_f32 v20, v192, v193
  v_cvt_pk_bf16_f32 v21, v194, v195
  s_waitcnt vmcnt(9)
  v_mfma_f32_4x4x4_16b_bf16 v[148:151], v[140:141], v[140:141], v[148:151]
  v_mfma_f32_16x16x32_bf16 v[152:155], v[96:99], v[140:143], v[152:155]
  buffer_load_dwordx4 v[172:175], v9, s[4:7], s47 offen offset:0
  v_cvt_pk_bf16_f32 v22, v104, v105
  v_cvt_pk_bf16_f32 v23, v106, v107
  v_mfma_f32_4x4x4_16b_bf16 v[148:151], v[142:143], v[142:143], v[148:151]
  ds_write_b128 v86, v[20:23] offset:8192
  s_waitcnt vmcnt(9)
  v_mfma_f32_4x4x4_16b_bf16 v[180:183], v[144:145], v[144:145], 0
  v_mfma_f32_16x16x32_bf16 v[16:19], v[96:99], v[144:147], 0
  buffer_load_dwordx4 v[184:187], v9, s[4:7], s47 offen offset:128
  v_add_f32_dpp v7, v152, v152 quad_perm:[1,0,3,2] row_mask:0xf bank_mask:0xf
  v_mov_b32_dpp v73, v148 quad_perm:[0,0,0,0] row_mask:0xf bank_mask:0xf
  v_mfma_f32_4x4x4_16b_bf16 v[180:183], v[146:147], v[146:147], v[180:183]
  v_add_f32_dpp v10, v7, v7 quad_perm:[2,3,0,1] row_mask:0xf bank_mask:0xf
  v_add_f32_dpp v7, v149, v73 quad_perm:[1,1,1,1] row_mask:0xf bank_mask:0xf
  s_waitcnt vmcnt(9)
  v_mfma_f32_4x4x4_16b_bf16 v[180:183], v[156:157], v[156:157], v[180:183]
  v_mfma_f32_16x16x32_bf16 v[16:19], v[96:99], v[156:159], v[16:19]
  buffer_load_dwordx4 v[104:107], v9, s[4:7], s47 offen offset:256
  v_add_f32_dpp v11, v10, v10 row_half_mirror row_mask:0xf bank_mask:0xf
  v_add_f32_dpp v10, v150, v7 quad_perm:[2,2,2,2] row_mask:0xf bank_mask:0xf
  v_mfma_f32_4x4x4_16b_bf16 v[180:183], v[158:159], v[158:159], v[180:183]
  v_mul_f32 v7, -0.001736111111111111, v11
  v_add_f32_dpp v11, v151, v10 quad_perm:[3,3,3,3] row_mask:0xf bank_mask:0xf
  s_waitcnt vmcnt(9)
  v_mfma_f32_4x4x4_16b_bf16 v[180:183], v[160:161], v[160:161], v[180:183]
  v_mfma_f32_16x16x32_bf16 v[16:19], v[96:99], v[160:163], v[16:19]
  buffer_load_dwordx4 v[20:23], v9, s[4:7], s47 offen offset:384
  v_cvt_pk_bf16_f32 v10, v7, v7
  v_add_f32_dpp v73, v11, v11 row_half_mirror row_mask:0xf bank_mask:0xf
  v_mfma_f32_4x4x4_16b_bf16 v[180:183], v[162:163], v[162:163], v[180:183]
  v_and_b32 v152, 0xffff0000, v10
  v_and_b32 v153, 0xffff0000, v10
  s_waitcnt vmcnt(9)
  v_mfma_f32_4x4x4_16b_bf16 v[180:183], v[108:109], v[108:109], v[180:183]
  v_mfma_f32_16x16x32_bf16 v[16:19], v[96:99], v[108:111], v[16:19]
  buffer_load_dwordx4 v[192:195], v9, s[4:7], s47 offen offset:512
  v_and_b32 v154, 0xffff0000, v10
  v_and_b32 v155, 0xffff0000, v10
  v_mfma_f32_4x4x4_16b_bf16 v[180:183], v[110:111], v[110:111], v[180:183]
  s_nop 0
  v_mfma_f32_4x4x4_16b_bf16 v[148:151], v[92:93], v[100:101], v[152:155]
  v_mfma_f32_4x4x4_16b_bf16 v[200:203], v[92:93], v[102:103], v[152:155]
  s_waitcnt vmcnt(9)
  v_mfma_f32_4x4x4_16b_bf16 v[180:183], v[168:169], v[168:169], v[180:183]
  v_mfma_f32_16x16x32_bf16 v[16:19], v[96:99], v[168:171], v[16:19]
  buffer_load_dwordx4 v[204:207], v9, s[4:7], s47 offen offset:640
  v_mfma_f32_4x4x4_16b_bf16 v[208:211], v[92:93], v[112:113], v[152:155]
  v_mfma_f32_4x4x4_16b_bf16 v[212:215], v[92:93], v[114:115], v[152:155]
  v_mfma_f32_4x4x4_16b_bf16 v[180:183], v[170:171], v[170:171], v[180:183]
  v_cvt_pk_bf16_f32 v100, v148, v149
  v_cvt_pk_bf16_f32 v101, v150, v151
  s_waitcnt vmcnt(9)
  v_mfma_f32_4x4x4_16b_bf16 v[180:183], v[176:177], v[176:177], v[180:183]
  v_mfma_f32_16x16x32_bf16 v[16:19], v[96:99], v[176:179], v[16:19]
  buffer_load_dwordx4 v[216:219], v9, s[4:7], s47 offen offset:768
  v_cvt_pk_bf16_f32 v102, v200, v201
  v_cvt_pk_bf16_f32 v103, v202, v203
  v_mfma_f32_4x4x4_16b_bf16 v[180:183], v[178:179], v[178:179], v[180:183]
  ds_write_b128 v87, v[100:103] offset:0
  v_mfma_f32_4x4x4_16b_bf16 v[220:223], v[92:93], v[116:117], v[152:155]
  s_waitcnt vmcnt(9)
  v_mfma_f32_4x4x4_16b_bf16 v[180:183], v[188:189], v[188:189], v[180:183]
  v_mfma_f32_16x16x32_bf16 v[16:19], v[96:99], v[188:191], v[16:19]
  buffer_load_dwordx4 v[224:227], v9, s[4:7], s47 offen offset:896
  v_mfma_f32_4x4x4_16b_bf16 v[148:151], v[92:93], v[118:119], v[152:155]
  v_cvt_pk_bf16_f32 v112, v208, v209
  v_mfma_f32_4x4x4_16b_bf16 v[180:183], v[190:191], v[190:191], v[180:183]
  v_cvt_pk_bf16_f32 v113, v210, v211
  v_cvt_pk_bf16_f32 v114, v212, v213
  s_waitcnt vmcnt(9)
  v_mfma_f32_4x4x4_16b_bf16 v[180:183], v[196:197], v[196:197], v[180:183]
  v_mfma_f32_16x16x32_bf16 v[16:19], v[96:99], v[196:199], v[16:19]
  buffer_load_dwordx4 v[100:103], v9, s[4:7], s47 offen offset:1024
  v_cvt_pk_bf16_f32 v115, v214, v215
  ds_write_b128 v87, v[112:115] offset:4096
  v_mfma_f32_4x4x4_16b_bf16 v[180:183], v[198:199], v[198:199], v[180:183]
  v_cvt_pk_bf16_f32 v116, v220, v221
  v_cvt_pk_bf16_f32 v117, v222, v223
  s_waitcnt vmcnt(9)
  v_mfma_f32_4x4x4_16b_bf16 v[180:183], v[12:13], v[12:13], v[180:183]
  v_mfma_f32_16x16x32_bf16 v[16:19], v[96:99], v[12:15], v[16:19]
  s_add_u32 m0, s0, 0x3000
  s_add_u32 s47, s56, 0
  buffer_load_dwordx4 v59, s[8:11], s47 offen offset:0 lds
  v_cvt_pk_bf16_f32 v118, v148, v149
  v_cvt_pk_bf16_f32 v119, v150, v151
  v_mfma_f32_4x4x4_16b_bf16 v[180:183], v[14:15], v[14:15], v[180:183]
  ds_write_b128 v87, v[116:119] offset:8192
  s_waitcnt vmcnt(9)
  v_mfma_f32_4x4x4_16b_bf16 v[112:115], v[172:173], v[172:173], 0
  v_mfma_f32_16x16x32_bf16 v[200:203], v[96:99], v[172:175], 0
  buffer_load_dwordx4 v6, s[8:11], s47 offen offset:1024 lds
  v_add_f32_dpp v53, v16, v16 quad_perm:[1,0,3,2] row_mask:0xf bank_mask:0xf
  v_mov_b32_dpp v55, v180 quad_perm:[0,0,0,0] row_mask:0xf bank_mask:0xf
  v_mfma_f32_4x4x4_16b_bf16 v[112:115], v[174:175], v[174:175], v[112:115]
  v_add_f32_dpp v60, v53, v53 quad_perm:[2,3,0,1] row_mask:0xf bank_mask:0xf
  v_add_f32_dpp v53, v181, v55 quad_perm:[1,1,1,1] row_mask:0xf bank_mask:0xf
  s_waitcnt vmcnt(9)
  v_mfma_f32_4x4x4_16b_bf16 v[112:115], v[184:185], v[184:185], v[112:115]
  v_mfma_f32_16x16x32_bf16 v[200:203], v[96:99], v[184:187], v[200:203]
  s_add_u32 m0, s0, 0x8000
  s_add_u32 s47, s57, 0
  buffer_load_dwordx4 v59, s[8:11], s47 offen offset:0 lds
  v_add_f32_dpp v55, v60, v60 row_half_mirror row_mask:0xf bank_mask:0xf
  v_add_f32_dpp v60, v182, v53 quad_perm:[2,2,2,2] row_mask:0xf bank_mask:0xf
  v_mfma_f32_4x4x4_16b_bf16 v[112:115], v[186:187], v[186:187], v[112:115]
  v_mul_f32 v61, -0.001736111111111111, v55
  v_add_f32_dpp v53, v183, v60 quad_perm:[3,3,3,3] row_mask:0xf bank_mask:0xf
  s_waitcnt vmcnt(9)
  v_mfma_f32_4x4x4_16b_bf16 v[112:115], v[104:105], v[104:105], v[112:115]
  v_mfma_f32_16x16x32_bf16 v[200:203], v[96:99], v[104:107], v[200:203]
  s_add_u32 m0, s0, 0x3800
  s_add_u32 s47, s1, 0
  buffer_load_dwordx4 v54, s[24:27], s47 offen offset:0 lds
  v_cvt_pk_bf16_f32 v55, v61, v61
  v_add_f32_dpp v60, v53, v53 row_half_mirror row_mask:0xf bank_mask:0xf
  v_mfma_f32_4x4x4_16b_bf16 v[112:115], v[106:107], v[106:107], v[112:115]
  v_and_b32 v16, 0xffff0000, v55
  v_and_b32 v17, 0xffff0000, v55
  s_waitcnt vmcnt(9)
  v_mfma_f32_4x4x4_16b_bf16 v[112:115], v[20:21], v[20:21], v[112:115]
  v_mfma_f32_16x16x32_bf16 v[200:203], v[96:99], v[20:23], v[200:203]
  buffer_load_dwordx4 v58, s[24:27], s47 offen offset:1024 lds
  v_and_b32 v18, 0xffff0000, v55
  v_and_b32 v19, 0xffff0000, v55
  v_mfma_f32_4x4x4_16b_bf16 v[112:115], v[22:23], v[22:23], v[112:115]
  s_nop 0
  v_mfma_f32_4x4x4_16b_bf16 v[116:119], v[92:93], v[144:145], v[16:19]
  v_mfma_f32_4x4x4_16b_bf16 v[148:151], v[92:93], v[146:147], v[16:19]
  s_waitcnt vmcnt(9)
  v_mfma_f32_4x4x4_16b_bf16 v[112:115], v[192:193], v[192:193], v[112:115]
  v_mfma_f32_16x16x32_bf16 v[200:203], v[96:99], v[192:195], v[200:203]
  s_add_u32 m0, s0, 0x4000
  s_add_u32 s47, s56, 0x80
  buffer_load_dwordx4 v59, s[8:11], s47 offen offset:0 lds
  v_mfma_f32_4x4x4_16b_bf16 v[180:183], v[92:93], v[156:157], v[16:19]
  v_mfma_f32_4x4x4_16b_bf16 v[208:211], v[92:93], v[158:159], v[16:19]
  v_mfma_f32_4x4x4_16b_bf16 v[112:115], v[194:195], v[194:195], v[112:115]
  v_cvt_pk_bf16_f32 v144, v116, v117
  v_cvt_pk_bf16_f32 v145, v118, v119
  s_waitcnt vmcnt(9)
  v_mfma_f32_4x4x4_16b_bf16 v[112:115], v[204:205], v[204:205], v[112:115]
  v_mfma_f32_16x16x32_bf16 v[200:203], v[96:99], v[204:207], v[200:203]
  buffer_load_dwordx4 v6, s[8:11], s47 offen offset:1024 lds
  v_cvt_pk_bf16_f32 v146, v148, v149
  v_cvt_pk_bf16_f32 v147, v150, v151
  v_mfma_f32_4x4x4_16b_bf16 v[112:115], v[206:207], v[206:207], v[112:115]
  ds_write_b128 v88, v[144:147] offset:0
  v_mfma_f32_4x4x4_16b_bf16 v[212:215], v[92:93], v[160:161], v[16:19]
  s_waitcnt vmcnt(9)
  v_mfma_f32_4x4x4_16b_bf16 v[112:115], v[216:217], v[216:217], v[112:115]
  v_mfma_f32_16x16x32_bf16 v[200:203], v[96:99], v[216:219], v[200:203]
  s_add_u32 m0, s0, 0x4800
  s_add_u32 s47, s1, 0x90000
  buffer_load_dwordx4 v54, s[24:27], s47 offen offset:0 lds
  v_mfma_f32_4x4x4_16b_bf16 v[116:119], v[92:93], v[162:163], v[16:19]
  v_cvt_pk_bf16_f32 v156, v180, v181
  v_mfma_f32_4x4x4_16b_bf16 v[112:115], v[218:219], v[218:219], v[112:115]
  v_cvt_pk_bf16_f32 v157, v182, v183
  v_cvt_pk_bf16_f32 v158, v208, v209
  s_waitcnt vmcnt(9)
  v_mfma_f32_4x4x4_16b_bf16 v[112:115], v[224:225], v[224:225], v[112:115]
  v_mfma_f32_16x16x32_bf16 v[200:203], v[96:99], v[224:227], v[200:203]
  buffer_load_dwordx4 v58, s[24:27], s47 offen offset:1024 lds
  v_cvt_pk_bf16_f32 v159, v210, v211
  ds_write_b128 v88, v[156:159] offset:4096
  v_mfma_f32_4x4x4_16b_bf16 v[112:115], v[226:227], v[226:227], v[112:115]
  v_cvt_pk_bf16_f32 v160, v212, v213
  v_cvt_pk_bf16_f32 v161, v214, v215
  s_waitcnt vmcnt(9)
  v_mfma_f32_4x4x4_16b_bf16 v[112:115], v[100:101], v[100:101], v[112:115]
  v_mfma_f32_16x16x32_bf16 v[200:203], v[96:99], v[100:103], v[200:203]
  s_add_u32 m0, s0, 0x5000
  s_add_u32 s47, s56, 0x100
  buffer_load_dwordx4 v59, s[8:11], s47 offen offset:0 lds
  v_cvt_pk_bf16_f32 v162, v116, v117
  v_cvt_pk_bf16_f32 v163, v118, v119
  v_mfma_f32_4x4x4_16b_bf16 v[112:115], v[102:103], v[102:103], v[112:115]
  ds_write_b128 v88, v[160:163] offset:8192
  s_nop 0
  v_add_f32_dpp v53, v200, v200 quad_perm:[1,0,3,2] row_mask:0xf bank_mask:0xf
  s_nop 1
  v_mov_b32_dpp v55, v112 quad_perm:[0,0,0,0] row_mask:0xf bank_mask:0xf
  v_add_f32_dpp v90, v53, v53 quad_perm:[2,3,0,1] row_mask:0xf bank_mask:0xf
  s_nop 0
  v_add_f32_dpp v53, v113, v55 quad_perm:[1,1,1,1] row_mask:0xf bank_mask:0xf
  v_add_f32_dpp v55, v90, v90 row_half_mirror row_mask:0xf bank_mask:0xf
  buffer_load_dwordx4 v6, s[8:11], s47 offen offset:1024 lds
  v_add_f32_dpp v90, v114, v53 quad_perm:[2,2,2,2] row_mask:0xf bank_mask:0xf
  v_mul_f32 v91, -0.001736111111111111, v55
  s_nop 0
  v_add_f32_dpp v53, v115, v90 quad_perm:[3,3,3,3] row_mask:0xf bank_mask:0xf
  v_cvt_pk_bf16_f32 v55, v91, v91
  s_nop 0
  v_add_f32_dpp v90, v53, v53 row_half_mirror row_mask:0xf bank_mask:0xf
  s_add_u32 m0, s0, 0x5800
  s_add_u32 s47, s57, 0x100
  buffer_load_dwordx4 v59, s[8:11], s47 offen offset:0 lds
  v_and_b32 v96, 0xffff0000, v55
  v_and_b32 v97, 0xffff0000, v55
  v_and_b32 v98, 0xffff0000, v55
  v_and_b32 v99, 0xffff0000, v55
  s_nop 1
  v_mfma_f32_4x4x4_16b_bf16 v[116:119], v[92:93], v[172:173], v[96:99]
  s_add_u32 m0, s0, 0x8400
  s_nop 0
  buffer_load_dwordx4 v66, s[4:7], s59 offen offset:0 lds
  v_mfma_f32_4x4x4_16b_bf16 v[112:115], v[92:93], v[174:175], v[96:99]
  v_mfma_f32_4x4x4_16b_bf16 v[144:147], v[92:93], v[184:185], v[96:99]
  v_mfma_f32_4x4x4_16b_bf16 v[148:151], v[92:93], v[186:187], v[96:99]
  v_cvt_pk_bf16_f32 v172, v116, v117
  v_cvt_pk_bf16_f32 v173, v118, v119
  s_add_u32 m0, s0, 0x8800
  s_nop 0
  buffer_load_dwordx4 v66, s[4:7], s60 offen offset:0 lds
  v_cvt_pk_bf16_f32 v174, v112, v113
  v_cvt_pk_bf16_f32 v175, v114, v115
  ds_write_b128 v89, v[172:175] offset:0
  v_mfma_f32_4x4x4_16b_bf16 v[156:159], v[92:93], v[104:105], v[96:99]
  v_mfma_f32_4x4x4_16b_bf16 v[160:163], v[92:93], v[106:107], v[96:99]
  s_add_u32 m0, s0, 0x8c00
  s_nop 0
  buffer_load_dwordx4 v65, s[4:7], s58 offen offset:0 lds
  v_cvt_pk_bf16_f32 v184, v144, v145
  v_cvt_pk_bf16_f32 v185, v146, v147
  v_cvt_pk_bf16_f32 v186, v148, v149
  v_cvt_pk_bf16_f32 v187, v150, v151
  ds_write_b128 v89, v[184:187] offset:4096
  v_cvt_pk_bf16_f32 v104, v156, v157
  v_cvt_pk_bf16_f32 v105, v158, v159
  v_cvt_pk_bf16_f32 v106, v160, v161
  v_cvt_pk_bf16_f32 v107, v162, v163
  ds_write_b128 v89, v[104:107] offset:8192
  s_waitcnt vmcnt(10) lgkmcnt(0)
  s_barrier
  ds_read_b128 a[0:3], v75 offset:0
  ds_read_b128 a[4:7], v78 offset:12288
  ds_read_b128 a[8:11], v75 offset:2048
  ds_read_b128 a[12:15], v76 offset:0
  ds_read_b128 a[16:19], v76 offset:2048
  ds_read_b128 a[20:23], v78 offset:13312
  ds_read_b128 a[24:27], v74 offset:0
  ds_read_b128 a[28:31], v2 offset:32768
  ds_read_b64_tr_b16 a[32:33], v4 offset:14336
  ds_read_b64_tr_b16 a[34:35], v71 offset:30720
  s_waitcnt lgkmcnt(4)
  v_mfma_f32_16x16x32_bf16 v[104:107], a[0:3], a[4:7], 0
  s_add_u32 m0, s0, 0x6000
  s_add_u32 s47, s1, 0x120000
  ds_read_b64_tr_b16 a[36:37], v4 offset:55296
  v_mfma_f32_16x16x32_bf16 v[112:115], a[8:11], a[4:7], 0
  ds_read_b64_tr_b16 a[38:39], v72 offset:6144
  buffer_load_dwordx4 v54, s[24:27], s47 offen offset:0 lds
  v_mfma_f32_16x16x32_bf16 v[116:119], a[12:15], a[4:7], 0
  v_cndmask_b32 v3, v3, v7, s[68:69]
  v_cndmask_b32 v7, v61, v91, s[68:69]
  v_mfma_f32_16x16x32_bf16 v[144:147], a[16:19], a[4:7], 0
  v_cndmask_b32 v3, v3, v7, s[70:71]
  v_cndmask_b32 v7, v49, v73, s[68:69]
  v_mfma_f32_16x16x32_bf16 v[148:151], a[16:19], a[20:23], 0
  buffer_load_dwordx4 v58, s[24:27], s47 offen offset:1024 lds
  s_add_u32 m0, s0, 0x6800
  v_mfma_f32_16x16x32_bf16 v[156:159], a[12:15], a[20:23], 0
  s_add_u32 s47, s56, 0x180
  ds_read_b128 a[40:43], v79 offset:0
  v_cndmask_b32 v49, v60, v90, s[68:69]
  v_mfma_f32_16x16x32_bf16 v[160:163], a[8:11], a[20:23], 0
  ds_read_b128 a[44:47], v84 offset:12288
  v_cndmask_b32 v7, v7, v49, s[70:71]
  v_mfma_f32_16x16x32_bf16 v[172:175], a[0:3], a[20:23], 0
  s_waitcnt lgkmcnt(2)
  ds_read_b128 a[4:7], v79 offset:2048
  buffer_load_dwordx4 v59, s[8:11], s47 offen offset:0 lds
  v_mfma_f32_16x16x32_bf16 v[180:183], a[24:27], a[28:31], 0
  ds_read_b128 a[48:51], v80 offset:0
  v_mul_f32 v49, v3, v3
  v_mfma_f32_16x16x32_bf16 v[184:187], a[32:35], a[0:3], 0
  ds_read_b128 a[52:55], v80 offset:2048
  v_mov_b32 v73, 0.001736111111111111
  v_mfma_f32_16x16x32_bf16 v[200:203], a[32:35], a[8:11], 0
  ds_read_b128 a[56:59], v84 offset:13312
  buffer_load_dwordx4 v6, s[8:11], s47 offen offset:1024 lds
  v_mfma_f32_16x16x32_bf16 v[208:211], a[32:35], a[12:15], 0
  s_add_u32 m0, s0, 0x7000
  s_add_u32 s47, s1, 0x1b0000
  ds_read_b128 a[20:23], v81 offset:0
  v_mfma_f32_16x16x32_bf16 v[212:215], a[32:35], a[16:19], 0
  ds_read_b128 a[24:27], v82 offset:32768
  v_fma_f32 v7, v7, v73, -v49
  v_mfma_f32_16x16x32_bf16 v[220:223], a[36:39], a[16:19], 0
  ds_read_b64_tr_b16 a[28:29], v4 offset:15360
  buffer_load_dwordx4 v54, s[24:27], s47 offen offset:0 lds
  v_mfma_f32_16x16x32_bf16 v[228:231], a[36:39], a[12:15], 0
  ds_read_b64_tr_b16 a[30:31], v71 offset:31744
  v_max_f32 v7, 0, v7
  v_mfma_f32_16x16x32_bf16 v[232:235], a[36:39], a[8:11], 0
  ds_read_b64_tr_b16 a[60:61], v4 offset:56320
  v_cvt_pk_bf16_f32 v3, v3, v3
  v_mfma_f32_16x16x32_bf16 v[236:239], a[36:39], a[0:3], 0
  s_waitcnt lgkmcnt(5)
  ds_read_b64_tr_b16 a[62:63], v72 offset:7168
  buffer_load_dwordx4 v58, s[24:27], s47 offen offset:1024 lds
  v_mfma_f32_16x16x32_bf16 v[104:107], a[40:43], a[44:47], v[104:107]
  s_add_u32 m0, s0, 0x7800
  s_add_u32 s47, s56, 0x200
  v_and_b32 v3, 0xffff0000, v3
  v_mfma_f32_16x16x32_bf16 v[112:115], a[4:7], a[44:47], v[112:115]
  v_cvt_pk_bf16_f32 v7, v7, v7
  v_and_b32 v7, 0xffff0000, v7
  v_mfma_f32_16x16x32_bf16 v[116:119], a[48:51], a[44:47], v[116:119]
  v_add_f32 v7, 1e-05, v7
  v_cvt_pk_bf16_f32 v7, v7, v7
  v_mfma_f32_16x16x32_bf16 v[144:147], a[52:55], a[44:47], v[144:147]
  v_and_b32 v7, 0xffff0000, v7
  v_mfma_f32_16x16x32_bf16 v[148:151], a[52:55], a[56:59], v[148:151]
  s_waitcnt vmcnt(12) lgkmcnt(0)
  s_barrier
  v_mfma_f32_16x16x32_bf16 v[156:159], a[48:51], a[56:59], v[156:159]
  ds_read_b128 a[32:35], v75 offset:4096
  v_sqrt_f32 v7, v7
  v_mfma_f32_16x16x32_bf16 v[160:163], a[4:7], a[56:59], v[160:163]
  ds_read_b128 a[36:39], v78 offset:16384
  v_bfe_u32 v49, v62, 4, 2
  v_mfma_f32_16x16x32_bf16 v[172:175], a[40:43], a[56:59], v[172:175]
  ds_read_b128 a[44:47], v75 offset:6144
  v_xor_b32 v49, s40, v49
  v_mfma_f32_16x16x32_bf16 v[180:183], a[20:23], a[24:27], v[180:183]
  s_bfe_u32 s55, s2, 0x10002
  s_mul_i32 s55, s55, 0x480
  ds_read_b128 a[64:67], v76 offset:4096
  v_mfma_f32_16x16x32_bf16 v[184:187], a[28:31], a[40:43], v[184:187]
  s_add_u32 s55, s54, s55
  ds_read_b128 a[68:71], v76 offset:6144
  v_cvt_pk_bf16_f32 v7, v7, v7
  v_mfma_f32_16x16x32_bf16 v[200:203], a[28:31], a[4:7], v[200:203]
  ds_read_b128 a[56:59], v78 offset:17408
  v_and_b32 v7, 0xffff0000, v7
  v_mfma_f32_16x16x32_bf16 v[208:211], a[28:31], a[48:51], v[208:211]
  v_rcp_f32 v7, v7
  v_mfma_f32_16x16x32_bf16 v[212:215], a[28:31], a[52:55], v[212:215]
  v_and_b32 v73, 1, v49
  v_lshl_add_u32 v73, v73, 5, v8
  v_mfma_f32_16x16x32_bf16 v[220:223], a[60:63], a[52:55], v[220:223]
  v_and_b32 v49, 2, v49
  v_lshl_add_u32 v49, v49, 1, v73
  v_mfma_f32_16x16x32_bf16 v[228:231], a[60:63], a[48:51], v[228:231]
  v_add_lshl_u32 v49, s46, v49, 2
  v_add_u32 v73, 0xa000, v49
  v_mfma_f32_16x16x32_bf16 v[232:235], a[60:63], a[4:7], v[232:235]
  ds_read_b128 a[20:23], v74 offset:4096
  v_mfma_f32_16x16x32_bf16 v[236:239], a[60:63], a[40:43], v[236:239]
  s_waitcnt lgkmcnt(1)
  ds_read_b128 a[24:27], v77 offset:32768
  v_mfma_f32_16x16x32_bf16 v[104:107], a[32:35], a[36:39], v[104:107]
  ds_read_b64_tr_b16 a[28:29], v4 offset:18432
  v_mfma_f32_16x16x32_bf16 v[112:115], a[44:47], a[36:39], v[112:115]
  ds_read_b64_tr_b16 a[30:31], v71 offset:34816
  v_mfma_f32_16x16x32_bf16 v[116:119], a[64:67], a[36:39], v[116:119]
  ds_read_b64_tr_b16 a[72:73], v4 offset:59392
  v_mfma_f32_16x16x32_bf16 v[144:147], a[68:71], a[36:39], v[144:147]
  ds_read_b64_tr_b16 a[74:75], v72 offset:10240
  v_mfma_f32_16x16x32_bf16 v[148:151], a[68:71], a[56:59], v[148:151]
  ds_write_b32 v49, v7 offset:40448
  v_mfma_f32_4x4x4_16b_bf16 v[8:11], v[92:93], v[24:25], v[164:167]
  v_mfma_f32_4x4x4_16b_bf16 v[240:243], v[92:93], v[26:27], v[164:167]
  ds_write_b32 v73, v3 offset:40448
  v_mfma_f32_16x16x32_bf16 v[156:159], a[64:67], a[56:59], v[156:159]
  v_mfma_f32_16x16x32_bf16 v[160:163], a[44:47], a[56:59], v[160:163]
  s_nop 0
  v_cvt_pk_bf16_f32 v24, v8, v9
  v_cvt_pk_bf16_f32 v25, v10, v11
  v_mfma_f32_16x16x32_bf16 v[172:175], a[32:35], a[56:59], v[172:175]
  s_waitcnt lgkmcnt(2)
  ds_read_b128 a[36:39], v79 offset:4096
  v_cvt_pk_bf16_f32 v26, v240, v241
  v_mfma_f32_16x16x32_bf16 v[180:183], a[20:23], a[24:27], v[180:183]
  ds_read_b128 a[60:63], v84 offset:16384
  v_cvt_pk_bf16_f32 v27, v242, v243
  v_mfma_f32_16x16x32_bf16 v[184:187], a[28:31], a[32:35], v[184:187]
  ds_read_b128 a[76:79], v79 offset:6144
  buffer_load_dword v1, v50, s[24:27], s55 offen offset:0
  v_mfma_f32_16x16x32_bf16 v[200:203], a[28:31], a[44:47], v[200:203]
  ds_read_b128 a[80:83], v80 offset:4096
  v_mfma_f32_16x16x32_bf16 v[208:211], a[28:31], a[64:67], v[208:211]
  ds_read_b128 a[56:59], v80 offset:6144
  buffer_load_dword v1, v50, s[24:27], s55 offen offset:640
  v_mfma_f32_16x16x32_bf16 v[212:215], a[28:31], a[68:71], v[212:215]
  ds_read_b128 a[20:23], v84 offset:17408
  v_mfma_f32_4x4x4_16b_bf16 v[8:11], v[92:93], v[120:121], v[152:155]
  buffer_load_dwordx4 v59, s[8:11], s47 offen offset:0 lds
  v_mfma_f32_4x4x4_16b_bf16 v[240:243], v[92:93], v[122:123], v[152:155]
  v_mfma_f32_16x16x32_bf16 v[220:223], a[72:75], a[68:71], v[220:223]
  v_mfma_f32_16x16x32_bf16 v[228:231], a[72:75], a[64:67], v[228:231]
  buffer_load_dwordx4 v6, s[8:11], s47 offen offset:1024 lds
  s_add_u32 m0, s0, 0x5c00
  v_mfma_f32_16x16x32_bf16 v[232:235], a[72:75], a[44:47], v[232:235]
  s_add_u32 s47, s57, 0x200
  ds_read_b128 a[24:27], v81 offset:4096
  v_cvt_pk_bf16_f32 v120, v8, v9
  v_mfma_f32_16x16x32_bf16 v[236:239], a[72:75], a[32:35], v[236:239]
  s_waitcnt lgkmcnt(1)
  ds_read_b128 a[28:31], v83 offset:32768
  v_cvt_pk_bf16_f32 v121, v10, v11
  v_mfma_f32_16x16x32_bf16 v[104:107], a[36:39], a[60:63], v[104:107]
  ds_read_b64_tr_b16 a[84:85], v4 offset:19456
  buffer_load_dwordx4 v59, s[8:11], s47 offen offset:0 lds
  v_mfma_f32_16x16x32_bf16 v[112:115], a[76:79], a[60:63], v[112:115]
  s_add_u32 m0, s0, 0
  s_add_u32 s47, s1, 0x240000
  ds_read_b64_tr_b16 a[86:87], v71 offset:35840
  v_mfma_f32_16x16x32_bf16 v[116:119], a[80:83], a[60:63], v[116:119]
  ds_read_b64_tr_b16 a[72:73], v4 offset:60416
  v_cvt_pk_bf16_f32 v122, v240, v241
  v_cvt_pk_bf16_f32 v123, v242, v243
  v_mfma_f32_16x16x32_bf16 v[144:147], a[56:59], a[60:63], v[144:147]
  ds_read_b64_tr_b16 a[74:75], v72 offset:11264
  buffer_load_dwordx4 v54, s[24:27], s47 offen offset:0 lds
  v_mfma_f32_4x4x4_16b_bf16 v[8:11], v[92:93], v[108:109], v[16:19]
  v_mfma_f32_4x4x4_16b_bf16 v[244:247], v[92:93], v[110:111], v[16:19]
  v_mfma_f32_16x16x32_bf16 v[148:151], a[56:59], a[20:23], v[148:151]
  buffer_load_dwordx4 v58, s[24:27], s47 offen offset:1024 lds
  s_add_u32 m0, s0, 0x800
  v_mfma_f32_16x16x32_bf16 v[156:159], a[80:83], a[20:23], v[156:159]
  s_add_u32 s47, s56, 0x280
  v_cvt_pk_bf16_f32 v108, v8, v9
  v_cvt_pk_bf16_f32 v109, v10, v11
  v_mfma_f32_16x16x32_bf16 v[160:163], a[76:79], a[20:23], v[160:163]
  s_waitcnt vmcnt(11) lgkmcnt(0)
  s_barrier
  v_mfma_f32_16x16x32_bf16 v[172:175], a[36:39], a[20:23], v[172:175]
  ds_read_b128 a[60:63], v75 offset:8192
  v_cvt_pk_bf16_f32 v110, v244, v245
  v_mfma_f32_16x16x32_bf16 v[180:183], a[24:27], a[28:31], v[180:183]
  ds_read_b128 a[88:91], v78 offset:20480
  v_cvt_pk_bf16_f32 v111, v246, v247
  v_mfma_f32_16x16x32_bf16 v[184:187], a[84:87], a[36:39], v[184:187]
  ds_read_b128 a[92:95], v75 offset:10240
  v_mfma_f32_16x16x32_bf16 v[200:203], a[84:87], a[76:79], v[200:203]
  ds_read_b128 a[96:99], v76 offset:8192
  v_mfma_f32_16x16x32_bf16 v[208:211], a[84:87], a[80:83], v[208:211]
  ds_read_b128 a[20:23], v76 offset:10240
  v_mfma_f32_4x4x4_16b_bf16 v[8:11], v[92:93], v[20:21], v[96:99]
  ds_read_b128 a[100:103], v78 offset:21504
  v_mfma_f32_4x4x4_16b_bf16 v[240:243], v[92:93], v[22:23], v[96:99]
  ds_write_b128 v86, v[24:27] offset:4096
  v_mfma_f32_16x16x32_bf16 v[212:215], a[84:87], a[56:59], v[212:215]
  ds_write_b128 v87, v[120:123] offset:4096
  v_mfma_f32_16x16x32_bf16 v[220:223], a[72:75], a[56:59], v[220:223]
  ds_write_b128 v88, v[108:111] offset:4096
  v_mfma_f32_16x16x32_bf16 v[228:231], a[72:75], a[80:83], v[228:231]
  v_cvt_pk_bf16_f32 v20, v8, v9
  v_cvt_pk_bf16_f32 v21, v10, v11
  v_mfma_f32_16x16x32_bf16 v[232:235], a[72:75], a[76:79], v[232:235]
  ds_read_b128 a[24:27], v74 offset:8192
  v_cvt_pk_bf16_f32 v22, v240, v241
  v_mfma_f32_16x16x32_bf16 v[236:239], a[72:75], a[36:39], v[236:239]
  s_waitcnt lgkmcnt(4)
  ds_read_b128 a[28:31], v2 offset:22528
  v_cvt_pk_bf16_f32 v23, v242, v243
  v_mfma_f32_16x16x32_bf16 v[104:107], a[60:63], a[88:91], v[104:107]
  ds_read_b64_tr_b16 a[84:85], v4 offset:24576
  v_mfma_f32_16x16x32_bf16 v[112:115], a[92:95], a[88:91], v[112:115]
  ds_read_b64_tr_b16 a[86:87], v71 offset:40960
  v_mfma_f32_16x16x32_bf16 v[116:119], a[96:99], a[88:91], v[116:119]
  ds_read_b64_tr_b16 a[104:105], v71 offset:0
  v_mfma_f32_16x16x32_bf16 v[144:147], a[20:23], a[88:91], v[144:147]
  ds_read_b64_tr_b16 a[106:107], v72 offset:16384
  v_mfma_f32_16x16x32_bf16 v[148:151], a[20:23], a[100:103], v[148:151]
  ds_write_b128 v89, v[20:23] offset:4096
  v_mfma_f32_4x4x4_16b_bf16 v[8:11], v[92:93], v[28:29], v[164:167]
  v_mfma_f32_4x4x4_16b_bf16 v[24:27], v[92:93], v[30:31], v[164:167]
  v_mfma_f32_16x16x32_bf16 v[156:159], a[96:99], a[100:103], v[156:159]
  v_mfma_f32_16x16x32_bf16 v[160:163], a[92:95], a[100:103], v[160:163]
  s_nop 1
  v_cvt_pk_bf16_f32 v28, v8, v9
  v_cvt_pk_bf16_f32 v29, v10, v11
  v_mfma_f32_16x16x32_bf16 v[172:175], a[60:63], a[100:103], v[172:175]
  s_waitcnt lgkmcnt(1)
  ds_read_b128 a[72:75], v79 offset:8192
  v_cvt_pk_bf16_f32 v30, v24, v25
  v_mfma_f32_16x16x32_bf16 v[180:183], a[24:27], a[28:31], v[180:183]
  ds_read_b128 a[88:91], v84 offset:20480
  v_cvt_pk_bf16_f32 v31, v26, v27
  v_mfma_f32_16x16x32_bf16 v[184:187], a[84:87], a[60:63], v[184:187]
  ds_read_b128 a[108:111], v79 offset:10240
  v_mfma_f32_16x16x32_bf16 v[200:203], a[84:87], a[92:95], v[200:203]
  ds_read_b128 a[112:115], v80 offset:8192
  v_mfma_f32_16x16x32_bf16 v[208:211], a[84:87], a[96:99], v[208:211]
  ds_read_b128 a[100:103], v80 offset:10240
  buffer_load_dwordx4 v59, s[8:11], s47 offen offset:0 lds
  v_mfma_f32_16x16x32_bf16 v[212:215], a[84:87], a[20:23], v[212:215]
  ds_read_b128 a[116:119], v84 offset:21504
  v_mfma_f32_4x4x4_16b_bf16 v[8:11], v[92:93], v[124:125], v[152:155]
  v_mfma_f32_4x4x4_16b_bf16 v[20:23], v[92:93], v[126:127], v[152:155]
  buffer_load_dwordx4 v6, s[8:11], s47 offen offset:1024 lds
  s_add_u32 m0, s0, 0x3000
  v_mfma_f32_16x16x32_bf16 v[220:223], a[104:107], a[20:23], v[220:223]
  s_add_u32 s47, s1, 0x2d0000
  v_mfma_f32_16x16x32_bf16 v[228:231], a[104:107], a[96:99], v[228:231]
  v_cvt_pk_bf16_f32 v124, v8, v9
  v_cvt_pk_bf16_f32 v125, v10, v11
  v_mfma_f32_16x16x32_bf16 v[232:235], a[104:107], a[92:95], v[232:235]
  ds_read_b128 a[24:27], v81 offset:8192
  buffer_load_dwordx4 v54, s[24:27], s47 offen offset:0 lds
  v_mfma_f32_16x16x32_bf16 v[236:239], a[104:107], a[60:63], v[236:239]
  s_waitcnt lgkmcnt(1)
  ds_read_b128 a[28:31], v82 offset:22528
  v_cvt_pk_bf16_f32 v126, v20, v21
  v_mfma_f32_16x16x32_bf16 v[104:107], a[72:75], a[88:91], v[104:107]
  ds_read_b64_tr_b16 a[84:85], v4 offset:25600
  v_cvt_pk_bf16_f32 v127, v22, v23
  v_mfma_f32_16x16x32_bf16 v[112:115], a[108:111], a[88:91], v[112:115]
  ds_read_b64_tr_b16 a[86:87], v71 offset:41984
  buffer_load_dwordx4 v58, s[24:27], s47 offen offset:1024 lds
  v_mfma_f32_16x16x32_bf16 v[116:119], a[112:115], a[88:91], v[116:119]
  s_add_u32 m0, s0, 0x3800
  s_add_u32 s47, s56, 0x300
  ds_read_b64_tr_b16 a[104:105], v71 offset:1024
  v_mfma_f32_16x16x32_bf16 v[144:147], a[100:103], a[88:91], v[144:147]
  s_lshl1_add_u32 s55, s41, s43
  s_sub_u32 s55, 31, s55
  ds_read_b64_tr_b16 a[106:107], v72 offset:17408
  v_mfma_f32_4x4x4_16b_bf16 v[8:11], v[92:93], v[168:169], v[16:19]
  s_lshl_b32 s60, s49, 5
  s_add_u32 s55, s55, s60
  v_mfma_f32_4x4x4_16b_bf16 v[20:23], v[92:93], v[170:171], v[16:19]
  s_lshl_b32 s55, s55, 7
  s_lshl1_add_u32 s60, s41, s44
  s_sub_u32 s60, 0x41f, s60
  v_mfma_f32_16x16x32_bf16 v[148:151], a[100:103], a[116:119], v[148:151]
  s_lshl1_add_u32 s58, s51, s45
  s_lshl_b32 s58, s58, 5
  s_add_u32 s60, s60, s58
  v_mfma_f32_16x16x32_bf16 v[156:159], a[112:115], a[116:119], v[156:159]
  s_lshl_b32 s60, s60, 7
  v_cvt_pk_bf16_f32 v168, v8, v9
  v_cvt_pk_bf16_f32 v169, v10, v11
  v_mfma_f32_16x16x32_bf16 v[160:163], a[108:111], a[116:119], v[160:163]
  s_waitcnt vmcnt(11) lgkmcnt(0)
  s_barrier
  v_mfma_f32_16x16x32_bf16 v[172:175], a[72:75], a[116:119], v[172:175]
  ds_read_b128 a[88:91], v75 offset:4096
  v_cvt_pk_bf16_f32 v170, v20, v21
  v_mfma_f32_16x16x32_bf16 v[180:183], a[24:27], a[28:31], v[180:183]
  s_lshl_b32 s58, s41, 7
  ds_read_b128 a[120:123], v78 offset:26624
  v_cvt_pk_bf16_f32 v171, v22, v23
  v_mfma_f32_16x16x32_bf16 v[184:187], a[84:87], a[72:75], v[184:187]
  s_and_b32 s59, s41, 7
  s_and_b32 s59, s41, 8
  ds_read_b128 a[124:127], v75 offset:6144
  v_mfma_f32_16x16x32_bf16 v[200:203], a[84:87], a[108:111], v[200:203]
  s_lshl_b32 s59, s59, 10
  s_add_u32 s58, s58, s59
  ds_read_b128 a[116:119], v76 offset:4096
  v_mfma_f32_16x16x32_bf16 v[208:211], a[84:87], a[112:115], v[208:211]
  s_add_u32 s58, s58, 0x50000
  s_lshl_b32 s59, s52, 2
  ds_read_b128 a[24:27], v76 offset:6144
  v_mfma_f32_4x4x4_16b_bf16 v[8:11], v[92:93], v[192:193], v[96:99]
  s_add_u32 s59, s59, s58
  ds_read_b128 a[28:31], v78 offset:27648
  v_mfma_f32_4x4x4_16b_bf16 v[20:23], v[92:93], v[194:195], v[96:99]
  ds_write_b128 v86, v[28:31] offset:8192
  v_mfma_f32_16x16x32_bf16 v[212:215], a[84:87], a[100:103], v[212:215]
  ds_write_b128 v87, v[124:127] offset:8192
  v_mfma_f32_16x16x32_bf16 v[220:223], a[104:107], a[100:103], v[220:223]
  ds_write_b128 v88, v[168:171] offset:8192
  v_mfma_f32_16x16x32_bf16 v[228:231], a[104:107], a[112:115], v[228:231]
  v_cvt_pk_bf16_f32 v192, v8, v9
  v_cvt_pk_bf16_f32 v193, v10, v11
  v_mfma_f32_16x16x32_bf16 v[232:235], a[104:107], a[108:111], v[232:235]
  ds_read_b128 a[128:131], v74 offset:4096
  v_cvt_pk_bf16_f32 v194, v20, v21
  v_mfma_f32_16x16x32_bf16 v[236:239], a[104:107], a[72:75], v[236:239]
  s_waitcnt lgkmcnt(4)
  ds_read_b128 a[84:87], v77 offset:22528
  v_cvt_pk_bf16_f32 v195, v22, v23
  v_mfma_f32_16x16x32_bf16 v[104:107], a[88:91], a[120:123], v[104:107]
  ds_read_b64_tr_b16 a[132:133], v4 offset:28672
  v_lshlrev_b32 v3, 3, v48
  v_mfma_f32_16x16x32_bf16 v[112:115], a[124:127], a[120:123], v[112:115]
  ds_read_b64_tr_b16 a[134:135], v71 offset:45056
  v_lshlrev_b32 v7, 2, v48
  v_mfma_f32_16x16x32_bf16 v[116:119], a[116:119], a[120:123], v[116:119]
  ds_read_b64_tr_b16 a[136:137], v71 offset:4096
  v_mov_b32 v49, 0
  v_mfma_f32_16x16x32_bf16 v[144:147], a[24:27], a[120:123], v[144:147]
  ds_read_b64_tr_b16 a[138:139], v72 offset:20480
  v_mov_b32 v8, -1
  v_mfma_f32_16x16x32_bf16 v[148:151], a[24:27], a[28:31], v[148:151]
  ds_write_b128 v89, v[192:195] offset:8192
  v_mfma_f32_4x4x4_16b_bf16 v[20:23], v[92:93], v[32:33], v[164:167]
  v_mov_b32 v9, -1
  v_mfma_f32_4x4x4_16b_bf16 v[24:27], v[92:93], v[34:35], v[164:167]
  v_mov_b32 v10, -1
  v_mov_b32 v11, -1
  v_mfma_f32_16x16x32_bf16 v[156:159], a[116:119], a[28:31], v[156:159]
  v_lshrrev_b32 v49, 7, v62
  v_lshl_add_u32 v49, v49, 28, v62
  v_mfma_f32_16x16x32_bf16 v[160:163], a[124:127], a[28:31], v[160:163]
  v_cvt_pk_bf16_f32 v32, v20, v21
  v_cvt_pk_bf16_f32 v33, v22, v23
  v_mfma_f32_16x16x32_bf16 v[172:175], a[88:91], a[28:31], v[172:175]
  s_waitcnt lgkmcnt(1)
  ds_read_b128 a[104:107], v79 offset:4096
  v_cvt_pk_bf16_f32 v34, v24, v25
  v_mfma_f32_16x16x32_bf16 v[180:183], a[128:131], a[84:87], v[180:183]
  ds_read_b128 a[120:123], v84 offset:26624
  v_cvt_pk_bf16_f32 v35, v26, v27
  v_mfma_f32_16x16x32_bf16 v[184:187], a[132:135], a[88:91], v[184:187]
  ds_read_b128 a[140:143], v79 offset:6144
  v_lshrrev_b32 v73, 6, v62
  v_mfma_f32_16x16x32_bf16 v[200:203], a[132:135], a[124:127], v[200:203]
  ds_read_b128 a[144:147], v80 offset:4096
  v_lshl_add_u32 v73, v73, 27, v62
  v_mfma_f32_16x16x32_bf16 v[208:211], a[132:135], a[116:119], v[208:211]
  s_min_u32 s73, s3, 1
  ds_read_b128 a[28:31], v80 offset:6144
  buffer_load_dwordx4 v59, s[8:11], s47 offen offset:0 lds
  v_mfma_f32_16x16x32_bf16 v[212:215], a[132:135], a[24:27], v[212:215]
  s_lshl_b32 s73, s73, 28
  s_add_u32 s73, s73, s60
  ds_read_b128 a[84:87], v84 offset:27648
  v_mfma_f32_4x4x4_16b_bf16 v[20:23], v[92:93], v[128:129], v[152:155]
  s_or_b32 s74, s52, s3
  s_min_u32 s74, s74, 1
  v_mfma_f32_4x4x4_16b_bf16 v[24:27], v[92:93], v[130:131], v[152:155]
  s_lshl_b32 s74, s74, 28
  buffer_load_dwordx4 v6, s[8:11], s47 offen offset:1024 lds
  s_add_u32 m0, s0, 0x8000
  v_mfma_f32_16x16x32_bf16 v[220:223], a[136:139], a[24:27], v[220:223]
  s_add_u32 s47, s57, 0x300
  s_add_u32 s57, s74, s58
  v_mfma_f32_16x16x32_bf16 v[228:231], a[136:139], a[116:119], v[228:231]
  buffer_store_dwordx4 v[8:11], v62, s[36:39], s64 offen offset:2048 sc1
  v_mfma_f32_16x16x32_bf16 v[232:235], a[136:139], a[124:127], v[232:235]
  ds_read_b128 a[128:131], v81 offset:4096
  v_cvt_pk_bf16_f32 v128, v20, v21
  v_mfma_f32_16x16x32_bf16 v[236:239], a[136:139], a[88:91], v[236:239]
  s_waitcnt lgkmcnt(1)
  ds_read_b128 a[132:135], v83 offset:22528
  v_cvt_pk_bf16_f32 v129, v22, v23
  v_mfma_f32_16x16x32_bf16 v[104:107], a[104:107], a[120:123], v[104:107]
  ds_read_b64_tr_b16 a[148:149], v4 offset:29696
  buffer_store_dwordx4 v[8:11], v49, s[36:39], s55 offen sc1
  v_mfma_f32_16x16x32_bf16 v[112:115], a[140:143], a[120:123], v[112:115]
  ds_read_b64_tr_b16 a[150:151], v71 offset:46080
  v_cvt_pk_bf16_f32 v130, v24, v25
  v_mfma_f32_16x16x32_bf16 v[116:119], a[144:147], a[120:123], v[116:119]
  ds_read_b64_tr_b16 a[152:153], v71 offset:5120
  v_cvt_pk_bf16_f32 v131, v26, v27
  v_mfma_f32_16x16x32_bf16 v[144:147], a[28:31], a[120:123], v[144:147]
  ds_read_b64_tr_b16 a[154:155], v72 offset:21504
  buffer_store_dwordx4 v[8:11], v49, s[36:39], s73 offen sc1
  v_mfma_f32_4x4x4_16b_bf16 v[20:23], v[92:93], v[176:177], v[16:19]
  v_mfma_f32_4x4x4_16b_bf16 v[28:31], v[92:93], v[178:179], v[16:19]
  buffer_store_dwordx4 v[8:11], v49, s[36:39], s57 offen sc1
  v_mfma_f32_16x16x32_bf16 v[148:151], a[28:31], a[84:87], v[148:151]
  v_mfma_f32_16x16x32_bf16 v[156:159], a[144:147], a[84:87], v[156:159]
  buffer_load_dwordx4 v59, s[8:11], s47 offen offset:0 lds
  s_add_u32 m0, s0, 0x4000
  v_mfma_f32_16x16x32_bf16 v[160:163], a[140:143], a[84:87], v[160:163]
  s_waitcnt vmcnt(11) lgkmcnt(0)
  s_barrier
  v_mfma_f32_16x16x32_bf16 v[172:175], a[104:107], a[84:87], v[172:175]
  s_add_u32 s47, s1, 0x360000
  ds_read_b128 a[120:123], v75 offset:8192
  v_mfma_f32_16x16x32_bf16 v[180:183], a[128:131], a[132:135], v[180:183]
  ds_read_b128 a[136:139], v78 offset:30720
  buffer_store_dwordx4 v[8:11], v62, s[36:39], s64 offen offset:3072 sc1
  v_mfma_f32_16x16x32_bf16 v[184:187], a[148:151], a[104:107], v[184:187]
  ds_read_b128 a[156:159], v75 offset:10240
  v_cvt_pk_bf16_f32 v176, v20, v21
  v_mfma_f32_16x16x32_bf16 v[200:203], a[148:151], a[140:143], v[200:203]
  ds_read_b128 a[160:163], v76 offset:8192
  v_cvt_pk_bf16_f32 v177, v22, v23
  v_cvt_pk_bf16_f32 v178, v28, v29
  v_cvt_pk_bf16_f32 v179, v30, v31
  v_mfma_f32_16x16x32_bf16 v[208:211], a[148:151], a[144:147], v[208:211]
  ds_read_b128 a[84:87], v76 offset:10240
  buffer_load_dwordx4 v54, s[24:27], s47 offen offset:0 lds
  v_mfma_f32_4x4x4_16b_bf16 v[24:27], v[92:93], v[204:205], v[96:99]
  ds_read_b128 a[128:131], v78 offset:31744
  v_mfma_f32_4x4x4_16b_bf16 v[108:111], v[92:93], v[206:207], v[96:99]
  buffer_store_dwordx4 v[8:11], v62, s[36:39], s65 offen offset:2048 sc1
  v_mfma_f32_16x16x32_bf16 v[212:215], a[148:151], a[28:31], v[212:215]
  ds_write_b128 v86, v[32:35] offset:4096
  v_mfma_f32_16x16x32_bf16 v[220:223], a[152:155], a[28:31], v[220:223]
  buffer_load_dwordx4 v58, s[24:27], s47 offen offset:1024 lds
  s_add_u32 m0, s0, 0x4800
  v_mfma_f32_16x16x32_bf16 v[228:231], a[152:155], a[144:147], v[228:231]
  s_add_u32 s47, s56, 0x380
  ds_write_b128 v87, v[128:131] offset:4096
  v_mfma_f32_16x16x32_bf16 v[232:235], a[152:155], a[140:143], v[232:235]
  ds_read_b128 a[132:135], v74 offset:8192
  v_cvt_pk_bf16_f32 v204, v24, v25
  v_mfma_f32_16x16x32_bf16 v[236:239], a[152:155], a[104:107], v[236:239]
  s_waitcnt lgkmcnt(3)
  ds_read_b128 a[148:151], v2 offset:23552
  buffer_store_dwordx4 v[8:11], v62, s[36:39], s65 offen offset:3072 sc1
  v_mfma_f32_16x16x32_bf16 v[104:107], a[120:123], a[136:139], v[104:107]
  ds_read_b64_tr_b16 a[164:165], v4 offset:0
  v_cvt_pk_bf16_f32 v205, v26, v27
  v_mfma_f32_16x16x32_bf16 v[112:115], a[156:159], a[136:139], v[112:115]
  ds_read_b64_tr_b16 a[166:167], v71 offset:16384
  v_cvt_pk_bf16_f32 v206, v108, v109
  v_cvt_pk_bf16_f32 v207, v110, v111
  v_mfma_f32_16x16x32_bf16 v[116:119], a[160:163], a[136:139], v[116:119]
  ds_read_b64_tr_b16 a[152:153], v4 offset:40960
  v_mfma_f32_16x16x32_bf16 v[144:147], a[84:87], a[136:139], v[144:147]
  ds_read_b64_tr_b16 a[154:155], v71 offset:57344
  v_mfma_f32_16x16x32_bf16 v[148:151], a[84:87], a[128:131], v[148:151]
  ds_write_b128 v88, v[176:179] offset:4096
  v_mfma_f32_4x4x4_16b_bf16 v[20:23], v[92:93], v[36:37], v[164:167]
  v_mfma_f32_4x4x4_16b_bf16 v[24:27], v[92:93], v[38:39], v[164:167]
  ds_write_b128 v89, v[204:207] offset:4096
  v_mfma_f32_16x16x32_bf16 v[156:159], a[160:163], a[128:131], v[156:159]
  v_mfma_f32_16x16x32_bf16 v[160:163], a[156:159], a[128:131], v[160:163]
  s_nop 0
  v_cvt_pk_bf16_f32 v36, v20, v21
  v_cvt_pk_bf16_f32 v37, v22, v23
  v_mfma_f32_16x16x32_bf16 v[172:175], a[120:123], a[128:131], v[172:175]
  s_waitcnt lgkmcnt(2)
  ds_read_b128 a[136:139], v79 offset:8192
  v_cvt_pk_bf16_f32 v38, v24, v25
  v_mfma_f32_16x16x32_bf16 v[180:183], a[132:135], a[148:151], v[180:183]
  ds_read_b128 a[168:171], v84 offset:30720
  v_cvt_pk_bf16_f32 v39, v26, v27
  v_mfma_f32_16x16x32_bf16 v[184:187], a[164:167], a[120:123], v[184:187]
  ds_read_b128 a[172:175], v79 offset:10240
  v_mfma_f32_16x16x32_bf16 v[200:203], a[164:167], a[156:159], v[200:203]
  ds_read_b128 a[176:179], v80 offset:8192
  v_mfma_f32_16x16x32_bf16 v[208:211], a[164:167], a[160:163], v[208:211]
  ds_read_b128 a[128:131], v80 offset:10240
  buffer_load_dwordx4 v59, s[8:11], s47 offen offset:0 lds
  v_mfma_f32_16x16x32_bf16 v[212:215], a[164:167], a[84:87], v[212:215]
  ds_read_b128 a[180:183], v84 offset:31744
  v_mfma_f32_4x4x4_16b_bf16 v[20:23], v[92:93], v[132:133], v[152:155]
  v_mfma_f32_4x4x4_16b_bf16 v[28:31], v[92:93], v[134:135], v[152:155]
  buffer_store_dwordx4 v[8:11], v62, s[36:39], s61 offen offset:2048 sc1
  v_mfma_f32_16x16x32_bf16 v[220:223], a[152:155], a[84:87], v[220:223]
  v_mfma_f32_16x16x32_bf16 v[228:231], a[152:155], a[160:163], v[228:231]
  buffer_load_dwordx4 v6, s[8:11], s47 offen offset:1024 lds
  s_add_u32 m0, s0, 0x5000
  v_mfma_f32_16x16x32_bf16 v[232:235], a[152:155], a[156:159], v[232:235]
  s_add_u32 s47, s1, 0x3f0000
  ds_read_b128 a[132:135], v81 offset:8192
  v_cvt_pk_bf16_f32 v132, v20, v21
  v_mfma_f32_16x16x32_bf16 v[236:239], a[152:155], a[120:123], v[236:239]
  s_waitcnt lgkmcnt(1)
  ds_read_b128 a[148:151], v82 offset:23552
  v_cvt_pk_bf16_f32 v133, v22, v23
  v_mfma_f32_16x16x32_bf16 v[104:107], a[136:139], a[168:171], v[104:107]
  ds_read_b64_tr_b16 a[164:165], v4 offset:1024
  buffer_store_dwordx4 v[8:11], v62, s[36:39], s61 offen offset:3072 sc1
  v_mfma_f32_16x16x32_bf16 v[112:115], a[172:175], a[168:171], v[112:115]
  ds_read_b64_tr_b16 a[166:167], v71 offset:17408
  v_cvt_pk_bf16_f32 v134, v28, v29
  v_mfma_f32_16x16x32_bf16 v[116:119], a[176:179], a[168:171], v[116:119]
  ds_read_b64_tr_b16 a[184:185], v4 offset:41984
  v_cvt_pk_bf16_f32 v135, v30, v31
  v_mfma_f32_16x16x32_bf16 v[144:147], a[128:131], a[168:171], v[144:147]
  ds_read_b64_tr_b16 a[186:187], v71 offset:58368
  buffer_load_dwordx4 v54, s[24:27], s47 offen offset:0 lds
  v_mfma_f32_4x4x4_16b_bf16 v[20:23], v[92:93], v[188:189], v[16:19]
  v_mov_b32 v49, 1
  v_mfma_f32_4x4x4_16b_bf16 v[8:11], v[92:93], v[190:191], v[16:19]
  s_and_b32 s57, s2, 1
  s_lshl_b32 s57, s57, 7
  v_mfma_f32_16x16x32_bf16 v[148:151], a[128:131], a[180:183], v[148:151]
  buffer_load_dwordx4 v58, s[24:27], s47 offen offset:1024 lds
  s_add_u32 m0, s0, 0x6000
  v_mfma_f32_16x16x32_bf16 v[156:159], a[176:179], a[180:183], v[156:159]
  s_add_u32 s47, s56, 0x400
  v_cvt_pk_bf16_f32 v188, v20, v21
  v_cvt_pk_bf16_f32 v189, v22, v23
  v_mfma_f32_16x16x32_bf16 v[160:163], a[172:175], a[180:183], v[160:163]
  s_waitcnt vmcnt(18) lgkmcnt(0)
  s_barrier
  v_mfma_f32_16x16x32_bf16 v[172:175], a[136:139], a[180:183], v[172:175]
  ds_read_b128 a[152:155], v75 offset:4096
  v_cvt_pk_bf16_f32 v190, v8, v9
  v_mfma_f32_16x16x32_bf16 v[180:183], a[132:135], a[148:151], v[180:183]
  ds_read_b128 a[168:171], v78 offset:2048
  v_cvt_pk_bf16_f32 v191, v10, v11
  v_mfma_f32_16x16x32_bf16 v[184:187], a[164:167], a[136:139], v[184:187]
  ds_read_b128 a[188:191], v75 offset:6144
  v_mfma_f32_16x16x32_bf16 v[200:203], a[164:167], a[172:175], v[200:203]
  ds_read_b128 a[192:195], v76 offset:4096
  v_mfma_f32_16x16x32_bf16 v[208:211], a[164:167], a[176:179], v[208:211]
  ds_read_b128 a[180:183], v76 offset:6144
  v_mfma_f32_4x4x4_16b_bf16 v[20:23], v[92:93], v[216:217], v[96:99]
  ds_read_b128 a[196:199], v78 offset:3072
  v_mfma_f32_4x4x4_16b_bf16 v[24:27], v[92:93], v[218:219], v[96:99]
  ds_write_b128 v86, v[36:39] offset:8192
  v_mfma_f32_16x16x32_bf16 v[212:215], a[164:167], a[128:131], v[212:215]
  ds_write_b128 v87, v[132:135] offset:8192
  v_mfma_f32_16x16x32_bf16 v[220:223], a[184:187], a[128:131], v[220:223]
  ds_write_b128 v88, v[188:191] offset:8192
  v_mfma_f32_16x16x32_bf16 v[228:231], a[184:187], a[176:179], v[228:231]
  v_cvt_pk_bf16_f32 v216, v20, v21
  v_cvt_pk_bf16_f32 v217, v22, v23
  v_mfma_f32_16x16x32_bf16 v[232:235], a[184:187], a[172:175], v[232:235]
  ds_read_b128 a[132:135], v74 offset:4096
  v_cvt_pk_bf16_f32 v218, v24, v25
  v_mfma_f32_16x16x32_bf16 v[236:239], a[184:187], a[136:139], v[236:239]
  s_waitcnt lgkmcnt(4)
  ds_read_b128 a[148:151], v77 offset:23552
  v_cvt_pk_bf16_f32 v219, v26, v27
  v_mfma_f32_16x16x32_bf16 v[104:107], a[152:155], a[168:171], v[104:107]
  ds_read_b64_tr_b16 a[164:165], v4 offset:12288
  v_mfma_f32_16x16x32_bf16 v[112:115], a[188:191], a[168:171], v[112:115]
  ds_read_b64_tr_b16 a[166:167], v71 offset:28672
  v_mfma_f32_16x16x32_bf16 v[116:119], a[192:195], a[168:171], v[116:119]
  ds_read_b64_tr_b16 a[200:201], v4 offset:53248
  v_mfma_f32_16x16x32_bf16 v[144:147], a[180:183], a[168:171], v[144:147]
  ds_read_b64_tr_b16 a[202:203], v72 offset:4096
  v_mfma_f32_16x16x32_bf16 v[148:151], a[180:183], a[196:199], v[148:151]
  ds_write_b128 v89, v[216:219] offset:8192
  v_mfma_f32_4x4x4_16b_bf16 v[8:11], v[92:93], v[40:41], v[164:167]
  buffer_load_dwordx4 v59, s[8:11], s47 offen offset:0 lds
  v_mfma_f32_4x4x4_16b_bf16 v[20:23], v[92:93], v[42:43], v[164:167]
  v_mfma_f32_16x16x32_bf16 v[156:159], a[192:195], a[196:199], v[156:159]
  v_mfma_f32_16x16x32_bf16 v[160:163], a[188:191], a[196:199], v[160:163]
  buffer_load_dwordx4 v6, s[8:11], s47 offen offset:1024 lds
  s_add_u32 m0, s0, 0x5800
  v_mfma_f32_16x16x32_bf16 v[172:175], a[152:155], a[196:199], v[172:175]
  s_waitcnt lgkmcnt(1)
  s_add_u32 s47, s50, 0x400
  ds_read_b128 a[168:171], v79 offset:4096
  v_mfma_f32_16x16x32_bf16 v[180:183], a[132:135], a[148:151], v[180:183]
  ds_read_b128 a[184:187], v84 offset:2048
  v_cvt_pk_bf16_f32 v40, v8, v9
  v_mfma_f32_16x16x32_bf16 v[184:187], a[164:167], a[152:155], v[184:187]
  ds_read_b128 a[204:207], v79 offset:6144
  buffer_load_dwordx4 v59, s[8:11], s47 offen offset:0 lds
  v_mfma_f32_16x16x32_bf16 v[200:203], a[164:167], a[188:191], v[200:203]
  s_add_u32 m0, s0, 0x6800
  s_add_u32 s1, s1, 0x480000
  ds_read_b128 a[196:199], v80 offset:4096
  v_mfma_f32_16x16x32_bf16 v[208:211], a[164:167], a[192:195], v[208:211]
  ds_read_b128 a[208:211], v80 offset:6144
  v_cvt_pk_bf16_f32 v41, v10, v11
  v_cvt_pk_bf16_f32 v42, v20, v21
  v_cvt_pk_bf16_f32 v43, v22, v23
  v_mfma_f32_16x16x32_bf16 v[212:215], a[164:167], a[180:183], v[212:215]
  ds_read_b128 a[132:135], v84 offset:3072
  buffer_load_dwordx4 v54, s[24:27], s1 offen offset:0 lds
  v_mfma_f32_4x4x4_16b_bf16 v[24:27], v[92:93], v[136:137], v[152:155]
  v_mfma_f32_4x4x4_16b_bf16 v[28:31], v[92:93], v[138:139], v[152:155]
  v_mfma_f32_16x16x32_bf16 v[220:223], a[200:203], a[180:183], v[220:223]
  buffer_load_dwordx4 v58, s[24:27], s1 offen offset:1024 lds
  s_add_u32 m0, s0, 0x7000
  v_mfma_f32_16x16x32_bf16 v[228:231], a[200:203], a[192:195], v[228:231]
  s_add_u32 s1, s48, 0
  v_cvt_pk_bf16_f32 v136, v24, v25
  v_cvt_pk_bf16_f32 v137, v26, v27
  v_mfma_f32_16x16x32_bf16 v[232:235], a[200:203], a[188:191], v[232:235]
  ds_read_b128 a[148:151], v81 offset:4096
  v_cvt_pk_bf16_f32 v138, v28, v29
  v_mfma_f32_16x16x32_bf16 v[236:239], a[200:203], a[152:155], v[236:239]
  s_waitcnt lgkmcnt(1)
  ds_read_b128 a[164:167], v83 offset:23552
  v_cvt_pk_bf16_f32 v139, v30, v31
  v_mfma_f32_16x16x32_bf16 v[104:107], a[168:171], a[184:187], v[104:107]
  ds_read_b64_tr_b16 a[212:213], v4 offset:13312
  v_mfma_f32_16x16x32_bf16 v[112:115], a[204:207], a[184:187], v[112:115]
  ds_read_b64_tr_b16 a[214:215], v71 offset:29696
  v_mfma_f32_16x16x32_bf16 v[116:119], a[196:199], a[184:187], v[116:119]
  ds_read_b64_tr_b16 a[216:217], v4 offset:54272
  v_mfma_f32_16x16x32_bf16 v[144:147], a[208:211], a[184:187], v[144:147]
  ds_read_b64_tr_b16 a[218:219], v72 offset:5120
  v_mfma_f32_4x4x4_16b_bf16 v[8:11], v[92:93], v[196:197], v[16:19]
  v_mfma_f32_4x4x4_16b_bf16 v[20:23], v[92:93], v[198:199], v[16:19]
  v_mfma_f32_16x16x32_bf16 v[148:151], a[208:211], a[132:135], v[148:151]
  v_mfma_f32_16x16x32_bf16 v[156:159], a[196:199], a[132:135], v[156:159]
  s_nop 1
  v_cvt_pk_bf16_f32 v196, v8, v9
  v_cvt_pk_bf16_f32 v197, v10, v11
  v_mfma_f32_16x16x32_bf16 v[160:163], a[204:207], a[132:135], v[160:163]
  s_waitcnt vmcnt(12) lgkmcnt(0)
  s_barrier
  v_mfma_f32_16x16x32_bf16 v[172:175], a[168:171], a[132:135], v[172:175]
  ds_read_b128 a[184:187], v75 offset:8192
  v_cvt_pk_bf16_f32 v198, v20, v21
  v_mfma_f32_16x16x32_bf16 v[180:183], a[148:151], a[164:167], v[180:183]
  ds_read_b128 a[200:203], v78 offset:14336
  v_cvt_pk_bf16_f32 v199, v22, v23
  v_mfma_f32_16x16x32_bf16 v[184:187], a[212:215], a[168:171], v[184:187]
  ds_read_b128 a[220:223], v75 offset:10240
  v_mfma_f32_16x16x32_bf16 v[200:203], a[212:215], a[204:207], v[200:203]
  ds_read_b128 a[224:227], v76 offset:8192
  v_mfma_f32_16x16x32_bf16 v[208:211], a[212:215], a[196:199], v[208:211]
  ds_read_b128 a[132:135], v76 offset:10240
  v_mfma_f32_4x4x4_16b_bf16 v[8:11], v[92:93], v[224:225], v[96:99]
  ds_read_b128 a[228:231], v78 offset:15360
  v_mfma_f32_4x4x4_16b_bf16 v[24:27], v[92:93], v[226:227], v[96:99]
  ds_write_b128 v86, v[40:43] offset:0
  v_mfma_f32_16x16x32_bf16 v[212:215], a[212:215], a[208:211], v[212:215]
  buffer_load_dwordx4 v63, s[24:27], s1 offen offset:0 lds
  v_mfma_f32_16x16x32_bf16 v[220:223], a[216:219], a[208:211], v[220:223]
  ds_write_b128 v87, v[136:139] offset:0
  v_mfma_f32_16x16x32_bf16 v[228:231], a[216:219], a[196:199], v[228:231]
  ds_write_b128 v88, v[196:199] offset:0
  v_mfma_f32_16x16x32_bf16 v[232:235], a[216:219], a[204:207], v[232:235]
  ds_read_b128 a[148:151], v74 offset:8192
  buffer_load_dwordx4 v56, s[24:27], s1 offen offset:1024 lds
  v_mfma_f32_16x16x32_bf16 v[236:239], a[216:219], a[168:171], v[236:239]
  s_waitcnt lgkmcnt(4)
  ds_read_b128 a[164:167], v2 offset:32768
  v_cvt_pk_bf16_f32 v224, v8, v9
  v_mfma_f32_16x16x32_bf16 v[104:107], a[184:187], a[200:203], v[104:107]
  ds_read_b64_tr_b16 a[212:213], v4 offset:16384
  v_cvt_pk_bf16_f32 v225, v10, v11
  v_mfma_f32_16x16x32_bf16 v[112:115], a[220:223], a[200:203], v[112:115]
  ds_read_b64_tr_b16 a[214:215], v71 offset:32768
  v_cvt_pk_bf16_f32 v226, v24, v25
  v_cvt_pk_bf16_f32 v227, v26, v27
  v_mfma_f32_16x16x32_bf16 v[116:119], a[224:227], a[200:203], v[116:119]
  ds_read_b64_tr_b16 a[216:217], v4 offset:57344
  buffer_load_dwordx4 v57, s[24:27], s1 offen offset:2048 lds
  v_mfma_f32_16x16x32_bf16 v[144:147], a[132:135], a[200:203], v[144:147]
  ds_read_b64_tr_b16 a[218:219], v72 offset:8192
  v_mfma_f32_16x16x32_bf16 v[148:151], a[132:135], a[228:231], v[148:151]
  ds_write_b128 v89, v[224:227] offset:0
  v_mfma_f32_4x4x4_16b_bf16 v[8:11], v[92:93], v[44:45], v[164:167]
  buffer_load_dwordx4 v64, s[24:27], s1 offen offset:3072 lds
  v_mfma_f32_4x4x4_16b_bf16 v[20:23], v[92:93], v[46:47], v[164:167]
  s_add_u32 m0, s0, 0x1000
  s_add_u32 s1, s48, 0x90000
  v_mfma_f32_16x16x32_bf16 v[156:159], a[224:227], a[228:231], v[156:159]
  v_mfma_f32_16x16x32_bf16 v[160:163], a[220:223], a[228:231], v[160:163]
  buffer_load_dwordx4 v63, s[24:27], s1 offen offset:0 lds
  v_cvt_pk_bf16_f32 v44, v8, v9
  v_mfma_f32_16x16x32_bf16 v[172:175], a[184:187], a[228:231], v[172:175]
  s_waitcnt lgkmcnt(1)
  ds_read_b128 a[200:203], v79 offset:8192
  v_cvt_pk_bf16_f32 v45, v10, v11
  v_mfma_f32_16x16x32_bf16 v[180:183], a[148:151], a[164:167], v[180:183]
  ds_read_b128 a[232:235], v84 offset:14336
  v_cvt_pk_bf16_f32 v46, v20, v21
  v_mfma_f32_16x16x32_bf16 v[184:187], a[212:215], a[184:187], v[184:187]
  ds_read_b128 a[236:239], v79 offset:10240
  buffer_load_dwordx4 v56, s[24:27], s1 offen offset:1024 lds
  v_mfma_f32_16x16x32_bf16 v[200:203], a[212:215], a[220:223], v[200:203]
  ds_read_b128 a[240:243], v80 offset:8192
  v_cvt_pk_bf16_f32 v47, v22, v23
  v_mfma_f32_16x16x32_bf16 v[208:211], a[212:215], a[224:227], v[208:211]
  ds_read_b128 a[228:231], v80 offset:10240
  v_mfma_f32_16x16x32_bf16 v[212:215], a[212:215], a[132:135], v[212:215]
  ds_read_b128 a[148:151], v84 offset:15360
  buffer_load_dwordx4 v57, s[24:27], s1 offen offset:2048 lds
  v_mfma_f32_4x4x4_16b_bf16 v[8:11], v[92:93], v[140:141], v[152:155]
  v_mfma_f32_4x4x4_16b_bf16 v[24:27], v[92:93], v[142:143], v[152:155]
  v_mfma_f32_16x16x32_bf16 v[220:223], a[216:219], a[132:135], v[220:223]
  buffer_load_dwordx4 v64, s[24:27], s1 offen offset:3072 lds
  v_mfma_f32_16x16x32_bf16 v[228:231], a[216:219], a[224:227], v[228:231]
  s_nop 0
  v_cvt_pk_bf16_f32 v140, v8, v9
  v_cvt_pk_bf16_f32 v141, v10, v11
  v_mfma_f32_16x16x32_bf16 v[232:235], a[216:219], a[220:223], v[232:235]
  ds_read_b128 a[164:167], v81 offset:8192
  v_cvt_pk_bf16_f32 v142, v24, v25
  v_mfma_f32_16x16x32_bf16 v[236:239], a[216:219], a[184:187], v[236:239]
  s_waitcnt lgkmcnt(1)
  ds_read_b128 a[212:215], v82 offset:32768
  v_cvt_pk_bf16_f32 v143, v26, v27
  v_mfma_f32_16x16x32_bf16 v[104:107], a[200:203], a[232:235], v[104:107]
  ds_read_b64_tr_b16 a[244:245], v4 offset:17408
  v_mfma_f32_16x16x32_bf16 v[112:115], a[236:239], a[232:235], v[112:115]
  ds_read_b64_tr_b16 a[246:247], v71 offset:33792
  v_mfma_f32_16x16x32_bf16 v[116:119], a[240:243], a[232:235], v[116:119]
  ds_read_b64_tr_b16 a[248:249], v4 offset:58368
  v_mfma_f32_16x16x32_bf16 v[144:147], a[228:231], a[232:235], v[144:147]
  ds_read_b64_tr_b16 a[250:251], v72 offset:9216
  v_mfma_f32_4x4x4_16b_bf16 v[8:11], v[92:93], v[12:13], v[16:19]
  v_mfma_f32_4x4x4_16b_bf16 v[20:23], v[92:93], v[14:15], v[16:19]
  v_mfma_f32_16x16x32_bf16 v[148:151], a[228:231], a[148:151], v[148:151]
  v_mfma_f32_16x16x32_bf16 v[156:159], a[240:243], a[148:151], v[156:159]
  s_nop 1
  v_cvt_pk_bf16_f32 v12, v8, v9
  v_cvt_pk_bf16_f32 v13, v10, v11
  v_mfma_f32_16x16x32_bf16 v[160:163], a[236:239], a[148:151], v[160:163]
  s_waitcnt vmcnt(13) lgkmcnt(0)
  s_barrier
  v_mfma_f32_16x16x32_bf16 v[172:175], a[200:203], a[148:151], v[172:175]
  s_add_u32 m0, s0, 0x3000
  ds_read_b128 v[24:27], v75 offset:0
  v_mfma_f32_16x16x32_bf16 v[180:183], a[164:167], a[212:215], v[180:183]
  s_add_u32 s1, s48, 0x120000
  ds_read_b128 a[216:219], v78 offset:18432
  v_cvt_pk_bf16_f32 v14, v20, v21
  v_mfma_f32_16x16x32_bf16 v[184:187], a[244:247], a[200:203], v[184:187]
  ds_read_b128 v[8:11], v75 offset:2048
  v_cvt_pk_bf16_f32 v15, v22, v23
  v_mfma_f32_16x16x32_bf16 v[200:203], a[244:247], a[236:239], v[200:203]
  ds_read_b128 v[16:19], v76 offset:0
  v_mfma_f32_16x16x32_bf16 v[208:211], a[244:247], a[240:243], v[208:211]
  ds_read_b128 v[28:31], v76 offset:2048
  v_mfma_f32_4x4x4_16b_bf16 v[32:35], v[92:93], v[100:101], v[96:99]
  ds_read_b128 a[148:151], v78 offset:19456
  v_mfma_f32_4x4x4_16b_bf16 v[36:39], v[92:93], v[102:103], v[96:99]
  buffer_load_dwordx4 v63, s[24:27], s1 offen offset:0 lds
  ds_write_b128 v86, v[44:47] offset:8192
  v_mfma_f32_16x16x32_bf16 v[212:215], a[244:247], a[228:231], v[212:215]
  ds_write_b128 v87, v[140:143] offset:8192
  v_mfma_f32_16x16x32_bf16 v[220:223], a[248:251], a[228:231], v[220:223]
  ds_read_b128 a[164:167], v74 offset:0
  v_cvt_pk_bf16_f32 v100, v32, v33
  v_mfma_f32_16x16x32_bf16 v[228:231], a[248:251], a[240:243], v[228:231]
  ds_read_b128 a[212:215], v77 offset:32768
  buffer_load_dwordx4 v56, s[24:27], s1 offen offset:1024 lds
  v_mfma_f32_16x16x32_bf16 v[232:235], a[248:251], a[236:239], v[232:235]
  ds_read_b64_tr_b16 a[232:233], v4 offset:20480
  v_cvt_pk_bf16_f32 v101, v34, v35
  v_mfma_f32_16x16x32_bf16 v[236:239], a[248:251], a[200:203], v[236:239]
  s_waitcnt lgkmcnt(5)
  ds_read_b64_tr_b16 a[234:235], v71 offset:36864
  v_cvt_pk_bf16_f32 v102, v36, v37
  v_mfma_f32_16x16x32_bf16 v[104:107], v[24:27], a[216:219], v[104:107]
  ds_read_b64_tr_b16 a[244:245], v4 offset:61440
  v_cvt_pk_bf16_f32 v103, v38, v39
  v_mfma_f32_16x16x32_bf16 v[112:115], v[8:11], a[216:219], v[112:115]
  ds_read_b64_tr_b16 a[246:247], v72 offset:12288
  v_mfma_f32_16x16x32_bf16 v[116:119], v[16:19], a[216:219], v[116:119]
  buffer_load_dwordx4 v57, s[24:27], s1 offen offset:2048 lds
  ds_write_b128 v88, v[12:15] offset:8192
  v_mfma_f32_16x16x32_bf16 v[144:147], v[28:31], a[216:219], v[144:147]
  ds_write_b128 v89, v[100:103] offset:8192
  v_mfma_f32_16x16x32_bf16 v[148:151], v[28:31], a[148:151], v[148:151]
  v_mfma_f32_16x16x32_bf16 v[156:159], v[16:19], a[148:151], v[156:159]
  ds_read_b128 v[20:23], v79 offset:0
  buffer_load_dwordx4 v64, s[24:27], s1 offen offset:3072 lds
  v_mfma_f32_16x16x32_bf16 v[160:163], v[8:11], a[148:151], v[160:163]
  ds_read_b128 a[248:251], v84 offset:18432
  v_mfma_f32_16x16x32_bf16 v[172:175], v[24:27], a[148:151], v[172:175]
  s_waitcnt lgkmcnt(4)
  ds_read_b128 v[32:35], v79 offset:2048
  v_mfma_f32_16x16x32_bf16 v[180:183], a[164:167], a[212:215], v[180:183]
  s_lshl1_add_u32 s1, s41, s43
  s_mul_i32 s1, s1, 0x120
  ds_read_b128 v[12:15], v80 offset:0
  v_mfma_f32_16x16x32_bf16 v[184:187], a[232:235], v[24:27], v[184:187]
  s_mul_i32 s47, s52, 9
  s_add_u32 s1, s1, s47
  ds_read_b128 v[36:39], v80 offset:2048
  v_mfma_f32_16x16x32_bf16 v[200:203], a[232:235], v[8:11], v[200:203]
  s_lshl1_add_u32 s1, s1, s42
  s_lshl_b32 s1, s1, 10
  ds_read_b128 a[148:151], v84 offset:19456
  v_mfma_f32_16x16x32_bf16 v[208:211], a[232:235], v[16:19], v[208:211]
  s_add_u32 s1, s1, 0x1b04000
  s_lshl1_add_u32 s47, s67, s1
  ds_read_b128 a[164:167], v81 offset:0
  v_mfma_f32_16x16x32_bf16 v[212:215], a[232:235], v[28:31], v[212:215]
  s_add_u32 s50, s1, 0x48000
  ds_read_b128 a[212:215], v83 offset:32768
  v_mfma_f32_16x16x32_bf16 v[220:223], a[244:247], v[28:31], v[220:223]
  ds_read_b64_tr_b16 a[216:217], v4 offset:21504
  v_mfma_f32_16x16x32_bf16 v[228:231], a[244:247], v[16:19], v[228:231]
  ds_read_b64_tr_b16 a[218:219], v71 offset:37888
  v_mfma_f32_16x16x32_bf16 v[232:235], a[244:247], v[8:11], v[232:235]
  ds_read_b64_tr_b16 a[252:253], v4 offset:62464
  v_mfma_f32_16x16x32_bf16 v[236:239], a[244:247], v[24:27], v[236:239]
  s_waitcnt lgkmcnt(5)
  ds_read_b64_tr_b16 a[254:255], v72 offset:13312
  v_mfma_f32_16x16x32_bf16 v[104:107], v[20:23], a[248:251], v[104:107]
  v_mfma_f32_16x16x32_bf16 v[112:115], v[32:35], a[248:251], v[112:115]
  v_mfma_f32_16x16x32_bf16 v[116:119], v[12:15], a[248:251], v[116:119]
  v_mfma_f32_16x16x32_bf16 v[144:147], v[36:39], a[248:251], v[144:147]
  v_mfma_f32_16x16x32_bf16 v[148:151], v[36:39], a[148:151], v[148:151]
  s_waitcnt vmcnt(12) lgkmcnt(0)
  s_barrier
  v_mfma_f32_16x16x32_bf16 v[156:159], v[12:15], a[148:151], v[156:159]
  s_add_u32 m0, s0, 0
  s_add_u32 s52, s48, 0x1b0000
  ds_read_b128 v[40:43], v75 offset:8192
  v_mfma_f32_16x16x32_bf16 v[160:163], v[32:35], a[148:151], v[160:163]
  ds_read_b128 a[232:235], v78 offset:24576
  buffer_atomic_add v49, v0, s[32:35], s57 offen sc1
  v_mfma_f32_16x16x32_bf16 v[172:175], v[20:23], a[148:151], v[172:175]
  ds_read_b128 v[44:47], v75 offset:10240
  v_mfma_f32_16x16x32_bf16 v[180:183], a[164:167], a[212:215], v[180:183]
  ds_read_b128 v[88:91], v76 offset:8192
  buffer_load_dwordx4 v63, s[24:27], s52 offen offset:0 lds
  v_mfma_f32_16x16x32_bf16 v[184:187], a[216:219], v[20:23], v[184:187]
  ds_read_b128 v[92:95], v76 offset:10240
  v_mfma_f32_16x16x32_bf16 v[200:203], a[216:219], v[32:35], v[200:203]
  ds_read_b128 a[244:247], v78 offset:25600
  v_mfma_f32_16x16x32_bf16 v[208:211], a[216:219], v[12:15], v[208:211]
  s_lshl_b32 s56, s43, 8
  buffer_load_dwordx4 v56, s[24:27], s52 offen offset:1024 lds
  v_lshl_add_u32 v6, v5, 6, s56
  v_mfma_f32_16x16x32_bf16 v[212:215], a[216:219], v[36:39], v[212:215]
  s_lshl4_add_u32 s56, s44, s3
  s_lshl_b32 s56, s56, 4
  v_lshl_add_u32 v49, v5, 6, s56
  v_mfma_f32_16x16x32_bf16 v[220:223], a[252:255], v[36:39], v[220:223]
  ds_read_b128 a[148:151], v74 offset:8192
  v_lshl_add_u32 v83, v48, 3, s0
  v_mfma_f32_16x16x32_bf16 v[228:231], a[252:255], v[12:15], v[228:231]
  ds_read_b128 a[164:167], v2 offset:22528
  buffer_load_dwordx4 v57, s[24:27], s52 offen offset:2048 lds
  v_mfma_f32_16x16x32_bf16 v[232:235], a[252:255], v[32:35], v[232:235]
  ds_read_b64_tr_b16 a[212:213], v4 offset:26624
  v_add_u32 v2, 0x9a00, v62
  v_mfma_f32_16x16x32_bf16 v[236:239], a[252:255], v[20:23], v[236:239]
  s_waitcnt lgkmcnt(3)
  ds_read_b64_tr_b16 a[214:215], v71 offset:43008
  v_add_u32 v58, 0x1da00, v62
  v_mfma_f32_16x16x32_bf16 v[104:107], v[40:43], a[232:235], v[104:107]
  ds_read_b64_tr_b16 a[216:217], v71 offset:2048
  buffer_load_dwordx4 v64, s[24:27], s52 offen offset:3072 lds
  v_mfma_f32_16x16x32_bf16 v[112:115], v[44:47], a[232:235], v[112:115]
  s_add_u32 m0, s0, 0x4000
  s_add_u32 s52, s48, 0x240000
  ds_read_b64_tr_b16 a[218:219], v72 offset:18432
  v_mfma_f32_16x16x32_bf16 v[116:119], v[88:91], a[232:235], v[116:119]
  ds_read_b128 v[96:99], v6 offset:40448
  v_mfma_f32_16x16x32_bf16 v[144:147], v[92:95], a[232:235], v[144:147]
  ds_read_b128 v[100:103], v79 offset:8192
  buffer_load_dwordx4 v63, s[24:27], s52 offen offset:0 lds
  v_mfma_f32_16x16x32_bf16 v[148:151], v[92:95], a[244:247], v[148:151]
  ds_read_b128 a[248:251], v84 offset:24576
  v_mfma_f32_16x16x32_bf16 v[156:159], v[88:91], a[244:247], v[156:159]
  s_bfe_u32 s56, s2, 0x10002
  s_mul_i32 s56, s56, 0x480
  ds_read_b128 v[108:111], v79 offset:10240
  v_mfma_f32_16x16x32_bf16 v[160:163], v[44:47], a[244:247], v[160:163]
  s_add_u32 s56, s54, s56
  ds_read_b128 v[120:123], v80 offset:8192
  buffer_load_dwordx4 v56, s[24:27], s52 offen offset:1024 lds
  v_mfma_f32_16x16x32_bf16 v[172:175], v[40:43], a[244:247], v[172:175]
  s_waitcnt lgkmcnt(5)
  ds_read_b128 v[124:127], v80 offset:10240
  v_mfma_f32_16x16x32_bf16 v[180:183], a[148:151], a[164:167], v[180:183]
  ds_read_b128 a[232:235], v84 offset:25600
  v_mfma_f32_16x16x32_bf16 v[184:187], a[212:215], v[40:43], v[184:187]
  ds_read_b128 a[252:255], v81 offset:8192
  buffer_load_dwordx4 v57, s[24:27], s52 offen offset:2048 lds
  v_mfma_f32_16x16x32_bf16 v[200:203], a[212:215], v[44:47], v[200:203]
  ds_read_b128 a[148:151], v82 offset:22528
  v_mfma_f32_16x16x32_bf16 v[208:211], a[212:215], v[88:91], v[208:211]
  ds_read_b64_tr_b16 a[164:165], v4 offset:27648
  v_mfma_f32_16x16x32_bf16 v[212:215], a[212:215], v[92:95], v[212:215]
  ds_read_b64_tr_b16 a[166:167], v71 offset:44032
  buffer_load_dwordx4 v64, s[24:27], s52 offen offset:3072 lds
  v_mfma_f32_16x16x32_bf16 v[220:223], a[216:219], v[92:95], v[220:223]
  ds_read_b64_tr_b16 a[244:245], v71 offset:3072
  v_mfma_f32_16x16x32_bf16 v[228:231], a[216:219], v[88:91], v[228:231]
  ds_read_b64_tr_b16 a[246:247], v72 offset:19456
  v_mfma_f32_16x16x32_bf16 v[232:235], a[216:219], v[44:47], v[232:235]
  ds_read_b128 v[76:79], v6 offset:40464
  v_mfma_f32_16x16x32_bf16 v[236:239], a[216:219], v[40:43], v[236:239]
  s_waitcnt lgkmcnt(7)
  ds_read_b128 v[128:131], v6 offset:40480
  v_mfma_f32_16x16x32_bf16 v[104:107], v[100:103], a[248:251], v[104:107]
  ds_read_b128 v[132:135], v6 offset:40496
  v_mfma_f32_16x16x32_bf16 v[112:115], v[108:111], a[248:251], v[112:115]
  ds_read_b128 v[136:139], v49 offset:40448
  v_mfma_f32_16x16x32_bf16 v[116:119], v[120:123], a[248:251], v[116:119]
  s_waitcnt vmcnt(13) lgkmcnt(4)
  s_barrier
  v_mfma_f32_16x16x32_bf16 v[144:147], v[124:127], a[248:251], v[144:147]
  s_add_u32 m0, s0, 0x2000
  s_add_u32 s52, s48, 0x2d0000
  ds_read_b64_tr_b16 a[212:213], v52 offset:28672
  v_mfma_f32_16x16x32_bf16 v[172:175], v[100:103], a[232:235], v[172:175]
  ds_read_b64_tr_b16 a[214:215], v51 offset:45056
  buffer_load_dwordx4 v63, s[24:27], s52 offen offset:0 lds
  v_mfma_f32_16x16x32_bf16 v[160:163], v[108:111], a[232:235], v[160:163]
  ds_read_b64_tr_b16 a[216:217], v51 offset:4096
  v_mfma_f32_16x16x32_bf16 v[156:159], v[120:123], a[232:235], v[156:159]
  ds_read_b64_tr_b16 a[218:219], v68 offset:20480
  v_mfma_f32_16x16x32_bf16 v[148:151], v[124:127], a[232:235], v[148:151]
  ds_read_b64_tr_b16 a[248:249], v52 offset:30720
  buffer_load_dwordx4 v56, s[24:27], s52 offen offset:1024 lds
  v_mfma_f32_16x16x32_bf16 v[180:183], a[252:255], a[148:151], v[180:183]
  ds_read_b64_tr_b16 a[250:251], v51 offset:47104
  v_mfma_f32_16x16x32_bf16 v[184:187], a[164:167], v[100:103], v[184:187]
  ds_read_b64_tr_b16 a[148:149], v51 offset:6144
  buffer_load_dword v1, v50, s[24:27], s56 offen offset:128
  v_mfma_f32_16x16x32_bf16 v[200:203], a[164:167], v[108:111], v[200:203]
  ds_read_b64_tr_b16 a[150:151], v68 offset:22528
  v_mfma_f32_16x16x32_bf16 v[208:211], a[164:167], v[120:123], v[208:211]
  buffer_load_dword v1, v50, s[24:27], s56 offen offset:768
  ds_read_b64 v[60:61], v83 offset:37376
  v_mfma_f32_16x16x32_bf16 v[212:215], a[164:167], v[124:127], v[212:215]
  ds_read_b64 v[54:55], v83 offset:37504
  v_mfma_f32_16x16x32_bf16 v[236:239], a[244:247], v[100:103], v[236:239]
  s_waitcnt lgkmcnt(10)
  ds_read_b64 v[80:81], v83 offset:37632
  v_mul_f32 v180, v180, v136
  v_mfma_f32_16x16x32_bf16 v[232:235], a[244:247], v[108:111], v[232:235]
  v_mul_f32 v181, v181, v137
  v_mul_f32 v182, v182, v138
  v_mfma_f32_16x16x32_bf16 v[228:231], a[244:247], v[120:123], v[228:231]
  v_mul_f32 v183, v183, v139
  v_mfma_f32_16x16x32_bf16 v[220:223], a[244:247], v[124:127], v[220:223]
  s_waitcnt lgkmcnt(3)
  buffer_load_dwordx4 v57, s[24:27], s52 offen offset:2048 lds
  v_mul_f32 v184, v184, v236
  v_mfma_f32_16x16x32_bf16 v[72:75], a[212:215], a[0:3], 0
  v_mul_f32 v185, v185, v237
  v_mul_f32 v186, v186, v238
  v_mfma_f32_16x16x32_bf16 v[140:143], a[212:215], a[8:11], 0
  v_mul_f32 v187, v187, v239
  v_cvt_pk_bf16_f32 v152, v184, v185
  v_mfma_f32_16x16x32_bf16 v[164:167], a[212:215], a[12:15], 0
  ds_read_b64_tr_b16 a[164:165], v52 offset:4096
  v_cvt_pk_bf16_f32 v153, v186, v187
  v_mfma_f32_16x16x32_bf16 v[136:139], a[212:215], a[16:19], 0
  ds_read_b64_tr_b16 a[166:167], v51 offset:20480
  v_mul_f32 v200, v200, v232
  v_mfma_f32_16x16x32_bf16 v[168:171], a[216:219], a[0:3], 0
  ds_read_b64_tr_b16 a[232:233], v52 offset:45056
  buffer_load_dwordx4 v64, s[24:27], s52 offen offset:3072 lds
  v_mfma_f32_16x16x32_bf16 v[176:179], a[216:219], a[8:11], 0
  s_add_u32 m0, s0, 0x5000
  s_add_u32 s52, s48, 0x360000
  ds_read_b64_tr_b16 a[234:235], v51 offset:61440
  v_mfma_f32_16x16x32_bf16 v[188:191], a[216:219], a[12:15], 0
  ds_read_b64_tr_b16 a[244:245], v67 offset:28672
  v_mul_f32 v201, v201, v233
  v_mfma_f32_16x16x32_bf16 v[184:187], a[216:219], a[16:19], 0
  ds_read_b64_tr_b16 a[246:247], v69 offset:45056
  v_mul_f32 v202, v202, v234
  v_mfma_f32_16x16x32_bf16 v[72:75], a[248:251], a[40:43], v[72:75]
  ds_read_b64_tr_b16 a[212:213], v69 offset:4096
  buffer_load_dwordx4 v63, s[24:27], s52 offen offset:0 lds
  v_mfma_f32_16x16x32_bf16 v[140:143], a[248:251], a[4:7], v[140:143]
  ds_read_b64_tr_b16 a[214:215], v70 offset:20480
  v_mul_f32 v203, v203, v235
  v_mfma_f32_16x16x32_bf16 v[164:167], a[248:251], a[48:51], v[164:167]
  v_cvt_pk_bf16_f32 v154, v200, v201
  v_cvt_pk_bf16_f32 v155, v202, v203
  v_mfma_f32_16x16x32_bf16 v[136:139], a[248:251], a[52:55], v[136:139]
  v_mul_f32 v208, v208, v228
  v_mul_f32 v209, v209, v229
  v_mfma_f32_16x16x32_bf16 v[184:187], a[148:151], a[52:55], v[184:187]
  v_mul_f32 v210, v210, v230
  v_mul_f32 v211, v211, v231
  v_mfma_f32_16x16x32_bf16 v[188:191], a[148:151], a[48:51], v[188:191]
  buffer_load_dwordx4 v56, s[24:27], s52 offen offset:1024 lds
  v_cvt_pk_bf16_f32 v192, v208, v209
  v_mfma_f32_16x16x32_bf16 v[176:179], a[148:151], a[4:7], v[176:179]
  v_cvt_pk_bf16_f32 v193, v210, v211
  v_mul_f32 v212, v212, v220
  v_mfma_f32_16x16x32_bf16 v[168:171], a[148:151], a[40:43], v[168:171]
  s_waitcnt lgkmcnt(0)
  buffer_store_dwordx4 v[152:155], v62, s[36:39], s1 offen offset:0 sc1
  v_mfma_f32_16x16x32_bf16 v[72:75], a[164:167], a[32:35], v[72:75]
  v_mul_f32 v213, v213, v221
  v_mul_f32 v214, v214, v222
  v_mfma_f32_16x16x32_bf16 v[140:143], a[164:167], a[44:47], v[140:143]
  v_mul_f32 v215, v215, v223
  v_cvt_pk_bf16_f32 v194, v212, v213
  v_mfma_f32_16x16x32_bf16 v[164:167], a[164:167], a[64:67], v[164:167]
  ds_read_b64_tr_b16 a[216:217], v67 offset:30720
  v_cvt_pk_bf16_f32 v195, v214, v215
  v_mfma_f32_16x16x32_bf16 v[136:139], a[164:167], a[68:71], v[136:139]
  ds_read_b64_tr_b16 a[218:219], v69 offset:47104
  v_mfma_f32_16x16x32_bf16 v[184:187], a[232:235], a[68:71], v[184:187]
  ds_read_b64_tr_b16 a[148:149], v69 offset:6144
  buffer_store_dwordx4 v[192:195], v62, s[36:39], s50 offen offset:0 sc1
  v_mfma_f32_16x16x32_bf16 v[188:191], a[232:235], a[64:67], v[188:191]
  ds_read_b64_tr_b16 a[150:151], v70 offset:22528
  v_mfma_f32_16x16x32_bf16 v[176:179], a[232:235], a[44:47], v[176:179]
  ds_read_b64_tr_b16 a[248:249], v67 offset:4096
  v_mfma_f32_16x16x32_bf16 v[168:171], a[232:235], a[32:35], v[168:171]
  ds_read_b64_tr_b16 a[250:251], v69 offset:20480
  v_mfma_f32_16x16x32_bf16 v[152:155], a[244:247], a[0:3], 0
  ds_read_b64_tr_b16 a[164:165], v67 offset:45056
  v_mfma_f32_16x16x32_bf16 v[196:199], a[244:247], a[8:11], 0
  ds_read_b64_tr_b16 a[166:167], v69 offset:61440
  v_mfma_f32_16x16x32_bf16 v[200:203], a[244:247], a[12:15], 0
  ds_write_b128 v85, v[180:183] offset:39424
  v_mfma_f32_16x16x32_bf16 v[192:195], a[244:247], a[16:19], 0
  v_mul_f32 v104, v104, v96
  v_mul_f32 v105, v105, v97
  v_mfma_f32_16x16x32_bf16 v[204:207], a[212:215], a[0:3], 0
  v_mul_f32 v106, v106, v98
  v_mul_f32 v107, v107, v99
  v_mfma_f32_16x16x32_bf16 v[208:211], a[212:215], a[8:11], 0
  v_mul_f32 v112, v112, v76
  v_mul_f32 v113, v113, v77
  v_mfma_f32_16x16x32_bf16 v[212:215], a[212:215], a[12:15], 0
  v_mul_f32 v114, v114, v78
  v_mul_f32 v115, v115, v79
  v_mfma_f32_16x16x32_bf16 v[84:87], a[212:215], a[16:19], 0
  s_waitcnt lgkmcnt(1)
  v_mul_f32 v116, v116, v128
  v_mul_f32 v117, v117, v129
  v_mfma_f32_16x16x32_bf16 v[152:155], a[216:219], a[40:43], v[152:155]
  v_mul_f32 v118, v118, v130
  v_mul_f32 v119, v119, v131
  v_mfma_f32_16x16x32_bf16 v[196:199], a[216:219], a[4:7], v[196:199]
  v_mul_f32 v144, v144, v132
  v_mul_f32 v145, v145, v133
  v_mfma_f32_16x16x32_bf16 v[200:203], a[216:219], a[48:51], v[200:203]
  ds_read_b64_tr_b16 a[232:233], v52 offset:6144
  v_mul_f32 v146, v146, v134
  v_mfma_f32_16x16x32_bf16 v[192:195], a[216:219], a[52:55], v[192:195]
  ds_read_b64_tr_b16 a[234:235], v51 offset:22528
  v_mul_f32 v147, v147, v135
  v_mfma_f32_16x16x32_bf16 v[84:87], a[148:151], a[52:55], v[84:87]
  ds_read_b64_tr_b16 a[212:213], v52 offset:47104
  v_mul_f32 v172, v172, v96
  v_mfma_f32_16x16x32_bf16 v[212:215], a[148:151], a[48:51], v[212:215]
  ds_read_b64_tr_b16 a[214:215], v51 offset:63488
  v_mul_f32 v173, v173, v97
  v_mfma_f32_16x16x32_bf16 v[208:211], a[148:151], a[4:7], v[208:211]
  ds_read_b64_tr_b16 a[244:245], v67 offset:6144
  v_mul_f32 v174, v174, v98
  v_mfma_f32_16x16x32_bf16 v[204:207], a[148:151], a[40:43], v[204:207]
  ds_read_b64_tr_b16 a[246:247], v69 offset:22528
  v_mul_f32 v175, v175, v99
  v_mfma_f32_16x16x32_bf16 v[152:155], a[248:251], a[32:35], v[152:155]
  ds_read_b64_tr_b16 a[216:217], v67 offset:47104
  v_mul_f32 v160, v160, v76
  v_mfma_f32_16x16x32_bf16 v[196:199], a[248:251], a[44:47], v[196:199]
  ds_read_b64_tr_b16 a[218:219], v69 offset:63488
  v_mul_f32 v161, v161, v77
  v_mfma_f32_16x16x32_bf16 v[200:203], a[248:251], a[64:67], v[200:203]
  v_mul_f32 v162, v162, v78
  v_mul_f32 v163, v163, v79
  v_mfma_f32_16x16x32_bf16 v[192:195], a[248:251], a[68:71], v[192:195]
  v_mul_f32 v156, v156, v128
  v_mul_f32 v157, v157, v129
  v_mfma_f32_16x16x32_bf16 v[84:87], a[164:167], a[68:71], v[84:87]
  v_mul_f32 v158, v158, v130
  v_mul_f32 v159, v159, v131
  v_mfma_f32_16x16x32_bf16 v[212:215], a[164:167], a[64:67], v[212:215]
  v_mul_f32 v148, v148, v132
  v_mul_f32 v149, v149, v133
  v_mfma_f32_16x16x32_bf16 v[208:211], a[164:167], a[44:47], v[208:211]
  v_mul_f32 v150, v150, v134
  v_mul_f32 v151, v151, v135
  v_mfma_f32_16x16x32_bf16 v[204:207], a[164:167], a[32:35], v[204:207]
  s_waitcnt lgkmcnt(0)
  v_mfma_f32_16x16x32_bf16 v[72:75], a[232:235], a[36:39], v[72:75]
  v_mfma_f32_16x16x32_bf16 v[140:143], a[232:235], a[76:79], v[140:143]
  s_waitcnt vmcnt(14)
  s_barrier
  v_mfma_f32_16x16x32_bf16 v[164:167], a[232:235], a[80:83], v[164:167]
  ds_read_b64_tr_b16 a[148:149], v52 offset:12288
  v_mfma_f32_16x16x32_bf16 v[136:139], a[232:235], a[56:59], v[136:139]
  ds_read_b64_tr_b16 a[150:151], v51 offset:28672
  v_mfma_f32_16x16x32_bf16 v[184:187], a[212:215], a[56:59], v[184:187]
  ds_read_b64_tr_b16 a[248:249], v52 offset:53248
  v_mfma_f32_16x16x32_bf16 v[188:191], a[212:215], a[80:83], v[188:191]
  ds_read_b64_tr_b16 a[250:251], v68 offset:4096
  v_mfma_f32_16x16x32_bf16 v[176:179], a[212:215], a[76:79], v[176:179]
  ds_read_b64_tr_b16 a[164:165], v67 offset:12288
  v_mfma_f32_16x16x32_bf16 v[168:171], a[212:215], a[36:39], v[168:171]
  ds_read_b64_tr_b16 a[166:167], v69 offset:28672
  v_mfma_f32_16x16x32_bf16 v[152:155], a[244:247], a[36:39], v[152:155]
  ds_read_b64_tr_b16 a[252:253], v67 offset:53248
  v_mfma_f32_16x16x32_bf16 v[196:199], a[244:247], a[76:79], v[196:199]
  ds_read_b64_tr_b16 a[254:255], v70 offset:4096
  v_mfma_f32_16x16x32_bf16 v[200:203], a[244:247], a[80:83], v[200:203]
  ds_read_b128 v[76:79], v2 offset:0
  v_mfma_f32_16x16x32_bf16 v[192:195], a[244:247], a[56:59], v[192:195]
  ds_read_b128 v[96:99], v2 offset:40960
  v_mfma_f32_16x16x32_bf16 v[84:87], a[216:219], a[56:59], v[84:87]
  ds_read_b128 v[128:131], v58 offset:0
  v_mfma_f32_16x16x32_bf16 v[212:215], a[216:219], a[80:83], v[212:215]
  ds_read_b128 v[132:135], v58 offset:40960
  v_mfma_f32_16x16x32_bf16 v[208:211], a[216:219], a[76:79], v[208:211]
  ds_read_b64 v[58:59], v83 offset:36864
  v_mfma_f32_16x16x32_bf16 v[204:207], a[216:219], a[36:39], v[204:207]
  s_waitcnt lgkmcnt(5)
  ds_read_b64 v[180:181], v83 offset:36992
  v_mfma_f32_16x16x32_bf16 v[72:75], a[148:151], a[60:63], v[72:75]
  ds_read_b64 v[182:183], v83 offset:37120
  v_mfma_f32_16x16x32_bf16 v[140:143], a[148:151], a[92:95], v[140:143]
  ds_read_b64 v[216:217], v83 offset:37888
  v_mfma_f32_16x16x32_bf16 v[164:167], a[148:151], a[96:99], v[164:167]
  ds_read_b64_tr_b16 a[212:213], v52 offset:14336
  v_mfma_f32_16x16x32_bf16 v[136:139], a[148:151], a[20:23], v[136:139]
  ds_read_b64_tr_b16 a[214:215], v51 offset:30720
  v_mfma_f32_16x16x32_bf16 v[184:187], a[248:251], a[20:23], v[184:187]
  ds_read_b64_tr_b16 a[216:217], v52 offset:55296
  v_mfma_f32_16x16x32_bf16 v[188:191], a[248:251], a[96:99], v[188:191]
  ds_read_b64_tr_b16 a[218:219], v68 offset:6144
  v_mfma_f32_16x16x32_bf16 v[176:179], a[248:251], a[92:95], v[176:179]
  ds_read_b64_tr_b16 a[232:233], v67 offset:14336
  v_mfma_f32_16x16x32_bf16 v[168:171], a[248:251], a[60:63], v[168:171]
  ds_read_b64_tr_b16 a[234:235], v69 offset:30720
  v_mfma_f32_16x16x32_bf16 v[152:155], a[164:167], a[60:63], v[152:155]
  ds_read_b64_tr_b16 a[244:245], v67 offset:55296
  v_mfma_f32_16x16x32_bf16 v[196:199], a[164:167], a[92:95], v[196:199]
  ds_read_b64_tr_b16 a[246:247], v70 offset:6144
  v_mfma_f32_16x16x32_bf16 v[200:203], a[164:167], a[96:99], v[200:203]
  ds_read_b64 v[218:219], v83 offset:38016
  v_mfma_f32_16x16x32_bf16 v[192:195], a[164:167], a[20:23], v[192:195]
  ds_read_b64 v[220:221], v83 offset:38144
  v_fma_f32 v2, v60, v104, v105
  v_mfma_f32_16x16x32_bf16 v[84:87], a[252:255], a[20:23], v[84:87]
  s_waitcnt lgkmcnt(15)
  v_fma_f32 v49, v54, v172, v173
  v_fma_f32 v53, v80, v76, v77
  v_mfma_f32_16x16x32_bf16 v[212:215], a[252:255], a[96:99], v[212:215]
  buffer_load_dwordx4 v57, s[24:27], s52 offen offset:2048 lds
  v_fmac_f32_dpp v2, v104, -v61 row_ror:8 row_mask:0xf bank_mask:0xf
  v_mfma_f32_16x16x32_bf16 v[208:211], a[252:255], a[92:95], v[208:211]
  v_fmac_f32_dpp v49, v172, -v55 row_ror:8 row_mask:0xf bank_mask:0xf
  v_fmac_f32_dpp v53, v76, -v81 row_ror:8 row_mask:0xf bank_mask:0xf
  v_mfma_f32_16x16x32_bf16 v[204:207], a[252:255], a[60:63], v[204:207]
  s_waitcnt lgkmcnt(2)
  v_fma_f32 v71, v60, v2, v106
  v_fma_f32 v82, v54, v49, v174
  v_mfma_f32_16x16x32_bf16 v[72:75], a[212:215], a[72:75], v[72:75]
  buffer_load_dwordx4 v64, s[24:27], s52 offen offset:3072 lds
  s_add_u32 m0, s0, 0x6000
  v_mfma_f32_16x16x32_bf16 v[140:143], a[212:215], a[108:111], v[140:143]
  s_add_u32 s1, s48, 0x3f0000
  v_fma_f32 v4, v80, v53, v78
  v_fmac_f32_dpp v71, v2, -v61 row_ror:8 row_mask:0xf bank_mask:0xf
  v_mfma_f32_16x16x32_bf16 v[164:167], a[212:215], a[112:115], v[164:167]
  ds_read_b64_tr_b16 a[148:149], v52 offset:0
  v_fmac_f32_dpp v82, v49, -v55 row_ror:8 row_mask:0xf bank_mask:0xf
  v_mfma_f32_16x16x32_bf16 v[136:139], a[212:215], a[100:103], v[136:139]
  ds_read_b64_tr_b16 a[150:151], v51 offset:16384
  buffer_load_dwordx4 v63, s[24:27], s1 offen offset:0 lds
  v_mfma_f32_16x16x32_bf16 v[184:187], a[216:219], a[100:103], v[184:187]
  ds_read_b64_tr_b16 a[164:165], v52 offset:40960
  v_fmac_f32_dpp v4, v53, -v81 row_ror:8 row_mask:0xf bank_mask:0xf
  v_mfma_f32_16x16x32_bf16 v[188:191], a[216:219], a[112:115], v[188:191]
  ds_read_b64_tr_b16 a[166:167], v51 offset:57344
  v_fma_f32 v2, v60, v71, v107
  v_mfma_f32_16x16x32_bf16 v[176:179], a[216:219], a[108:111], v[176:179]
  ds_read_b64_tr_b16 a[248:249], v67 offset:0
  buffer_load_dwordx4 v56, s[24:27], s1 offen offset:1024 lds
  v_mfma_f32_16x16x32_bf16 v[168:171], a[216:219], a[72:75], v[168:171]
  ds_read_b64_tr_b16 a[250:251], v69 offset:16384
  v_fma_f32 v6, v54, v82, v175
  v_mfma_f32_16x16x32_bf16 v[152:155], a[232:235], a[72:75], v[152:155]
  ds_read_b64_tr_b16 a[212:213], v67 offset:40960
  v_fma_f32 v49, v80, v4, v79
  v_mfma_f32_16x16x32_bf16 v[196:199], a[232:235], a[108:111], v[196:199]
  ds_read_b64_tr_b16 a[214:215], v69 offset:57344
  buffer_load_dwordx4 v57, s[24:27], s1 offen offset:2048 lds
  v_mfma_f32_16x16x32_bf16 v[200:203], a[232:235], a[112:115], v[200:203]
  v_fmac_f32_dpp v2, v71, -v61 row_ror:8 row_mask:0xf bank_mask:0xf
  v_fmac_f32_dpp v6, v82, -v55 row_ror:8 row_mask:0xf bank_mask:0xf
  v_mfma_f32_16x16x32_bf16 v[192:195], a[232:235], a[100:103], v[192:195]
  v_fmac_f32_dpp v49, v4, -v81 row_ror:8 row_mask:0xf bank_mask:0xf
  v_fma_f32 v4, v60, v2, v112
  v_mfma_f32_16x16x32_bf16 v[84:87], a[244:247], a[100:103], v[84:87]
  buffer_load_dwordx4 v64, s[24:27], s1 offen offset:3072 lds
  s_add_u32 m0, s0, 0x1000
  v_mfma_f32_16x16x32_bf16 v[212:215], a[244:247], a[112:115], v[212:215]
  s_add_u32 s1, s48, 0x480000
  v_fma_f32 v53, v54, v6, v160
  v_fma_f32 v71, v80, v49, v96
  v_mfma_f32_16x16x32_bf16 v[208:211], a[244:247], a[108:111], v[208:211]
  v_fmac_f32_dpp v4, v2, -v61 row_ror:8 row_mask:0xf bank_mask:0xf
  v_fmac_f32_dpp v53, v6, -v55 row_ror:8 row_mask:0xf bank_mask:0xf
  v_mfma_f32_16x16x32_bf16 v[204:207], a[244:247], a[72:75], v[204:207]
  s_waitcnt lgkmcnt(0)
  buffer_load_dwordx4 v63, s[24:27], s1 offen offset:0 lds
  v_fmac_f32_dpp v71, v49, -v81 row_ror:8 row_mask:0xf bank_mask:0xf
  v_mfma_f32_16x16x32_bf16 v[72:75], a[148:151], a[88:91], v[72:75]
  s_bfe_u32 s50, s2, 0x10002
  s_mul_i32 s50, s50, 0x80
  s_add_u32 s50, s54, s50
  v_mfma_f32_16x16x32_bf16 v[140:143], a[148:151], a[124:127], v[140:143]
  v_fma_f32 v2, v60, v4, v113
  v_fma_f32 v6, v54, v53, v161
  v_mfma_f32_16x16x32_bf16 v[164:167], a[148:151], a[116:119], v[164:167]
  ds_read_b64_tr_b16 a[216:217], v52 offset:2048
  buffer_load_dwordx4 v56, s[24:27], s1 offen offset:1024 lds
  v_mfma_f32_16x16x32_bf16 v[136:139], a[148:151], a[24:27], v[136:139]
  ds_read_b64_tr_b16 a[218:219], v51 offset:18432
  v_fma_f32 v49, v80, v71, v97
  v_mfma_f32_16x16x32_bf16 v[184:187], a[164:167], a[24:27], v[184:187]
  ds_read_b64_tr_b16 a[232:233], v52 offset:43008
  v_fmac_f32_dpp v2, v4, -v61 row_ror:8 row_mask:0xf bank_mask:0xf
  v_mfma_f32_16x16x32_bf16 v[188:191], a[164:167], a[116:119], v[188:191]
  ds_read_b64_tr_b16 a[234:235], v51 offset:59392
  buffer_load_dwordx4 v57, s[24:27], s1 offen offset:2048 lds
  v_mfma_f32_16x16x32_bf16 v[176:179], a[164:167], a[124:127], v[176:179]
  ds_read_b64_tr_b16 a[244:245], v67 offset:2048
  v_fmac_f32_dpp v6, v53, -v55 row_ror:8 row_mask:0xf bank_mask:0xf
  v_mfma_f32_16x16x32_bf16 v[168:171], a[164:167], a[88:91], v[168:171]
  ds_read_b64_tr_b16 a[246:247], v69 offset:18432
  v_fmac_f32_dpp v49, v71, -v81 row_ror:8 row_mask:0xf bank_mask:0xf
  v_mfma_f32_16x16x32_bf16 v[152:155], a[248:251], a[88:91], v[152:155]
  ds_read_b64_tr_b16 a[148:149], v67 offset:43008
  buffer_load_dwordx4 v64, s[24:27], s1 offen offset:3072 lds
  v_mfma_f32_16x16x32_bf16 v[196:199], a[248:251], a[124:127], v[196:199]
  s_add_u32 m0, s0, 0x7000
  s_add_u32 s1, s48, 0x80
  ds_read_b64_tr_b16 a[150:151], v69 offset:59392
  v_mfma_f32_16x16x32_bf16 v[200:203], a[248:251], a[116:119], v[200:203]
  v_fma_f32 v4, v60, v2, v114
  v_fma_f32 v53, v54, v6, v162
  v_mfma_f32_16x16x32_bf16 v[192:195], a[248:251], a[24:27], v[192:195]
  v_fma_f32 v71, v80, v49, v98
  v_fmac_f32_dpp v4, v2, -v61 row_ror:8 row_mask:0xf bank_mask:0xf
  v_mfma_f32_16x16x32_bf16 v[84:87], a[212:215], a[24:27], v[84:87]
  v_fmac_f32_dpp v53, v6, -v55 row_ror:8 row_mask:0xf bank_mask:0xf
  v_fmac_f32_dpp v71, v49, -v81 row_ror:8 row_mask:0xf bank_mask:0xf
  v_mfma_f32_16x16x32_bf16 v[212:215], a[212:215], a[116:119], v[212:215]
  v_fma_f32 v2, v60, v4, v115
  v_fma_f32 v6, v54, v53, v163
  v_mfma_f32_16x16x32_bf16 v[208:211], a[212:215], a[124:127], v[208:211]
  v_fma_f32 v49, v80, v71, v99
  v_fmac_f32_dpp v2, v4, -v61 row_ror:8 row_mask:0xf bank_mask:0xf
  v_mfma_f32_16x16x32_bf16 v[204:207], a[212:215], a[88:91], v[204:207]
  s_waitcnt lgkmcnt(0)
  v_fmac_f32_dpp v6, v53, -v55 row_ror:8 row_mask:0xf bank_mask:0xf
  v_fmac_f32_dpp v49, v71, -v81 row_ror:8 row_mask:0xf bank_mask:0xf
  v_mfma_f32_16x16x32_bf16 v[72:75], a[216:219], a[104:107], v[72:75]
  v_fma_f32 v4, v60, v2, v116
  v_fma_f32 v53, v54, v6, v156
  v_mfma_f32_16x16x32_bf16 v[140:143], a[216:219], a[140:143], v[140:143]
  s_waitcnt vmcnt(14)
  s_barrier
  v_mfma_f32_16x16x32_bf16 v[164:167], a[216:219], a[144:147], v[164:167]
  ds_read_b64_tr_b16 a[164:165], v52 offset:16384
  v_fma_f32 v71, v80, v49, v128
  v_mfma_f32_16x16x32_bf16 v[136:139], a[216:219], a[28:31], v[136:139]
  ds_read_b64_tr_b16 a[166:167], v51 offset:32768
  v_fmac_f32_dpp v4, v2, -v61 row_ror:8 row_mask:0xf bank_mask:0xf
  v_mfma_f32_16x16x32_bf16 v[184:187], a[232:235], a[28:31], v[184:187]
  ds_read_b64_tr_b16 a[212:213], v52 offset:57344
  buffer_load_dword v1, v50, s[24:27], s50 offen offset:256
  v_mfma_f32_16x16x32_bf16 v[188:191], a[232:235], a[144:147], v[188:191]
  ds_read_b64_tr_b16 a[214:215], v68 offset:8192
  v_fmac_f32_dpp v53, v6, -v55 row_ror:8 row_mask:0xf bank_mask:0xf
  v_mfma_f32_16x16x32_bf16 v[176:179], a[232:235], a[140:143], v[176:179]
  ds_read_b64_tr_b16 a[248:249], v67 offset:16384
  buffer_load_dword v1, v50, s[24:27], s50 offen offset:896
  v_mfma_f32_16x16x32_bf16 v[168:171], a[232:235], a[104:107], v[168:171]
  ds_read_b64_tr_b16 a[250:251], v69 offset:32768
  v_fmac_f32_dpp v71, v49, -v81 row_ror:8 row_mask:0xf bank_mask:0xf
  v_mfma_f32_16x16x32_bf16 v[152:155], a[244:247], a[104:107], v[152:155]
  ds_read_b64_tr_b16 a[216:217], v67 offset:57344
  buffer_load_dword v1, v50, s[24:27], s50 offen offset:1408
  v_mfma_f32_16x16x32_bf16 v[196:199], a[244:247], a[140:143], v[196:199]
  ds_read_b64_tr_b16 a[218:219], v70 offset:8192
  v_fma_f32 v2, v60, v4, v117
  v_mfma_f32_16x16x32_bf16 v[200:203], a[244:247], a[144:147], v[200:203]
  buffer_load_dword v1, v50, s[24:27], s50 offen offset:2048
  v_fma_f32 v6, v54, v53, v157
  v_mfma_f32_16x16x32_bf16 v[192:195], a[244:247], a[28:31], v[192:195]
  v_fma_f32 v49, v80, v71, v129
  v_fmac_f32_dpp v2, v4, -v61 row_ror:8 row_mask:0xf bank_mask:0xf
  v_mfma_f32_16x16x32_bf16 v[84:87], a[148:151], a[28:31], v[84:87]
  v_fmac_f32_dpp v6, v53, -v55 row_ror:8 row_mask:0xf bank_mask:0xf
  v_fmac_f32_dpp v49, v71, -v81 row_ror:8 row_mask:0xf bank_mask:0xf
  v_mfma_f32_16x16x32_bf16 v[212:215], a[148:151], a[144:147], v[212:215]
  v_fma_f32 v4, v60, v2, v118
  v_fma_f32 v53, v54, v6, v158
  v_mfma_f32_16x16x32_bf16 v[208:211], a[148:151], a[140:143], v[208:211]
  v_lshlrev_b32 v71, 3, v62
  v_and_b32 v71, 0x80, v71
  v_mfma_f32_16x16x32_bf16 v[204:207], a[148:151], a[104:107], v[204:207]
  s_waitcnt lgkmcnt(0)
  v_fma_f32 v82, v80, v49, v130
  v_fmac_f32_dpp v4, v2, -v61 row_ror:8 row_mask:0xf bank_mask:0xf
  v_mfma_f32_16x16x32_bf16 v[72:75], a[164:167], a[120:123], v[72:75]
  v_fmac_f32_dpp v53, v6, -v55 row_ror:8 row_mask:0xf bank_mask:0xf
  v_fmac_f32_dpp v82, v49, -v81 row_ror:8 row_mask:0xf bank_mask:0xf
  v_mfma_f32_16x16x32_bf16 v[140:143], a[164:167], a[156:159], v[140:143]
  v_fma_f32 v2, v60, v4, v119
  v_fma_f32 v6, v54, v53, v159
  v_mfma_f32_16x16x32_bf16 v[164:167], a[164:167], a[160:163], v[164:167]
  ds_read_b64_tr_b16 a[232:233], v52 offset:18432
  v_fma_f32 v49, v80, v82, v131
  v_mfma_f32_16x16x32_bf16 v[136:139], a[164:167], a[84:87], v[136:139]
  ds_read_b64_tr_b16 a[234:235], v51 offset:34816
  v_fmac_f32_dpp v2, v4, -v61 row_ror:8 row_mask:0xf bank_mask:0xf
  v_mfma_f32_16x16x32_bf16 v[184:187], a[212:215], a[84:87], v[184:187]
  ds_read_b64_tr_b16 a[148:149], v52 offset:59392
  v_fmac_f32_dpp v6, v53, -v55 row_ror:8 row_mask:0xf bank_mask:0xf
  v_mfma_f32_16x16x32_bf16 v[188:191], a[212:215], a[160:163], v[188:191]
  ds_read_b64_tr_b16 a[150:151], v68 offset:10240
  v_fmac_f32_dpp v49, v82, -v81 row_ror:8 row_mask:0xf bank_mask:0xf
  v_mfma_f32_16x16x32_bf16 v[176:179], a[212:215], a[156:159], v[176:179]
  ds_read_b64_tr_b16 a[244:245], v67 offset:18432
  v_fma_f32 v4, v60, v2, v144
  v_mfma_f32_16x16x32_bf16 v[168:171], a[212:215], a[120:123], v[168:171]
  ds_read_b64_tr_b16 a[246:247], v69 offset:34816
  v_fma_f32 v53, v54, v6, v148
  v_mfma_f32_16x16x32_bf16 v[152:155], a[248:251], a[120:123], v[152:155]
  ds_read_b64_tr_b16 a[164:165], v67 offset:59392
  v_fma_f32 v82, v80, v49, v132
  v_mfma_f32_16x16x32_bf16 v[196:199], a[248:251], a[156:159], v[196:199]
  ds_read_b64_tr_b16 a[166:167], v70 offset:10240
  v_fmac_f32_dpp v4, v2, -v61 row_ror:8 row_mask:0xf bank_mask:0xf
  v_mfma_f32_16x16x32_bf16 v[200:203], a[248:251], a[160:163], v[200:203]
  v_fmac_f32_dpp v53, v6, -v55 row_ror:8 row_mask:0xf bank_mask:0xf
  v_fmac_f32_dpp v82, v49, -v81 row_ror:8 row_mask:0xf bank_mask:0xf
  v_mfma_f32_16x16x32_bf16 v[192:195], a[248:251], a[84:87], v[192:195]
  v_fma_f32 v2, v60, v4, v145
  v_fma_f32 v6, v54, v53, v149
  v_mfma_f32_16x16x32_bf16 v[84:87], a[216:219], a[84:87], v[84:87]
  v_fma_f32 v49, v80, v82, v133
  v_fmac_f32_dpp v2, v4, -v61 row_ror:8 row_mask:0xf bank_mask:0xf
  v_mfma_f32_16x16x32_bf16 v[212:215], a[216:219], a[160:163], v[212:215]
  v_fmac_f32_dpp v6, v53, -v55 row_ror:8 row_mask:0xf bank_mask:0xf
  v_fmac_f32_dpp v49, v82, -v81 row_ror:8 row_mask:0xf bank_mask:0xf
  v_mfma_f32_16x16x32_bf16 v[208:211], a[216:219], a[156:159], v[208:211]
  buffer_load_dwordx4 v63, s[24:27], s1 offen offset:0 lds
  v_fma_f32 v4, v60, v2, v146
  v_mfma_f32_16x16x32_bf16 v[204:207], a[216:219], a[120:123], v[204:207]
  s_waitcnt lgkmcnt(0)
  v_fma_f32 v53, v54, v6, v150
  v_fma_f32 v82, v80, v49, v134
  v_mfma_f32_16x16x32_bf16 v[72:75], a[232:235], a[136:139], v[72:75]
  v_fmac_f32_dpp v4, v2, -v61 row_ror:8 row_mask:0xf bank_mask:0xf
  v_fmac_f32_dpp v53, v6, -v55 row_ror:8 row_mask:0xf bank_mask:0xf
  v_mfma_f32_16x16x32_bf16 v[140:143], a[232:235], a[172:175], v[140:143]
  v_fmac_f32_dpp v82, v49, -v81 row_ror:8 row_mask:0xf bank_mask:0xf
  v_fma_f32 v2, v60, v4, v147
  v_mfma_f32_16x16x32_bf16 v[164:167], a[232:235], a[176:179], v[164:167]
  ds_read_b64_tr_b16 a[212:213], v52 offset:8192
  buffer_load_dwordx4 v56, s[24:27], s1 offen offset:1024 lds
  v_mfma_f32_16x16x32_bf16 v[136:139], a[232:235], a[128:131], v[136:139]
  ds_read_b64_tr_b16 a[214:215], v51 offset:24576
  v_fma_f32 v6, v54, v53, v151
  v_mfma_f32_16x16x32_bf16 v[184:187], a[148:151], a[128:131], v[184:187]
  ds_read_b64_tr_b16 a[216:217], v52 offset:49152
  v_fma_f32 v49, v80, v82, v135
  v_mfma_f32_16x16x32_bf16 v[188:191], a[148:151], a[176:179], v[188:191]
  ds_read_b64_tr_b16 a[218:219], v68 offset:0
  v_fmac_f32_dpp v2, v4, -v61 row_ror:8 row_mask:0xf bank_mask:0xf
  v_mfma_f32_16x16x32_bf16 v[176:179], a[148:151], a[172:175], v[176:179]
  ds_read_b64_tr_b16 a[248:249], v67 offset:8192
  v_fmac_f32_dpp v6, v53, -v55 row_ror:8 row_mask:0xf bank_mask:0xf
  v_mfma_f32_16x16x32_bf16 v[168:171], a[148:151], a[136:139], v[168:171]
  ds_read_b64_tr_b16 a[250:251], v69 offset:24576
  v_fmac_f32_dpp v49, v82, -v81 row_ror:8 row_mask:0xf bank_mask:0xf
  v_mfma_f32_16x16x32_bf16 v[152:155], a[244:247], a[136:139], v[152:155]
  ds_read_b64_tr_b16 a[232:233], v67 offset:49152
  v_mul_f32 v4, v58, v2
  v_mfma_f32_16x16x32_bf16 v[196:199], a[244:247], a[172:175], v[196:199]
  ds_read_b64_tr_b16 a[234:235], v70 offset:0
  v_mul_f32 v60, v180, v6
  v_mfma_f32_16x16x32_bf16 v[200:203], a[244:247], a[176:179], v[200:203]
  v_mul_f32 v61, v182, v49
  v_fmac_f32_dpp v4, v2, v59 row_ror:8 row_mask:0xf bank_mask:0xf
  v_mfma_f32_16x16x32_bf16 v[192:195], a[244:247], a[128:131], v[192:195]
  v_fmac_f32_dpp v60, v6, v181 row_ror:8 row_mask:0xf bank_mask:0xf
  v_fmac_f32_dpp v61, v49, v183 row_ror:8 row_mask:0xf bank_mask:0xf
  v_mfma_f32_16x16x32_bf16 v[84:87], a[164:167], a[128:131], v[84:87]
  ds_bpermute_b32 v224, v7, v4 offset:0
  v_mfma_f32_16x16x32_bf16 v[212:215], a[164:167], a[176:179], v[212:215]
  ds_bpermute_b32 v225, v7, v4 offset:64
  v_mfma_f32_16x16x32_bf16 v[208:211], a[164:167], a[172:175], v[208:211]
  ds_bpermute_b32 v226, v7, v4 offset:128
  v_mfma_f32_16x16x32_bf16 v[204:207], a[164:167], a[136:139], v[204:207]
  s_waitcnt lgkmcnt(3)
  ds_bpermute_b32 v227, v7, v4 offset:192
  v_mfma_f32_16x16x32_bf16 v[72:75], a[212:215], a[152:155], v[72:75]
  ds_bpermute_b32 v228, v7, v60 offset:0
  v_mfma_f32_16x16x32_bf16 v[140:143], a[212:215], a[188:191], v[140:143]
  ds_bpermute_b32 v229, v7, v60 offset:64
  v_mfma_f32_16x16x32_bf16 v[164:167], a[212:215], a[192:195], v[164:167]
  ds_read_b64_tr_b16 a[148:149], v52 offset:10240
  v_mfma_f32_16x16x32_bf16 v[136:139], a[212:215], a[180:183], v[136:139]
  ds_read_b64_tr_b16 a[150:151], v51 offset:26624
  v_mfma_f32_16x16x32_bf16 v[184:187], a[216:219], a[180:183], v[184:187]
  ds_read_b64_tr_b16 a[164:165], v52 offset:51200
  v_mfma_f32_16x16x32_bf16 v[188:191], a[216:219], a[192:195], v[188:191]
  ds_read_b64_tr_b16 a[166:167], v68 offset:2048
  v_mfma_f32_16x16x32_bf16 v[176:179], a[216:219], a[188:191], v[176:179]
  ds_read_b64_tr_b16 a[244:245], v67 offset:10240
  v_mfma_f32_16x16x32_bf16 v[168:171], a[216:219], a[152:155], v[168:171]
  ds_read_b64_tr_b16 a[246:247], v69 offset:26624
  v_mfma_f32_16x16x32_bf16 v[152:155], a[248:251], a[152:155], v[152:155]
  ds_read_b64_tr_b16 a[252:253], v67 offset:51200
  v_mfma_f32_16x16x32_bf16 v[196:199], a[248:251], a[188:191], v[196:199]
  ds_read_b64_tr_b16 a[254:255], v70 offset:2048
  v_mfma_f32_16x16x32_bf16 v[200:203], a[248:251], a[192:195], v[200:203]
  ds_bpermute_b32 v230, v7, v60 offset:128
  v_mfma_f32_16x16x32_bf16 v[192:195], a[248:251], a[180:183], v[192:195]
  ds_bpermute_b32 v231, v7, v60 offset:192
  v_mfma_f32_16x16x32_bf16 v[84:87], a[232:235], a[180:183], v[84:87]
  ds_bpermute_b32 v232, v7, v61 offset:0
  v_mfma_f32_16x16x32_bf16 v[212:215], a[232:235], a[192:195], v[212:215]
  buffer_load_dwordx4 v57, s[24:27], s1 offen offset:2048 lds
  v_mfma_f32_16x16x32_bf16 v[208:211], a[232:235], a[188:191], v[208:211]
  ds_bpermute_b32 v233, v7, v61 offset:64
  v_mfma_f32_16x16x32_bf16 v[204:207], a[232:235], a[152:155], v[204:207]
  s_waitcnt lgkmcnt(4)
  ds_bpermute_b32 v234, v7, v61 offset:128
  v_mfma_f32_16x16x32_bf16 v[72:75], a[148:151], a[168:171], v[72:75]
  buffer_load_dwordx4 v64, s[24:27], s1 offen offset:3072 lds
  s_add_u32 m0, s0, 0
  v_mfma_f32_16x16x32_bf16 v[140:143], a[148:151], a[204:207], v[140:143]
  s_waitcnt vmcnt(8)
  s_barrier
  v_mfma_f32_16x16x32_bf16 v[164:167], a[148:151], a[196:199], v[164:167]
  s_add_u32 s1, s48, 0x90080
  ds_read_b64_tr_b16 a[212:213], v52 offset:20480
  v_mfma_f32_16x16x32_bf16 v[136:139], a[148:151], a[208:211], v[136:139]
  ds_read_b64_tr_b16 a[214:215], v51 offset:36864
  buffer_load_dwordx4 v63, s[24:27], s1 offen offset:0 lds
  v_mfma_f32_16x16x32_bf16 v[184:187], a[164:167], a[208:211], v[184:187]
  ds_read_b64_tr_b16 a[216:217], v52 offset:61440
  v_mfma_f32_16x16x32_bf16 v[188:191], a[164:167], a[196:199], v[188:191]
  ds_read_b64_tr_b16 a[218:219], v68 offset:12288
  v_mfma_f32_16x16x32_bf16 v[176:179], a[164:167], a[204:207], v[176:179]
  ds_read_b64_tr_b16 a[232:233], v67 offset:20480
  buffer_load_dwordx4 v56, s[24:27], s1 offen offset:1024 lds
  v_mfma_f32_16x16x32_bf16 v[168:171], a[164:167], a[168:171], v[168:171]
  ds_read_b64_tr_b16 a[234:235], v69 offset:36864
  v_mfma_f32_16x16x32_bf16 v[152:155], a[244:247], a[168:171], v[152:155]
  ds_read_b64_tr_b16 a[148:149], v67 offset:61440
  v_mfma_f32_16x16x32_bf16 v[196:199], a[244:247], a[204:207], v[196:199]
  ds_read_b64_tr_b16 a[150:151], v70 offset:12288
  buffer_load_dwordx4 v57, s[24:27], s1 offen offset:2048 lds
  v_mfma_f32_16x16x32_bf16 v[200:203], a[244:247], a[196:199], v[200:203]
  ds_bpermute_b32 v235, v7, v61 offset:192
  v_mfma_f32_16x16x32_bf16 v[192:195], a[244:247], a[208:211], v[192:195]
  v_mfma_f32_16x16x32_bf16 v[84:87], a[252:255], a[208:211], v[84:87]
  buffer_load_dwordx4 v64, s[24:27], s1 offen offset:3072 lds
  s_add_u32 m0, s0, 0x3000
  v_mfma_f32_16x16x32_bf16 v[212:215], a[252:255], a[196:199], v[212:215]
  s_add_u32 s1, s48, 0x120080
  v_mfma_f32_16x16x32_bf16 v[208:211], a[252:255], a[204:207], v[208:211]
  v_mfma_f32_16x16x32_bf16 v[204:207], a[252:255], a[168:171], v[204:207]
  s_waitcnt lgkmcnt(1)
  v_fma_f32 v2, v216, v224, v225
  v_fma_f32 v49, v218, v228, v229
  v_mfma_f32_16x16x32_bf16 v[72:75], a[212:215], a[184:187], v[72:75]
  v_fma_f32 v4, v220, v232, v233
  v_fmac_f32_dpp v2, v224, v217 row_ror:8 row_mask:0xf bank_mask:0xf
  v_mfma_f32_16x16x32_bf16 v[140:143], a[212:215], a[220:223], v[140:143]
  v_fmac_f32_dpp v49, v228, v219 row_ror:8 row_mask:0xf bank_mask:0xf
  v_fmac_f32_dpp v4, v232, v221 row_ror:8 row_mask:0xf bank_mask:0xf
  v_mfma_f32_16x16x32_bf16 v[164:167], a[212:215], a[224:227], v[164:167]
  ds_read_b64_tr_b16 a[164:165], v52 offset:22528
  v_fma_f32 v6, v216, v2, v226
  v_mfma_f32_16x16x32_bf16 v[136:139], a[212:215], a[132:135], v[136:139]
  ds_read_b64_tr_b16 a[166:167], v51 offset:38912
  v_fma_f32 v60, v218, v49, v230
  v_mfma_f32_16x16x32_bf16 v[184:187], a[216:219], a[132:135], v[184:187]
  ds_read_b64_tr_b16 a[244:245], v52 offset:63488
  v_fma_f32 v61, v220, v4, v234
  v_mfma_f32_16x16x32_bf16 v[188:191], a[216:219], a[224:227], v[188:191]
  ds_read_b64_tr_b16 a[246:247], v68 offset:14336
  v_fmac_f32_dpp v6, v2, v217 row_ror:8 row_mask:0xf bank_mask:0xf
  v_mfma_f32_16x16x32_bf16 v[176:179], a[216:219], a[220:223], v[176:179]
  ds_read_b64_tr_b16 a[248:249], v67 offset:22528
  v_fmac_f32_dpp v60, v49, v219 row_ror:8 row_mask:0xf bank_mask:0xf
  v_mfma_f32_16x16x32_bf16 v[168:171], a[216:219], a[184:187], v[168:171]
  ds_read_b64_tr_b16 a[250:251], v69 offset:38912
  v_fmac_f32_dpp v61, v4, v221 row_ror:8 row_mask:0xf bank_mask:0xf
  v_mfma_f32_16x16x32_bf16 v[152:155], a[232:235], a[184:187], v[152:155]
  ds_read_b64_tr_b16 a[212:213], v67 offset:63488
  v_fma_f32 v2, v216, v6, v227
  v_mfma_f32_16x16x32_bf16 v[196:199], a[232:235], a[220:223], v[196:199]
  ds_read_b64_tr_b16 a[214:215], v70 offset:14336
  v_fma_f32 v4, v218, v60, v231
  v_mfma_f32_16x16x32_bf16 v[200:203], a[232:235], a[224:227], v[200:203]
  s_waitcnt lgkmcnt(8)
  v_fma_f32 v49, v220, v61, v235
  v_fmac_f32_dpp v2, v6, v217 row_ror:8 row_mask:0xf bank_mask:0xf
  v_mfma_f32_16x16x32_bf16 v[192:195], a[232:235], a[132:135], v[192:195]
  v_fmac_f32_dpp v4, v60, v219 row_ror:8 row_mask:0xf bank_mask:0xf
  v_fmac_f32_dpp v49, v61, v221 row_ror:8 row_mask:0xf bank_mask:0xf
  v_mfma_f32_16x16x32_bf16 v[84:87], a[148:151], a[132:135], v[84:87]
  v_min_u32 v60, -2, v2
  v_min_u32 v61, -2, v4
  v_mfma_f32_16x16x32_bf16 v[212:215], a[148:151], a[224:227], v[212:215]
  v_min_u32 v2, -2, v49
  v_lshl_add_u32 v49, v5, 28, v3
  v_mfma_f32_16x16x32_bf16 v[208:211], a[148:151], a[220:223], v[208:211]
  v_lshl_add_u32 v4, v5, 28, v7
  s_min_u32 s50, s3, 1
  v_mfma_f32_16x16x32_bf16 v[204:207], a[148:151], a[184:187], v[204:207]
  s_waitcnt lgkmcnt(0)
  s_lshl_b32 s50, s50, 28
  s_add_u32 s50, s50, s60
  v_mfma_f32_16x16x32_bf16 v[72:75], a[164:167], a[200:203], v[72:75]
  buffer_store_dwordx2 v[60:61], v49, s[36:39], s55 offen sc1
  v_mfma_f32_16x16x32_bf16 v[140:143], a[164:167], a[236:239], v[140:143]
  v_mfma_f32_16x16x32_bf16 v[164:167], a[164:167], a[240:243], v[164:167]
  ds_read_b64_tr_b16 a[216:217], v52 offset:24576
  v_mfma_f32_16x16x32_bf16 v[136:139], a[164:167], a[228:231], v[136:139]
  ds_read_b64_tr_b16 a[218:219], v51 offset:40960
  buffer_store_dword v2, v4, s[36:39], s50 offen sc1
  v_mfma_f32_16x16x32_bf16 v[184:187], a[244:247], a[228:231], v[184:187]
  ds_read_b64_tr_b16 a[148:149], v51 offset:0
  v_mfma_f32_16x16x32_bf16 v[188:191], a[244:247], a[240:243], v[188:191]
  ds_read_b64_tr_b16 a[150:151], v68 offset:16384
  v_mfma_f32_16x16x32_bf16 v[176:179], a[244:247], a[236:239], v[176:179]
  ds_read_b64_tr_b16 a[232:233], v67 offset:24576
  v_mfma_f32_16x16x32_bf16 v[168:171], a[244:247], a[200:203], v[168:171]
  ds_read_b64_tr_b16 a[234:235], v69 offset:40960
  v_mfma_f32_16x16x32_bf16 v[152:155], a[248:251], a[200:203], v[152:155]
  ds_read_b64_tr_b16 a[164:165], v69 offset:0
  buffer_load_dword v2, v71, s[32:35], 0 offen sc1
  v_mfma_f32_16x16x32_bf16 v[196:199], a[248:251], a[236:239], v[196:199]
  ds_read_b64_tr_b16 a[166:167], v70 offset:16384
  v_mul_f32 v216, v58, v104
  v_mfma_f32_16x16x32_bf16 v[200:203], a[248:251], a[240:243], v[200:203]
  v_mul_f32 v217, v58, v105
  v_mul_f32 v218, v58, v106
  v_mfma_f32_16x16x32_bf16 v[192:195], a[248:251], a[228:231], v[192:195]
  v_mul_f32 v219, v58, v107
  v_fmac_f32_dpp v216, v104, v59 row_ror:8 row_mask:0xf bank_mask:0xf
  v_mfma_f32_16x16x32_bf16 v[84:87], a[212:215], a[228:231], v[84:87]
  v_fmac_f32_dpp v217, v105, v59 row_ror:8 row_mask:0xf bank_mask:0xf
  v_fmac_f32_dpp v218, v106, v59 row_ror:8 row_mask:0xf bank_mask:0xf
  v_mfma_f32_16x16x32_bf16 v[212:215], a[212:215], a[240:243], v[212:215]
  v_fmac_f32_dpp v219, v107, v59 row_ror:8 row_mask:0xf bank_mask:0xf
  v_mul_f32 v220, v58, v112
  v_mfma_f32_16x16x32_bf16 v[208:211], a[212:215], a[236:239], v[208:211]
  v_mul_f32 v221, v58, v113
  v_mul_f32 v222, v58, v114
  v_mfma_f32_16x16x32_bf16 v[204:207], a[212:215], a[200:203], v[204:207]
  s_waitcnt lgkmcnt(0)
  v_mul_f32 v223, v58, v115
  v_fmac_f32_dpp v220, v112, v59 row_ror:8 row_mask:0xf bank_mask:0xf
  v_mfma_f32_16x16x32_bf16 v[72:75], a[216:219], v[24:27], v[72:75]
  v_fmac_f32_dpp v221, v113, v59 row_ror:8 row_mask:0xf bank_mask:0xf
  v_fmac_f32_dpp v222, v114, v59 row_ror:8 row_mask:0xf bank_mask:0xf
  v_mfma_f32_16x16x32_bf16 v[140:143], a[216:219], v[8:11], v[140:143]
  v_fmac_f32_dpp v223, v115, v59 row_ror:8 row_mask:0xf bank_mask:0xf
  v_mul_f32 v104, v58, v116
  v_mfma_f32_16x16x32_bf16 v[164:167], a[216:219], v[16:19], v[164:167]
  ds_read_b64_tr_b16 a[244:245], v52 offset:26624
  v_mul_f32 v105, v58, v117
  v_mfma_f32_16x16x32_bf16 v[136:139], a[216:219], v[28:31], v[136:139]
  ds_read_b64_tr_b16 a[246:247], v51 offset:43008
  v_mul_f32 v106, v58, v118
  v_mfma_f32_16x16x32_bf16 v[184:187], a[148:151], v[28:31], v[184:187]
  ds_read_b64_tr_b16 a[212:213], v51 offset:2048
  v_mul_f32 v107, v58, v119
  v_mfma_f32_16x16x32_bf16 v[188:191], a[148:151], v[16:19], v[188:191]
  ds_read_b64_tr_b16 a[214:215], v68 offset:18432
  v_fmac_f32_dpp v104, v116, v59 row_ror:8 row_mask:0xf bank_mask:0xf
  v_mfma_f32_16x16x32_bf16 v[176:179], a[148:151], v[8:11], v[176:179]
  ds_read_b64_tr_b16 a[248:249], v52 offset:4096
  v_fmac_f32_dpp v105, v117, v59 row_ror:8 row_mask:0xf bank_mask:0xf
  v_mfma_f32_16x16x32_bf16 v[168:171], a[148:151], v[24:27], v[168:171]
  ds_read_b64_tr_b16 a[250:251], v51 offset:20480
  v_fmac_f32_dpp v106, v118, v59 row_ror:8 row_mask:0xf bank_mask:0xf
  v_mfma_f32_16x16x32_bf16 v[152:155], a[232:235], v[24:27], v[152:155]
  ds_read_b64_tr_b16 a[216:217], v52 offset:45056
  v_fmac_f32_dpp v107, v119, v59 row_ror:8 row_mask:0xf bank_mask:0xf
  v_mfma_f32_16x16x32_bf16 v[196:199], a[232:235], v[8:11], v[196:199]
  ds_read_b64_tr_b16 a[218:219], v51 offset:61440
  v_mul_f32 v112, v58, v144
  v_mfma_f32_16x16x32_bf16 v[200:203], a[232:235], v[16:19], v[200:203]
  v_mul_f32 v113, v58, v145
  v_mul_f32 v114, v58, v146
  v_mfma_f32_16x16x32_bf16 v[192:195], a[232:235], v[28:31], v[192:195]
  v_mul_f32 v115, v58, v147
  v_fmac_f32_dpp v112, v144, v59 row_ror:8 row_mask:0xf bank_mask:0xf
  v_mfma_f32_16x16x32_bf16 v[84:87], a[164:167], v[28:31], v[84:87]
  v_fmac_f32_dpp v113, v145, v59 row_ror:8 row_mask:0xf bank_mask:0xf
  v_fmac_f32_dpp v114, v146, v59 row_ror:8 row_mask:0xf bank_mask:0xf
  v_mfma_f32_16x16x32_bf16 v[212:215], a[164:167], v[16:19], v[212:215]
  buffer_load_dwordx4 v63, s[24:27], s1 offen offset:0 lds
  v_fmac_f32_dpp v115, v147, v59 row_ror:8 row_mask:0xf bank_mask:0xf
  v_mfma_f32_16x16x32_bf16 v[208:211], a[164:167], v[8:11], v[208:211]
  v_mul_f32 v116, v180, v172
  v_mul_f32 v117, v180, v173
  v_mfma_f32_16x16x32_bf16 v[204:207], a[164:167], v[24:27], v[204:207]
  s_waitcnt lgkmcnt(0)
  v_mul_f32 v118, v180, v174
  v_mul_f32 v119, v180, v175
  v_mfma_f32_16x16x32_bf16 v[72:75], a[244:247], v[20:23], v[72:75]
  buffer_load_dwordx4 v56, s[24:27], s1 offen offset:1024 lds
  v_fmac_f32_dpp v116, v172, v181 row_ror:8 row_mask:0xf bank_mask:0xf
  v_mfma_f32_16x16x32_bf16 v[140:143], a[244:247], v[32:35], v[140:143]
  v_fmac_f32_dpp v117, v173, v181 row_ror:8 row_mask:0xf bank_mask:0xf
  v_fmac_f32_dpp v118, v174, v181 row_ror:8 row_mask:0xf bank_mask:0xf
  v_mfma_f32_16x16x32_bf16 v[164:167], a[244:247], v[12:15], v[164:167]
  ds_read_b64_tr_b16 a[148:149], v52 offset:6144
  v_fmac_f32_dpp v119, v175, v181 row_ror:8 row_mask:0xf bank_mask:0xf
  v_mfma_f32_16x16x32_bf16 v[136:139], a[244:247], v[36:39], v[136:139]
  ds_read_b64_tr_b16 a[150:151], v51 offset:22528
  buffer_load_dwordx4 v57, s[24:27], s1 offen offset:2048 lds
  v_mfma_f32_16x16x32_bf16 v[184:187], a[212:215], v[36:39], v[184:187]
  ds_read_b64_tr_b16 a[164:165], v52 offset:47104
  v_mul_f32 v144, v180, v160
  v_mfma_f32_16x16x32_bf16 v[188:191], a[212:215], v[12:15], v[188:191]
  ds_read_b64_tr_b16 a[166:167], v51 offset:63488
  v_mul_f32 v145, v180, v161
  v_mfma_f32_16x16x32_bf16 v[176:179], a[212:215], v[32:35], v[176:179]
  ds_read_b64_tr_b16 a[232:233], v67 offset:26624
  buffer_load_dwordx4 v64, s[24:27], s1 offen offset:3072 lds
  v_mfma_f32_16x16x32_bf16 v[168:171], a[212:215], v[20:23], v[168:171]
  s_add_u32 m0, s0, 0x2000
  s_add_u32 s1, s48, 0x1b0080
  ds_read_b64_tr_b16 a[234:235], v69 offset:43008
  v_mfma_f32_16x16x32_bf16 v[72:75], a[248:251], v[40:43], v[72:75]
  ds_read_b64_tr_b16 a[244:245], v69 offset:2048
  v_mul_f32 v146, v180, v162
  v_mfma_f32_16x16x32_bf16 v[140:143], a[248:251], v[44:47], v[140:143]
  ds_read_b64_tr_b16 a[246:247], v70 offset:18432
  buffer_load_dwordx4 v63, s[24:27], s1 offen offset:0 lds
  v_mfma_f32_16x16x32_bf16 v[164:167], a[248:251], v[88:91], v[164:167]
  v_mul_f32 v147, v180, v163
  v_fmac_f32_dpp v144, v160, v181 row_ror:8 row_mask:0xf bank_mask:0xf
  v_mfma_f32_16x16x32_bf16 v[136:139], a[248:251], v[92:95], v[136:139]
  v_fmac_f32_dpp v145, v161, v181 row_ror:8 row_mask:0xf bank_mask:0xf
  v_fmac_f32_dpp v146, v162, v181 row_ror:8 row_mask:0xf bank_mask:0xf
  v_mfma_f32_16x16x32_bf16 v[184:187], a[216:219], v[92:95], v[184:187]
  buffer_load_dwordx4 v56, s[24:27], s1 offen offset:1024 lds
  v_fmac_f32_dpp v147, v163, v181 row_ror:8 row_mask:0xf bank_mask:0xf
  v_mfma_f32_16x16x32_bf16 v[188:191], a[216:219], v[88:91], v[188:191]
  v_mul_f32 v172, v180, v156
  v_mul_f32 v173, v180, v157
  v_mfma_f32_16x16x32_bf16 v[176:179], a[216:219], v[44:47], v[176:179]
  v_mul_f32 v174, v180, v158
  v_mul_f32 v175, v180, v159
  v_mfma_f32_16x16x32_bf16 v[168:171], a[216:219], v[40:43], v[168:171]
  s_waitcnt lgkmcnt(0)
  buffer_load_dwordx4 v57, s[24:27], s1 offen offset:2048 lds
  v_fmac_f32_dpp v172, v156, v181 row_ror:8 row_mask:0xf bank_mask:0xf
  v_mfma_f32_16x16x32_bf16 v[72:75], a[148:151], v[100:103], v[72:75]
  v_fmac_f32_dpp v173, v157, v181 row_ror:8 row_mask:0xf bank_mask:0xf
  v_fmac_f32_dpp v174, v158, v181 row_ror:8 row_mask:0xf bank_mask:0xf
  v_mfma_f32_16x16x32_bf16 v[140:143], a[148:151], v[108:111], v[140:143]
  v_fmac_f32_dpp v175, v159, v181 row_ror:8 row_mask:0xf bank_mask:0xf
  v_mul_f32 v160, v180, v148
  v_mfma_f32_16x16x32_bf16 v[164:167], a[148:151], v[120:123], v[164:167]
  ds_read_b64_tr_b16 a[212:213], v67 offset:4096
  buffer_load_dwordx4 v64, s[24:27], s1 offen offset:3072 lds
  v_mfma_f32_16x16x32_bf16 v[136:139], a[148:151], v[124:127], v[136:139]
  s_add_u32 m0, s0, 0x4000
  s_add_u32 s1, s48, 0x240080
  ds_read_b64_tr_b16 a[214:215], v69 offset:20480
  v_mfma_f32_16x16x32_bf16 v[168:171], a[164:167], v[100:103], v[168:171]
  ds_read_b64_tr_b16 a[216:217], v67 offset:45056
  v_mul_f32 v161, v180, v149
  v_mfma_f32_16x16x32_bf16 v[176:179], a[164:167], v[108:111], v[176:179]
  ds_read_b64_tr_b16 a[218:219], v69 offset:61440
  v_mul_f32 v162, v180, v150
  v_mfma_f32_16x16x32_bf16 v[188:191], a[164:167], v[120:123], v[188:191]
  ds_read_b64_tr_b16 a[248:249], v67 offset:6144
  v_mul_f32 v163, v180, v151
  v_mfma_f32_16x16x32_bf16 v[184:187], a[164:167], v[124:127], v[184:187]
  ds_read_b64_tr_b16 a[250:251], v69 offset:22528
  v_mul_f32 v72, v72, v168
  v_mfma_f32_16x16x32_bf16 v[152:155], a[232:235], v[20:23], v[152:155]
  ds_read_b64_tr_b16 a[148:149], v67 offset:47104
  v_mul_f32 v73, v73, v169
  v_mfma_f32_16x16x32_bf16 v[196:199], a[232:235], v[32:35], v[196:199]
  ds_read_b64_tr_b16 a[150:151], v69 offset:63488
  v_mul_f32 v74, v74, v170
  v_mfma_f32_16x16x32_bf16 v[200:203], a[232:235], v[12:15], v[200:203]
  v_mul_f32 v75, v75, v171
  v_cvt_pk_bf16_f32 v156, v72, v73
  v_mfma_f32_16x16x32_bf16 v[192:195], a[232:235], v[36:39], v[192:195]
  v_cvt_pk_bf16_f32 v157, v74, v75
  v_mul_f32 v140, v140, v176
  v_mfma_f32_16x16x32_bf16 v[84:87], a[244:247], v[36:39], v[84:87]
  v_mul_f32 v141, v141, v177
  v_mul_f32 v142, v142, v178
  v_mfma_f32_16x16x32_bf16 v[212:215], a[244:247], v[12:15], v[212:215]
  v_mul_f32 v143, v143, v179
  v_cvt_pk_bf16_f32 v236, v140, v141
  v_mfma_f32_16x16x32_bf16 v[208:211], a[244:247], v[32:35], v[208:211]
  v_cvt_pk_bf16_f32 v237, v142, v143
  v_mul_f32 v164, v164, v188
  v_mfma_f32_16x16x32_bf16 v[204:207], a[244:247], v[20:23], v[204:207]
  s_waitcnt lgkmcnt(0)
  v_mul_f32 v165, v165, v189
  v_mul_f32 v166, v166, v190
  v_mfma_f32_16x16x32_bf16 v[152:155], a[212:215], v[40:43], v[152:155]
  v_mul_f32 v167, v167, v191
  v_cvt_pk_bf16_f32 v72, v164, v165
  v_mfma_f32_16x16x32_bf16 v[196:199], a[212:215], v[44:47], v[196:199]
  s_waitcnt vmcnt(11)
  s_barrier
  v_mfma_f32_16x16x32_bf16 v[200:203], a[212:215], v[88:91], v[200:203]
  ds_read_b64_tr_b16 a[164:165], v52 offset:28672
  v_cvt_pk_bf16_f32 v73, v166, v167
  v_mfma_f32_16x16x32_bf16 v[192:195], a[212:215], v[92:95], v[192:195]
  ds_read_b64_tr_b16 a[166:167], v51 offset:45056
  v_mul_f32 v136, v136, v184
  v_mfma_f32_16x16x32_bf16 v[84:87], a[216:219], v[92:95], v[84:87]
  ds_read_b64_tr_b16 a[232:233], v51 offset:4096
  v_mul_f32 v137, v137, v185
  v_mfma_f32_16x16x32_bf16 v[212:215], a[216:219], v[88:91], v[212:215]
  s_add_u32 s50, s47, 0xffffc000
  s_add_u32 s52, s47, 0x44000
  ds_read_b64_tr_b16 a[234:235], v68 offset:20480
  v_mfma_f32_16x16x32_bf16 v[208:211], a[216:219], v[44:47], v[208:211]
  ds_read_b64_tr_b16 a[244:245], v52 offset:30720
  v_mul_f32 v138, v138, v186
  v_mfma_f32_16x16x32_bf16 v[204:207], a[216:219], v[40:43], v[204:207]
  ds_read_b64_tr_b16 a[246:247], v51 offset:47104
  v_mul_f32 v139, v139, v187
  v_mfma_f32_16x16x32_bf16 v[152:155], a[248:251], v[100:103], v[152:155]
  ds_read_b64_tr_b16 a[212:213], v51 offset:6144
  v_cvt_pk_bf16_f32 v140, v136, v137
  v_mfma_f32_16x16x32_bf16 v[196:199], a[248:251], v[108:111], v[196:199]
  ds_read_b64_tr_b16 a[214:215], v68 offset:22528
  v_cvt_pk_bf16_f32 v141, v138, v139
  v_mfma_f32_16x16x32_bf16 v[200:203], a[248:251], v[120:123], v[200:203]
  v_fmac_f32_dpp v160, v148, v181 row_ror:8 row_mask:0xf bank_mask:0xf
  v_fmac_f32_dpp v161, v149, v181 row_ror:8 row_mask:0xf bank_mask:0xf
  v_mfma_f32_16x16x32_bf16 v[192:195], a[248:251], v[124:127], v[192:195]
  v_fmac_f32_dpp v162, v150, v181 row_ror:8 row_mask:0xf bank_mask:0xf
  v_fmac_f32_dpp v163, v151, v181 row_ror:8 row_mask:0xf bank_mask:0xf
  v_mfma_f32_16x16x32_bf16 v[204:207], a[148:151], v[100:103], v[204:207]
  buffer_load_dwordx4 v63, s[24:27], s1 offen offset:0 lds
  v_lshl_add_u32 v3, v5, 10, v3
  v_mfma_f32_16x16x32_bf16 v[208:211], a[148:151], v[108:111], v[208:211]
  v_lshl_add_u32 v49, v5, 10, v7
  s_mov_b64 s[4:5], s[36:37]
  v_mfma_f32_16x16x32_bf16 v[212:215], a[148:151], v[120:123], v[212:215]
  s_or_b32 s54, s55, 0xfff
  s_add_u32 s6, s54, 1
  s_mov_b32 s7, 0x20000
  v_mfma_f32_16x16x32_bf16 v[84:87], a[148:151], v[124:127], v[84:87]
  s_waitcnt lgkmcnt(0)
  v_mul_f32 v152, v152, v204
  v_mul_f32 v153, v153, v205
  v_mfma_f32_16x16x32_bf16 v[136:139], a[164:167], a[0:3], 0
  s_mov_b64 s[8:9], s[36:37]
  v_mul_f32 v154, v154, v206
  v_mul_f32 v155, v155, v207
  v_mfma_f32_16x16x32_bf16 v[148:151], a[164:167], a[8:11], 0
  s_or_b32 s54, s60, 0xfff
  buffer_load_dwordx4 v56, s[24:27], s1 offen offset:1024 lds
  v_cvt_pk_bf16_f32 v158, v152, v153
  v_mfma_f32_16x16x32_bf16 v[164:167], a[164:167], a[12:15], 0
  s_add_u32 s10, s54, 1
  ds_read_b64_tr_b16 a[148:149], v52 offset:0
  v_cvt_pk_bf16_f32 v159, v154, v155
  v_mfma_f32_16x16x32_bf16 v[168:171], a[164:167], a[16:19], 0
  s_mov_b32 s11, 0x20000
  ds_read_b64_tr_b16 a[150:151], v51 offset:16384
  v_mul_f32 v196, v196, v208
  v_mfma_f32_16x16x32_bf16 v[176:179], a[232:235], a[0:3], 0
  ds_read_b64_tr_b16 a[216:217], v52 offset:40960
  buffer_store_dwordx4 v[156:159], v62, s[36:39], s50 offen offset:0 sc1
  v_mfma_f32_16x16x32_bf16 v[184:187], a[232:235], a[8:11], 0
  ds_read_b64_tr_b16 a[218:219], v51 offset:57344
  v_mul_f32 v197, v197, v209
  v_mfma_f32_16x16x32_bf16 v[188:191], a[232:235], a[12:15], 0
  ds_read_b64_tr_b16 a[248:249], v67 offset:28672
  v_mul_f32 v198, v198, v210
  v_mfma_f32_16x16x32_bf16 v[152:155], a[232:235], a[16:19], 0
  ds_read_b64_tr_b16 a[250:251], v69 offset:45056
  v_mul_f32 v199, v199, v211
  v_mfma_f32_16x16x32_bf16 v[136:139], a[244:247], a[40:43], v[136:139]
  ds_read_b64_tr_b16 a[164:165], v69 offset:4096
  v_cvt_pk_bf16_f32 v238, v196, v197
  v_mfma_f32_16x16x32_bf16 v[148:151], a[244:247], a[4:7], v[148:151]
  ds_read_b64_tr_b16 a[166:167], v70 offset:20480
  v_cvt_pk_bf16_f32 v239, v198, v199
  v_mfma_f32_16x16x32_bf16 v[164:167], a[244:247], a[48:51], v[164:167]
  v_mul_f32 v200, v200, v212
  v_mul_f32 v201, v201, v213
  v_mfma_f32_16x16x32_bf16 v[168:171], a[244:247], a[52:55], v[168:171]
  buffer_load_dwordx4 v57, s[24:27], s1 offen offset:2048 lds
  v_mul_f32 v202, v202, v214
  v_mfma_f32_16x16x32_bf16 v[152:155], a[212:215], a[52:55], v[152:155]
  v_mul_f32 v203, v203, v215
  v_cvt_pk_bf16_f32 v74, v200, v201
  v_mfma_f32_16x16x32_bf16 v[188:191], a[212:215], a[48:51], v[188:191]
  buffer_store_dwordx4 v[236:239], v62, s[36:39], s50 offen offset:1024 sc1
  v_mfma_f32_16x16x32_bf16 v[184:187], a[212:215], a[4:7], v[184:187]
  v_cvt_pk_bf16_f32 v75, v202, v203
  v_mul_f32 v192, v192, v84
  v_mfma_f32_16x16x32_bf16 v[176:179], a[212:215], a[40:43], v[176:179]
  s_waitcnt lgkmcnt(0)
  buffer_load_dwordx4 v64, s[24:27], s1 offen offset:3072 lds
  s_add_u32 m0, s0, 0x1000
  v_mfma_f32_16x16x32_bf16 v[136:139], a[148:151], a[32:35], v[136:139]
  s_add_u32 s1, s48, 0x2d0080
  v_mul_f32 v193, v193, v85
  v_mul_f32 v194, v194, v86
  v_mfma_f32_16x16x32_bf16 v[148:151], a[148:151], a[44:47], v[148:151]
  buffer_store_dwordx4 v[72:75], v62, s[36:39], s52 offen offset:0 sc1
  v_mfma_f32_16x16x32_bf16 v[164:167], a[148:151], a[64:67], v[164:167]
  ds_read_b64_tr_b16 a[232:233], v67 offset:30720
  v_mul_f32 v195, v195, v87
  v_mfma_f32_16x16x32_bf16 v[168:171], a[148:151], a[68:71], v[168:171]
  ds_read_b64_tr_b16 a[234:235], v69 offset:47104
  buffer_load_dwordx4 v63, s[24:27], s1 offen offset:0 lds
  v_mfma_f32_16x16x32_bf16 v[152:155], a[216:219], a[68:71], v[152:155]
  ds_read_b64_tr_b16 a[212:213], v69 offset:6144
  v_cvt_pk_bf16_f32 v142, v192, v193
  v_mfma_f32_16x16x32_bf16 v[188:191], a[216:219], a[64:67], v[188:191]
  ds_read_b64_tr_b16 a[214:215], v70 offset:22528
  v_cvt_pk_bf16_f32 v143, v194, v195
  v_mfma_f32_16x16x32_bf16 v[184:187], a[216:219], a[44:47], v[184:187]
  ds_read_b64_tr_b16 a[244:245], v67 offset:0
  buffer_load_dwordx4 v56, s[24:27], s1 offen offset:1024 lds
  v_mfma_f32_16x16x32_bf16 v[176:179], a[216:219], a[32:35], v[176:179]
  s_waitcnt vmcnt(17)
  ds_read_b64_tr_b16 a[246:247], v69 offset:16384
  v_cmp_gt_u32 vcc, 0x80, v2
  v_mfma_f32_16x16x32_bf16 v[72:75], a[248:251], a[0:3], 0
  s_cbranch_vccnz L_rc
L_bc:
  ds_read_b64_tr_b16 a[148:149], v67 offset:40960
  v_mfma_f32_16x16x32_bf16 v[84:87], a[248:251], a[8:11], 0
  ds_read_b64_tr_b16 a[150:151], v69 offset:57344
  buffer_store_dwordx4 v[140:143], v62, s[36:39], s52 offen offset:1024 sc1
  v_mfma_f32_16x16x32_bf16 v[156:159], a[248:251], a[12:15], 0
  v_mfma_f32_16x16x32_bf16 v[192:195], a[248:251], a[16:19], 0
  buffer_load_dwordx4 v57, s[24:27], s1 offen offset:2048 lds
  v_mfma_f32_16x16x32_bf16 v[196:199], a[164:167], a[0:3], 0
  v_mfma_f32_16x16x32_bf16 v[200:203], a[164:167], a[8:11], 0
  v_mfma_f32_16x16x32_bf16 v[204:207], a[164:167], a[12:15], 0
  buffer_load_dwordx4 v64, s[24:27], s1 offen offset:3072 lds
  s_add_u32 m0, s0, 0x5000
  v_mfma_f32_16x16x32_bf16 v[208:211], a[164:167], a[16:19], 0
  s_waitcnt lgkmcnt(0)
  s_add_u32 s1, s48, 0x360080
  v_mfma_f32_16x16x32_bf16 v[72:75], a[232:235], a[40:43], v[72:75]
  v_mfma_f32_16x16x32_bf16 v[84:87], a[232:235], a[4:7], v[84:87]
  v_mfma_f32_16x16x32_bf16 v[156:159], a[232:235], a[48:51], v[156:159]
  ds_read_b64_tr_b16 a[216:217], v52 offset:2048
  v_mfma_f32_16x16x32_bf16 v[192:195], a[232:235], a[52:55], v[192:195]
  ds_read_b64_tr_b16 a[218:219], v51 offset:18432
  v_mfma_f32_16x16x32_bf16 v[208:211], a[212:215], a[52:55], v[208:211]
  ds_read_b64_tr_b16 a[248:249], v52 offset:43008
  v_mfma_f32_16x16x32_bf16 v[204:207], a[212:215], a[48:51], v[204:207]
  ds_read_b64_tr_b16 a[250:251], v51 offset:59392
  v_mfma_f32_16x16x32_bf16 v[200:203], a[212:215], a[4:7], v[200:203]
  ds_read_b64_tr_b16 a[164:165], v67 offset:2048
  v_mfma_f32_16x16x32_bf16 v[196:199], a[212:215], a[40:43], v[196:199]
  ds_read_b64_tr_b16 a[166:167], v69 offset:18432
  v_mfma_f32_16x16x32_bf16 v[72:75], a[244:247], a[32:35], v[72:75]
  ds_read_b64_tr_b16 a[252:253], v67 offset:43008
  v_mfma_f32_16x16x32_bf16 v[84:87], a[244:247], a[44:47], v[84:87]
  ds_read_b64_tr_b16 a[254:255], v69 offset:59392
  v_mfma_f32_16x16x32_bf16 v[156:159], a[244:247], a[64:67], v[156:159]
  v_mfma_f32_16x16x32_bf16 v[192:195], a[244:247], a[68:71], v[192:195]
  v_mfma_f32_16x16x32_bf16 v[208:211], a[148:151], a[68:71], v[208:211]
  v_mfma_f32_16x16x32_bf16 v[204:207], a[148:151], a[64:67], v[204:207]
  v_mfma_f32_16x16x32_bf16 v[200:203], a[148:151], a[44:47], v[200:203]
  v_mfma_f32_16x16x32_bf16 v[196:199], a[148:151], a[32:35], v[196:199]
  s_waitcnt lgkmcnt(0)
  v_mfma_f32_16x16x32_bf16 v[136:139], a[216:219], a[36:39], v[136:139]
  v_mfma_f32_16x16x32_bf16 v[148:151], a[216:219], a[76:79], v[148:151]
  s_waitcnt vmcnt(12)
  s_barrier
  v_mfma_f32_16x16x32_bf16 v[164:167], a[216:219], a[80:83], v[164:167]
  ds_read_b64_tr_b16 a[212:213], v52 offset:12288
  v_mfma_f32_16x16x32_bf16 v[168:171], a[216:219], a[56:59], v[168:171]
  ds_read_b64_tr_b16 a[214:215], v51 offset:28672
  v_mfma_f32_16x16x32_bf16 v[152:155], a[248:251], a[56:59], v[152:155]
  ds_read_b64_tr_b16 a[232:233], v52 offset:53248
  v_mfma_f32_16x16x32_bf16 v[188:191], a[248:251], a[80:83], v[188:191]
  ds_read_b64_tr_b16 a[234:235], v68 offset:4096
  v_mfma_f32_16x16x32_bf16 v[184:187], a[248:251], a[76:79], v[184:187]
  ds_read_b64_tr_b16 a[148:149], v67 offset:12288
  v_mfma_f32_16x16x32_bf16 v[176:179], a[248:251], a[36:39], v[176:179]
  ds_read_b64_tr_b16 a[150:151], v69 offset:28672
  v_mfma_f32_16x16x32_bf16 v[72:75], a[164:167], a[36:39], v[72:75]
  ds_read_b64_tr_b16 a[244:245], v67 offset:53248
  v_mfma_f32_16x16x32_bf16 v[84:87], a[164:167], a[76:79], v[84:87]
  ds_read_b64_tr_b16 a[246:247], v70 offset:4096
  v_mfma_f32_16x16x32_bf16 v[156:159], a[164:167], a[80:83], v[156:159]
  buffer_load_dwordx2 v[58:59], v3, s[4:7], s55 offen offset:128 sc1
  v_mul_f32 v140, v182, v76
  v_mfma_f32_16x16x32_bf16 v[192:195], a[164:167], a[56:59], v[192:195]
  v_mul_f32 v141, v182, v77
  v_mfma_f32_16x16x32_bf16 v[208:211], a[252:255], a[56:59], v[208:211]
  buffer_load_dword v2, v49, s[8:11], s60 offen offset:128 sc1
  v_mul_f32 v142, v182, v78
  v_mfma_f32_16x16x32_bf16 v[204:207], a[252:255], a[80:83], v[204:207]
  v_mul_f32 v143, v182, v79
  v_mfma_f32_16x16x32_bf16 v[200:203], a[252:255], a[76:79], v[200:203]
  buffer_load_dwordx2 v[60:61], v3, s[4:7], s55 offen offset:256 sc1
  v_fmac_f32_dpp v140, v76, v183 row_ror:8 row_mask:0xf bank_mask:0xf
  v_mfma_f32_16x16x32_bf16 v[196:199], a[252:255], a[36:39], v[196:199]
  s_waitcnt lgkmcnt(0)
  v_fmac_f32_dpp v141, v77, v183 row_ror:8 row_mask:0xf bank_mask:0xf
  v_mfma_f32_16x16x32_bf16 v[136:139], a[212:215], a[60:63], v[136:139]
  buffer_load_dword v71, v49, s[8:11], s60 offen offset:256 sc1
  v_fmac_f32_dpp v142, v78, v183 row_ror:8 row_mask:0xf bank_mask:0xf
  v_mfma_f32_16x16x32_bf16 v[148:151], a[212:215], a[92:95], v[148:151]
  v_fmac_f32_dpp v143, v79, v183 row_ror:8 row_mask:0xf bank_mask:0xf
  v_mfma_f32_16x16x32_bf16 v[164:167], a[212:215], a[96:99], v[164:167]
  ds_read_b64_tr_b16 a[164:165], v52 offset:14336
  buffer_load_dwordx2 v[180:181], v3, s[4:7], s55 offen offset:384 sc1
  v_mfma_f32_16x16x32_bf16 v[168:171], a[212:215], a[20:23], v[168:171]
  ds_read_b64_tr_b16 a[166:167], v51 offset:30720
  v_mul_f32 v212, v182, v96
  v_mfma_f32_16x16x32_bf16 v[152:155], a[232:235], a[20:23], v[152:155]
  ds_read_b64_tr_b16 a[216:217], v52 offset:55296
  v_mul_f32 v213, v182, v97
  v_mfma_f32_16x16x32_bf16 v[188:191], a[232:235], a[96:99], v[188:191]
  ds_read_b64_tr_b16 a[218:219], v68 offset:6144
  buffer_load_dword v4, v49, s[8:11], s60 offen offset:384 sc1
  v_mfma_f32_16x16x32_bf16 v[184:187], a[232:235], a[92:95], v[184:187]
  ds_read_b64_tr_b16 a[248:249], v67 offset:14336
  v_mul_f32 v214, v182, v98
  v_mfma_f32_16x16x32_bf16 v[176:179], a[232:235], a[60:63], v[176:179]
  ds_read_b64_tr_b16 a[250:251], v69 offset:30720
  v_mul_f32 v215, v182, v99
  v_mfma_f32_16x16x32_bf16 v[72:75], a[148:151], a[60:63], v[72:75]
  ds_read_b64_tr_b16 a[212:213], v67 offset:55296
  buffer_load_dwordx2 v[54:55], v3, s[4:7], s55 offen offset:512 sc1
  v_mfma_f32_16x16x32_bf16 v[84:87], a[148:151], a[92:95], v[84:87]
  ds_read_b64_tr_b16 a[214:215], v70 offset:6144
  v_fmac_f32_dpp v212, v96, v183 row_ror:8 row_mask:0xf bank_mask:0xf
  v_mfma_f32_16x16x32_bf16 v[156:159], a[148:151], a[96:99], v[156:159]
  buffer_load_dwordx4 v63, s[24:27], s1 offen offset:0 lds
  v_fmac_f32_dpp v213, v97, v183 row_ror:8 row_mask:0xf bank_mask:0xf
  v_mfma_f32_16x16x32_bf16 v[192:195], a[148:151], a[20:23], v[192:195]
  v_mfma_f32_16x16x32_bf16 v[208:211], a[244:247], a[20:23], v[208:211]
  buffer_load_dword v6, v49, s[8:11], s60 offen offset:512 sc1
  v_fmac_f32_dpp v214, v98, v183 row_ror:8 row_mask:0xf bank_mask:0xf
  v_mfma_f32_16x16x32_bf16 v[204:207], a[244:247], a[96:99], v[204:207]
  v_fmac_f32_dpp v215, v99, v183 row_ror:8 row_mask:0xf bank_mask:0xf
  v_mfma_f32_16x16x32_bf16 v[200:203], a[244:247], a[92:95], v[200:203]
  buffer_load_dwordx2 v[80:81], v3, s[4:7], s55 offen offset:640 sc1
  v_mul_f32 v76, v182, v128
  v_mfma_f32_16x16x32_bf16 v[196:199], a[244:247], a[60:63], v[196:199]
  s_waitcnt lgkmcnt(0)
  v_mul_f32 v77, v182, v129
  v_mfma_f32_16x16x32_bf16 v[136:139], a[164:167], a[72:75], v[136:139]
  buffer_load_dword v53, v49, s[8:11], s60 offen offset:640 sc1
  v_mul_f32 v78, v182, v130
  v_mfma_f32_16x16x32_bf16 v[148:151], a[164:167], a[108:111], v[148:151]
  v_mul_f32 v79, v182, v131
  v_mfma_f32_16x16x32_bf16 v[164:167], a[164:167], a[112:115], v[164:167]
  ds_read_b64_tr_b16 a[148:149], v52 offset:8192
  buffer_load_dwordx2 v[96:97], v3, s[4:7], s55 offen offset:768 sc1
  v_mfma_f32_16x16x32_bf16 v[168:171], a[164:167], a[100:103], v[168:171]
  ds_read_b64_tr_b16 a[150:151], v51 offset:24576
  v_fmac_f32_dpp v76, v128, v183 row_ror:8 row_mask:0xf bank_mask:0xf
  v_mfma_f32_16x16x32_bf16 v[152:155], a[216:219], a[100:103], v[152:155]
  ds_read_b64_tr_b16 a[232:233], v52 offset:49152
  buffer_load_dwordx4 v56, s[24:27], s1 offen offset:1024 lds
  v_mfma_f32_16x16x32_bf16 v[188:191], a[216:219], a[112:115], v[188:191]
  ds_read_b64_tr_b16 a[234:235], v68 offset:0
  v_fmac_f32_dpp v77, v129, v183 row_ror:8 row_mask:0xf bank_mask:0xf
  v_mfma_f32_16x16x32_bf16 v[184:187], a[216:219], a[108:111], v[184:187]
  ds_read_b64_tr_b16 a[244:245], v67 offset:8192
  buffer_load_dword v82, v49, s[8:11], s60 offen offset:768 sc1
  v_mfma_f32_16x16x32_bf16 v[176:179], a[216:219], a[72:75], v[176:179]
  ds_read_b64_tr_b16 a[246:247], v69 offset:24576
  v_fmac_f32_dpp v78, v130, v183 row_ror:8 row_mask:0xf bank_mask:0xf
  v_mfma_f32_16x16x32_bf16 v[72:75], a[248:251], a[72:75], v[72:75]
  ds_read_b64_tr_b16 a[164:165], v67 offset:49152
  buffer_load_dwordx4 v57, s[24:27], s1 offen offset:2048 lds
  v_mfma_f32_16x16x32_bf16 v[84:87], a[248:251], a[108:111], v[84:87]
  ds_read_b64_tr_b16 a[166:167], v70 offset:0
  v_fmac_f32_dpp v79, v131, v183 row_ror:8 row_mask:0xf bank_mask:0xf
  v_mfma_f32_16x16x32_bf16 v[156:159], a[248:251], a[112:115], v[156:159]
  buffer_load_dwordx2 v[98:99], v3, s[4:7], s55 offen offset:896 sc1
  v_mul_f32 v236, v182, v132
  v_mfma_f32_16x16x32_bf16 v[192:195], a[248:251], a[100:103], v[192:195]
  v_mul_f32 v237, v182, v133
  v_mfma_f32_16x16x32_bf16 v[208:211], a[212:215], a[100:103], v[208:211]
  buffer_load_dword v65, v49, s[8:11], s60 offen offset:896 sc1
  v_mul_f32 v238, v182, v134
  v_mfma_f32_16x16x32_bf16 v[204:207], a[212:215], a[112:115], v[204:207]
  v_mul_f32 v239, v182, v135
  v_mfma_f32_16x16x32_bf16 v[200:203], a[212:215], a[108:111], v[200:203]
  buffer_load_dwordx2 v[128:129], v3, s[4:7], s55 offen offset:1024 sc1
  v_fmac_f32_dpp v236, v132, v183 row_ror:8 row_mask:0xf bank_mask:0xf
  v_mfma_f32_16x16x32_bf16 v[196:199], a[212:215], a[72:75], v[196:199]
  s_waitcnt lgkmcnt(0)
  v_fmac_f32_dpp v237, v133, v183 row_ror:8 row_mask:0xf bank_mask:0xf
  v_mfma_f32_16x16x32_bf16 v[136:139], a[148:151], a[88:91], v[136:139]
  buffer_load_dword v66, v49, s[8:11], s60 offen offset:1024 sc1
  v_fmac_f32_dpp v238, v134, v183 row_ror:8 row_mask:0xf bank_mask:0xf
  v_mfma_f32_16x16x32_bf16 v[148:151], a[148:151], a[124:127], v[148:151]
  v_fmac_f32_dpp v239, v135, v183 row_ror:8 row_mask:0xf bank_mask:0xf
  v_mfma_f32_16x16x32_bf16 v[164:167], a[148:151], a[116:119], v[164:167]
  ds_read_b64_tr_b16 a[216:217], v52 offset:10240
  buffer_load_dwordx4 v64, s[24:27], s1 offen offset:3072 lds
  v_mfma_f32_16x16x32_bf16 v[168:171], a[148:151], a[24:27], v[168:171]
  s_add_u32 m0, s0, 0x6000
  s_add_u32 s1, s48, 0x3f0080
  ds_read_b64_tr_b16 a[218:219], v51 offset:26624
  v_mfma_f32_16x16x32_bf16 v[152:155], a[232:235], a[24:27], v[152:155]
  ds_read_b64_tr_b16 a[212:213], v52 offset:51200
  v_mfma_f32_16x16x32_bf16 v[188:191], a[232:235], a[116:119], v[188:191]
  ds_read_b64_tr_b16 a[214:215], v68 offset:2048
  buffer_load_dwordx4 v63, s[24:27], s1 offen offset:0 lds
  v_mfma_f32_16x16x32_bf16 v[184:187], a[232:235], a[124:127], v[184:187]
  ds_read_b64_tr_b16 a[248:249], v67 offset:10240
  v_mfma_f32_16x16x32_bf16 v[176:179], a[232:235], a[88:91], v[176:179]
  ds_read_b64_tr_b16 a[250:251], v69 offset:26624
  v_mfma_f32_16x16x32_bf16 v[72:75], a[244:247], a[88:91], v[72:75]
  ds_read_b64_tr_b16 a[148:149], v67 offset:51200
  buffer_load_dwordx4 v56, s[24:27], s1 offen offset:1024 lds
  v_mfma_f32_16x16x32_bf16 v[84:87], a[244:247], a[124:127], v[84:87]
  ds_read_b64_tr_b16 a[150:151], v70 offset:2048
  v_mfma_f32_16x16x32_bf16 v[156:159], a[244:247], a[116:119], v[156:159]
  ds_read_b64 v[130:131], v83 offset:38400
  v_mfma_f32_16x16x32_bf16 v[192:195], a[244:247], a[24:27], v[192:195]
  buffer_load_dwordx4 v57, s[24:27], s1 offen offset:2048 lds
  ds_read_b64 v[182:183], v83 offset:38528
  v_mfma_f32_16x16x32_bf16 v[208:211], a[164:167], a[24:27], v[208:211]
  ds_read_b64 v[132:133], v83 offset:38656
  v_mfma_f32_16x16x32_bf16 v[204:207], a[164:167], a[116:119], v[204:207]
  v_mfma_f32_16x16x32_bf16 v[200:203], a[164:167], a[124:127], v[200:203]
  buffer_load_dwordx4 v64, s[24:27], s1 offen offset:3072 lds
  s_add_u32 m0, s0, 0
  v_mfma_f32_16x16x32_bf16 v[196:199], a[164:167], a[88:91], v[196:199]
  s_waitcnt lgkmcnt(3)
  s_add_u32 s1, s48, 0x480080
  v_mfma_f32_16x16x32_bf16 v[136:139], a[216:219], a[104:107], v[136:139]
  v_mfma_f32_16x16x32_bf16 v[148:151], a[216:219], a[140:143], v[148:151]
  s_waitcnt vmcnt(24)
  s_barrier
  v_mfma_f32_16x16x32_bf16 v[164:167], a[216:219], a[144:147], v[164:167]
  ds_read_b64_tr_b16 a[232:233], v52 offset:16384
  buffer_load_dwordx4 v63, s[24:27], s1 offen offset:0 lds
  v_mfma_f32_16x16x32_bf16 v[168:171], a[216:219], a[28:31], v[168:171]
  ds_read_b64_tr_b16 a[234:235], v51 offset:32768
  v_mfma_f32_16x16x32_bf16 v[152:155], a[212:215], a[28:31], v[152:155]
  ds_read_b64_tr_b16 a[164:165], v52 offset:57344
  v_mfma_f32_16x16x32_bf16 v[188:191], a[212:215], a[144:147], v[188:191]
  ds_read_b64_tr_b16 a[166:167], v68 offset:8192
  buffer_load_dwordx4 v56, s[24:27], s1 offen offset:1024 lds
  v_mfma_f32_16x16x32_bf16 v[184:187], a[212:215], a[140:143], v[184:187]
  ds_read_b64_tr_b16 a[244:245], v67 offset:16384
  v_mfma_f32_16x16x32_bf16 v[176:179], a[212:215], a[104:107], v[176:179]
  ds_read_b64_tr_b16 a[246:247], v69 offset:32768
  v_mfma_f32_16x16x32_bf16 v[72:75], a[248:251], a[104:107], v[72:75]
  ds_read_b64_tr_b16 a[216:217], v67 offset:57344
  buffer_load_dwordx4 v57, s[24:27], s1 offen offset:2048 lds
  v_mfma_f32_16x16x32_bf16 v[84:87], a[248:251], a[140:143], v[84:87]
  ds_read_b64_tr_b16 a[218:219], v70 offset:8192
  v_mfma_f32_16x16x32_bf16 v[156:159], a[248:251], a[144:147], v[156:159]
  v_mfma_f32_16x16x32_bf16 v[192:195], a[248:251], a[28:31], v[192:195]
  buffer_load_dwordx4 v64, s[24:27], s1 offen offset:3072 lds
  s_add_u32 m0, s0, 0x7000
  v_mfma_f32_16x16x32_bf16 v[208:211], a[148:151], a[28:31], v[208:211]
  s_add_u32 s1, s48, 0x100
  v_mfma_f32_16x16x32_bf16 v[204:207], a[148:151], a[144:147], v[204:207]
  v_mfma_f32_16x16x32_bf16 v[200:203], a[148:151], a[140:143], v[200:203]
  v_mfma_f32_16x16x32_bf16 v[196:199], a[148:151], a[104:107], v[196:199]
  s_waitcnt lgkmcnt(0)
  v_mfma_f32_16x16x32_bf16 v[136:139], a[232:235], a[120:123], v[136:139]
  v_mfma_f32_16x16x32_bf16 v[148:151], a[232:235], a[156:159], v[148:151]
  v_mfma_f32_16x16x32_bf16 v[164:167], a[232:235], a[160:163], v[164:167]
  ds_read_b64_tr_b16 a[212:213], v52 offset:18432
  v_mfma_f32_16x16x32_bf16 v[168:171], a[232:235], a[84:87], v[168:171]
  ds_read_b64_tr_b16 a[214:215], v51 offset:34816
  v_mfma_f32_16x16x32_bf16 v[152:155], a[164:167], a[84:87], v[152:155]
  ds_read_b64_tr_b16 a[248:249], v52 offset:59392
  v_mfma_f32_16x16x32_bf16 v[188:191], a[164:167], a[160:163], v[188:191]
  ds_read_b64_tr_b16 a[250:251], v68 offset:10240
  v_mfma_f32_16x16x32_bf16 v[184:187], a[164:167], a[156:159], v[184:187]
  ds_read_b64_tr_b16 a[148:149], v67 offset:18432
  v_mfma_f32_16x16x32_bf16 v[176:179], a[164:167], a[120:123], v[176:179]
  ds_read_b64_tr_b16 a[150:151], v69 offset:34816
  v_mfma_f32_16x16x32_bf16 v[72:75], a[244:247], a[120:123], v[72:75]
  ds_read_b64_tr_b16 a[252:253], v67 offset:59392
  v_mfma_f32_16x16x32_bf16 v[84:87], a[244:247], a[156:159], v[84:87]
  ds_read_b64_tr_b16 a[254:255], v70 offset:10240
  v_mfma_f32_16x16x32_bf16 v[156:159], a[244:247], a[160:163], v[156:159]
  v_mfma_f32_16x16x32_bf16 v[192:195], a[244:247], a[84:87], v[192:195]
  v_mfma_f32_16x16x32_bf16 v[208:211], a[216:219], a[84:87], v[208:211]
  v_mfma_f32_16x16x32_bf16 v[204:207], a[216:219], a[160:163], v[204:207]
  v_mfma_f32_16x16x32_bf16 v[200:203], a[216:219], a[156:159], v[200:203]
  v_mfma_f32_16x16x32_bf16 v[196:199], a[216:219], a[120:123], v[196:199]
  s_waitcnt lgkmcnt(0)
  v_mfma_f32_16x16x32_bf16 v[136:139], a[212:215], a[136:139], v[136:139]
  v_mfma_f32_16x16x32_bf16 v[148:151], a[212:215], a[172:175], v[148:151]
  v_mfma_f32_16x16x32_bf16 v[164:167], a[212:215], a[176:179], v[164:167]
  s_waitcnt vmcnt(26)
  ds_read_b64_tr_b16 a[164:165], v52 offset:4096
  v_max3_u32 v134, v58, v59, v2
  v_mfma_f32_16x16x32_bf16 v[168:171], a[212:215], a[128:131], v[168:171]
  ds_read_b64_tr_b16 a[166:167], v51 offset:20480
  buffer_load_dwordx4 v63, s[24:27], s1 offen offset:0 lds
  v_mfma_f32_16x16x32_bf16 v[152:155], a[248:251], a[128:131], v[152:155]
  s_waitcnt vmcnt(26)
  ds_read_b64_tr_b16 a[232:233], v52 offset:45056
  v_max3_u32 v134, v134, v60, v61
  v_mfma_f32_16x16x32_bf16 v[188:191], a[248:251], a[176:179], v[188:191]
  s_lshl_b32 s50, s51, 6
  s_add_u32 s50, s50, s53
  ds_read_b64_tr_b16 a[234:235], v51 offset:61440
  v_mfma_f32_16x16x32_bf16 v[184:187], a[248:251], a[172:175], v[184:187]
  s_lshl1_add_u32 s50, s50, s42
  s_mul_i32 s50, s50, 0x2880
  ds_read_b64_tr_b16 a[212:213], v67 offset:4096
  v_mfma_f32_16x16x32_bf16 v[176:179], a[248:251], a[136:139], v[176:179]
  s_mul_i32 s56, s53, 0x2880
  s_lshl_b32 s57, s51, 8
  ds_read_b64_tr_b16 a[214:215], v69 offset:20480
  v_mfma_f32_16x16x32_bf16 v[72:75], a[148:151], a[136:139], v[72:75]
  s_add_u32 s57, s56, s57
  ds_read_b64_tr_b16 a[216:217], v67 offset:45056
  buffer_load_dwordx4 v56, s[24:27], s1 offen offset:1024 lds
  v_mfma_f32_16x16x32_bf16 v[84:87], a[148:151], a[172:175], v[84:87]
  ds_read_b64_tr_b16 a[218:219], v69 offset:61440
  v_lshrrev_b32 v50, 3, v50
  v_mfma_f32_16x16x32_bf16 v[156:159], a[148:151], a[176:179], v[156:159]
  s_waitcnt vmcnt(24)
  v_max3_u32 v134, v134, v71, v180
  v_max3_u32 v134, v134, v181, v4
  v_mfma_f32_16x16x32_bf16 v[192:195], a[148:151], a[128:131], v[192:195]
  s_waitcnt vmcnt(20)
  v_max3_u32 v134, v134, v54, v55
  v_max3_u32 v134, v134, v6, v80
  v_mfma_f32_16x16x32_bf16 v[208:211], a[252:255], a[128:131], v[208:211]
  s_waitcnt vmcnt(19)
  buffer_load_dwordx4 v57, s[24:27], s1 offen offset:2048 lds
  v_max3_u32 v134, v134, v81, v53
  v_mfma_f32_16x16x32_bf16 v[204:207], a[252:255], a[176:179], v[204:207]
  s_waitcnt vmcnt(15)
  v_max3_u32 v134, v134, v96, v97
  v_max3_u32 v134, v134, v82, v98
  v_mfma_f32_16x16x32_bf16 v[200:203], a[252:255], a[172:175], v[200:203]
  s_waitcnt vmcnt(13)
  v_max3_u32 v134, v134, v99, v65
  v_max3_u32 v134, v134, v128, v129
  v_mfma_f32_16x16x32_bf16 v[196:199], a[252:255], a[136:139], v[196:199]
  s_waitcnt lgkmcnt(0)
  s_bfe_u32 s52, s2, 0x10002
  s_mul_i32 s52, s52, 0x200
  v_mfma_f32_16x16x32_bf16 v[136:139], a[164:167], a[152:155], v[136:139]
  s_waitcnt vmcnt(12)
  s_add_u32 s52, s50, s52
  v_lshlrev_b32 v135, 3, v62
  v_max_u32 v134, v134, v66
  v_mfma_f32_16x16x32_bf16 v[148:151], a[164:167], a[188:191], v[148:151]
  buffer_load_dwordx4 v64, s[24:27], s1 offen offset:3072 lds
  s_add_u32 m0, s0, 0x2000
  v_mfma_f32_16x16x32_bf16 v[164:167], a[164:167], a[192:195], v[164:167]
  s_add_u32 s1, s48, 0x90100
  ds_read_b64_tr_b16 a[148:149], v52 offset:6144
  v_cmp_eq_u32 vcc, -1, v134
  v_mfma_f32_16x16x32_bf16 v[168:171], a[164:167], a[180:183], v[168:171]
  s_cbranch_vccnz L_ra
L_ba:
  ds_read_b64_tr_b16 a[150:151], v51 offset:22528
  v_fma_f32 v3, v130, v128, v98
  v_mfma_f32_16x16x32_bf16 v[152:155], a[232:235], a[180:183], v[152:155]
  ds_read_b64_tr_b16 a[244:245], v52 offset:47104
  v_fma_f32 v49, v182, v129, v99
  v_mfma_f32_16x16x32_bf16 v[188:191], a[232:235], a[192:195], v[188:191]
  ds_read_b64_tr_b16 a[246:247], v51 offset:63488
  v_fma_f32 v65, v132, v66, v65
  v_mfma_f32_16x16x32_bf16 v[184:187], a[232:235], a[188:191], v[184:187]
  ds_read_b64_tr_b16 a[164:165], v67 offset:6144
  buffer_load_dwordx4 v63, s[24:27], s1 offen offset:0 lds
  v_mfma_f32_16x16x32_bf16 v[176:179], a[232:235], a[152:155], v[176:179]
  ds_read_b64_tr_b16 a[166:167], v69 offset:22528
  v_fmac_f32_dpp v3, v128, v131 row_ror:8 row_mask:0xf bank_mask:0xf
  v_mfma_f32_16x16x32_bf16 v[72:75], a[212:215], a[152:155], v[72:75]
  ds_read_b64_tr_b16 a[248:249], v67 offset:47104
  v_fmac_f32_dpp v49, v129, v183 row_ror:8 row_mask:0xf bank_mask:0xf
  v_mfma_f32_16x16x32_bf16 v[84:87], a[212:215], a[188:191], v[84:87]
  ds_read_b64_tr_b16 a[250:251], v69 offset:63488
  v_fmac_f32_dpp v65, v66, v133 row_ror:8 row_mask:0xf bank_mask:0xf
  v_mfma_f32_16x16x32_bf16 v[156:159], a[212:215], a[192:195], v[156:159]
  buffer_load_dwordx4 v56, s[24:27], s1 offen offset:1024 lds
  v_fma_f32 v66, v130, v3, v96
  v_mfma_f32_16x16x32_bf16 v[192:195], a[212:215], a[180:183], v[192:195]
  v_fma_f32 v134, v182, v49, v97
  v_fma_f32 v82, v132, v65, v82
  v_mfma_f32_16x16x32_bf16 v[208:211], a[216:219], a[180:183], v[208:211]
  v_fmac_f32_dpp v66, v3, v131 row_ror:8 row_mask:0xf bank_mask:0xf
  v_fmac_f32_dpp v134, v49, v183 row_ror:8 row_mask:0xf bank_mask:0xf
  v_mfma_f32_16x16x32_bf16 v[204:207], a[216:219], a[192:195], v[204:207]
  buffer_load_dwordx4 v57, s[24:27], s1 offen offset:2048 lds
  v_fmac_f32_dpp v82, v65, v133 row_ror:8 row_mask:0xf bank_mask:0xf
  v_mfma_f32_16x16x32_bf16 v[200:203], a[216:219], a[188:191], v[200:203]
  v_fma_f32 v3, v130, v66, v80
  v_fma_f32 v49, v182, v134, v81
  v_mfma_f32_16x16x32_bf16 v[196:199], a[216:219], a[152:155], v[196:199]
  s_waitcnt lgkmcnt(0)
  v_fma_f32 v53, v132, v82, v53
  v_fmac_f32_dpp v3, v66, v131 row_ror:8 row_mask:0xf bank_mask:0xf
  v_mfma_f32_16x16x32_bf16 v[136:139], a[148:151], a[168:171], v[136:139]
  buffer_load_dwordx4 v64, s[24:27], s1 offen offset:3072 lds
  s_add_u32 m0, s0, 0x3000
  v_mfma_f32_16x16x32_bf16 v[148:151], a[148:151], a[204:207], v[148:151]
  s_waitcnt vmcnt(8)
  s_barrier
  v_mfma_f32_16x16x32_bf16 v[164:167], a[148:151], a[196:199], v[164:167]
  s_add_u32 s1, s48, 0x120100
  ds_read_b64_tr_b16 a[212:213], v52 offset:20480
  v_fmac_f32_dpp v49, v134, v183 row_ror:8 row_mask:0xf bank_mask:0xf
  v_mfma_f32_16x16x32_bf16 v[168:171], a[148:151], a[208:211], v[168:171]
  ds_read_b64_tr_b16 a[214:215], v51 offset:36864
  buffer_load_dword v1, v50, s[28:31], s52 offen offset:0
  v_mfma_f32_16x16x32_bf16 v[152:155], a[244:247], a[208:211], v[152:155]
  ds_read_b64_tr_b16 a[216:217], v52 offset:61440
  v_fmac_f32_dpp v53, v82, v133 row_ror:8 row_mask:0xf bank_mask:0xf
  v_mfma_f32_16x16x32_bf16 v[188:191], a[244:247], a[196:199], v[188:191]
  ds_read_b64_tr_b16 a[218:219], v68 offset:12288
  buffer_load_dword v1, v50, s[28:31], s52 offen offset:128
  v_mfma_f32_16x16x32_bf16 v[184:187], a[244:247], a[204:207], v[184:187]
  ds_read_b64_tr_b16 a[232:233], v67 offset:20480
  v_fma_f32 v134, v130, v3, v54
  v_mfma_f32_16x16x32_bf16 v[176:179], a[244:247], a[168:171], v[176:179]
  ds_read_b64_tr_b16 a[234:235], v69 offset:36864
  buffer_load_dword v1, v50, s[28:31], s52 offen offset:256
  v_mfma_f32_16x16x32_bf16 v[72:75], a[164:167], a[168:171], v[72:75]
  ds_read_b64_tr_b16 a[148:149], v67 offset:61440
  v_fma_f32 v54, v182, v49, v55
  v_mfma_f32_16x16x32_bf16 v[84:87], a[164:167], a[204:207], v[84:87]
  ds_read_b64_tr_b16 a[150:151], v70 offset:12288
  buffer_load_dword v1, v50, s[28:31], s52 offen offset:384
  v_mfma_f32_16x16x32_bf16 v[156:159], a[164:167], a[196:199], v[156:159]
  v_fma_f32 v6, v132, v53, v6
  v_fmac_f32_dpp v134, v3, v131 row_ror:8 row_mask:0xf bank_mask:0xf
  v_mfma_f32_16x16x32_bf16 v[192:195], a[164:167], a[208:211], v[192:195]
  buffer_load_dword v1, v50, s[28:31], s50 offen offset:1024
  v_fmac_f32_dpp v54, v49, v183 row_ror:8 row_mask:0xf bank_mask:0xf
  v_mfma_f32_16x16x32_bf16 v[208:211], a[248:251], a[208:211], v[208:211]
  v_fmac_f32_dpp v6, v53, v133 row_ror:8 row_mask:0xf bank_mask:0xf
  v_fma_f32 v3, v130, v134, v180
  v_mfma_f32_16x16x32_bf16 v[204:207], a[248:251], a[196:199], v[204:207]
  buffer_load_dword v1, v135, s[20:23], 0 offen offset:0
  v_fma_f32 v49, v182, v54, v181
  v_mfma_f32_16x16x32_bf16 v[200:203], a[248:251], a[204:207], v[200:203]
  v_fma_f32 v4, v132, v6, v4
  v_fmac_f32_dpp v3, v134, v131 row_ror:8 row_mask:0xf bank_mask:0xf
  v_mfma_f32_16x16x32_bf16 v[196:199], a[248:251], a[168:171], v[196:199]
  s_waitcnt lgkmcnt(0)
  v_fmac_f32_dpp v49, v54, v183 row_ror:8 row_mask:0xf bank_mask:0xf
  v_fmac_f32_dpp v4, v6, v133 row_ror:8 row_mask:0xf bank_mask:0xf
  v_mfma_f32_16x16x32_bf16 v[136:139], a[212:215], a[184:187], v[136:139]
  v_fma_f32 v6, v130, v3, v60
  v_fma_f32 v60, v182, v49, v61
  v_mfma_f32_16x16x32_bf16 v[148:151], a[212:215], a[220:223], v[148:151]
  v_fma_f32 v61, v132, v4, v71
  v_fmac_f32_dpp v6, v3, v131 row_ror:8 row_mask:0xf bank_mask:0xf
  v_mfma_f32_16x16x32_bf16 v[164:167], a[212:215], a[224:227], v[164:167]
  ds_read_b64_tr_b16 a[164:165], v52 offset:22528
  v_fmac_f32_dpp v60, v49, v183 row_ror:8 row_mask:0xf bank_mask:0xf
  v_mfma_f32_16x16x32_bf16 v[168:171], a[212:215], a[132:135], v[168:171]
  ds_read_b64_tr_b16 a[166:167], v51 offset:38912
  v_fmac_f32_dpp v61, v4, v133 row_ror:8 row_mask:0xf bank_mask:0xf
  v_mfma_f32_16x16x32_bf16 v[152:155], a[216:219], a[132:135], v[152:155]
  ds_read_b64_tr_b16 a[244:245], v52 offset:63488
  v_fma_f32 v3, v130, v6, v58
  v_mfma_f32_16x16x32_bf16 v[188:191], a[216:219], a[224:227], v[188:191]
  ds_read_b64_tr_b16 a[246:247], v68 offset:14336
  v_fma_f32 v4, v182, v60, v59
  v_mfma_f32_16x16x32_bf16 v[184:187], a[216:219], a[220:223], v[184:187]
  ds_read_b64_tr_b16 a[248:249], v67 offset:22528
  v_fma_f32 v2, v132, v61, v2
  v_mfma_f32_16x16x32_bf16 v[176:179], a[216:219], a[184:187], v[176:179]
  ds_read_b64_tr_b16 a[250:251], v69 offset:38912
  v_fmac_f32_dpp v3, v6, v131 row_ror:8 row_mask:0xf bank_mask:0xf
  v_mfma_f32_16x16x32_bf16 v[72:75], a[232:235], a[184:187], v[72:75]
  ds_read_b64_tr_b16 a[212:213], v67 offset:63488
  v_fmac_f32_dpp v4, v60, v183 row_ror:8 row_mask:0xf bank_mask:0xf
  v_mfma_f32_16x16x32_bf16 v[84:87], a[232:235], a[220:223], v[84:87]
  ds_read_b64_tr_b16 a[214:215], v70 offset:14336
  v_fmac_f32_dpp v2, v61, v133 row_ror:8 row_mask:0xf bank_mask:0xf
  v_mfma_f32_16x16x32_bf16 v[156:159], a[232:235], a[224:227], v[156:159]
  buffer_load_dwordx4 v63, s[24:27], s1 offen offset:0 lds
  ds_read_b64 v[58:59], v83 offset:38912
  v_mfma_f32_16x16x32_bf16 v[192:195], a[232:235], a[132:135], v[192:195]
  ds_read_b64 v[60:61], v83 offset:39040
  v_mfma_f32_16x16x32_bf16 v[208:211], a[148:151], a[132:135], v[208:211]
  ds_read_b64 v[54:55], v83 offset:39168
  v_mfma_f32_16x16x32_bf16 v[204:207], a[148:151], a[224:227], v[204:207]
  ds_read_b64 v[80:81], v83 offset:37888
  v_mfma_f32_16x16x32_bf16 v[200:203], a[148:151], a[220:223], v[200:203]
  ds_read_b64 v[96:97], v83 offset:38016
  v_mfma_f32_16x16x32_bf16 v[196:199], a[148:151], a[184:187], v[196:199]
  s_waitcnt lgkmcnt(5)
  ds_read_b64 v[98:99], v83 offset:38144
  v_mfma_f32_16x16x32_bf16 v[136:139], a[164:167], a[200:203], v[136:139]
  ds_read_b64 v[128:129], v83 offset:37376
  v_mfma_f32_16x16x32_bf16 v[148:151], a[164:167], a[236:239], v[148:151]
  ds_read_b64 v[130:131], v83 offset:37504
  v_mfma_f32_16x16x32_bf16 v[164:167], a[164:167], a[240:243], v[164:167]
  ds_read_b64_tr_b16 a[216:217], v52 offset:24576
  v_mfma_f32_16x16x32_bf16 v[168:171], a[164:167], a[228:231], v[168:171]
  ds_read_b64_tr_b16 a[218:219], v51 offset:40960
  v_mfma_f32_16x16x32_bf16 v[152:155], a[244:247], a[228:231], v[152:155]
  ds_read_b64_tr_b16 a[148:149], v51 offset:0
  v_mfma_f32_16x16x32_bf16 v[188:191], a[244:247], a[240:243], v[188:191]
  ds_read_b64_tr_b16 a[150:151], v68 offset:16384
  v_mfma_f32_16x16x32_bf16 v[184:187], a[244:247], a[236:239], v[184:187]
  ds_read_b64_tr_b16 a[232:233], v67 offset:24576
  v_mfma_f32_16x16x32_bf16 v[176:179], a[244:247], a[200:203], v[176:179]
  ds_read_b64_tr_b16 a[234:235], v69 offset:40960
  v_mfma_f32_16x16x32_bf16 v[72:75], a[248:251], a[200:203], v[72:75]
  ds_read_b64_tr_b16 a[252:253], v69 offset:0
  v_mfma_f32_16x16x32_bf16 v[84:87], a[248:251], a[236:239], v[84:87]
  ds_read_b64_tr_b16 a[254:255], v70 offset:16384
  v_mfma_f32_16x16x32_bf16 v[156:159], a[248:251], a[240:243], v[156:159]
  ds_read_b64 v[132:133], v83 offset:37632
  v_mfma_f32_16x16x32_bf16 v[192:195], a[248:251], a[228:231], v[192:195]
  ds_bpermute_b32 v180, v7, v3 offset:0
  v_mfma_f32_16x16x32_bf16 v[208:211], a[212:215], a[228:231], v[208:211]
  ds_bpermute_b32 v181, v7, v3 offset:64
  v_mfma_f32_16x16x32_bf16 v[204:207], a[212:215], a[240:243], v[204:207]
  ds_bpermute_b32 v182, v7, v3 offset:128
  v_mfma_f32_16x16x32_bf16 v[200:203], a[212:215], a[236:239], v[200:203]
  ds_bpermute_b32 v183, v7, v3 offset:192
  v_mfma_f32_16x16x32_bf16 v[196:199], a[212:215], a[200:203], v[196:199]
  s_waitcnt lgkmcnt(5)
  ds_bpermute_b32 v240, v7, v4 offset:0
  v_mfma_f32_16x16x32_bf16 v[136:139], a[216:219], v[24:27], v[136:139]
  ds_bpermute_b32 v241, v7, v4 offset:64
  v_mfma_f32_16x16x32_bf16 v[148:151], a[216:219], v[8:11], v[148:151]
  ds_bpermute_b32 v242, v7, v4 offset:128
  v_mfma_f32_16x16x32_bf16 v[164:167], a[216:219], v[16:19], v[164:167]
  ds_read_b64_tr_b16 a[164:165], v52 offset:26624
  v_mfma_f32_16x16x32_bf16 v[168:171], a[216:219], v[28:31], v[168:171]
  ds_read_b64_tr_b16 a[166:167], v51 offset:43008
  v_mfma_f32_16x16x32_bf16 v[152:155], a[148:151], v[28:31], v[152:155]
  ds_read_b64_tr_b16 a[212:213], v51 offset:2048
  v_mfma_f32_16x16x32_bf16 v[188:191], a[148:151], v[16:19], v[188:191]
  ds_read_b64_tr_b16 a[214:215], v68 offset:18432
  v_mfma_f32_16x16x32_bf16 v[184:187], a[148:151], v[8:11], v[184:187]
  ds_read_b64_tr_b16 a[244:245], v52 offset:0
  v_mfma_f32_16x16x32_bf16 v[176:179], a[148:151], v[24:27], v[176:179]
  ds_read_b64_tr_b16 a[246:247], v51 offset:16384
  v_mfma_f32_16x16x32_bf16 v[72:75], a[232:235], v[24:27], v[72:75]
  ds_read_b64_tr_b16 a[248:249], v52 offset:40960
  v_mfma_f32_16x16x32_bf16 v[84:87], a[232:235], v[8:11], v[84:87]
  ds_read_b64_tr_b16 a[250:251], v51 offset:57344
  v_mfma_f32_16x16x32_bf16 v[156:159], a[232:235], v[16:19], v[156:159]
  ds_bpermute_b32 v243, v7, v4 offset:192
  v_mfma_f32_16x16x32_bf16 v[192:195], a[232:235], v[28:31], v[192:195]
  ds_bpermute_b32 v244, v7, v2 offset:0
  v_mfma_f32_16x16x32_bf16 v[208:211], a[252:255], v[28:31], v[208:211]
  ds_bpermute_b32 v245, v7, v2 offset:64
  v_mfma_f32_16x16x32_bf16 v[204:207], a[252:255], v[16:19], v[204:207]
  buffer_load_dwordx4 v56, s[24:27], s1 offen offset:1024 lds
  v_mfma_f32_16x16x32_bf16 v[200:203], a[252:255], v[8:11], v[200:203]
  ds_bpermute_b32 v246, v7, v2 offset:128
  v_mfma_f32_16x16x32_bf16 v[196:199], a[252:255], v[24:27], v[196:199]
  s_waitcnt lgkmcnt(4)
  ds_bpermute_b32 v247, v7, v2 offset:192
  v_mfma_f32_16x16x32_bf16 v[136:139], a[164:167], v[20:23], v[136:139]
  buffer_load_dwordx4 v57, s[24:27], s1 offen offset:2048 lds
  v_cmp_lt_u32 s[74:75], 0, v5
  v_mfma_f32_16x16x32_bf16 v[148:151], a[164:167], v[32:35], v[148:151]
  v_cmp_lt_u32 s[4:5], 1, v5
  v_cmp_lt_u32 s[6:7], 2, v5
  v_mfma_f32_16x16x32_bf16 v[164:167], a[164:167], v[12:15], v[164:167]
  ds_read_b64_tr_b16 a[148:149], v52 offset:2048
  v_mul_u32_u24 v49, 0x90, v48
  v_mfma_f32_16x16x32_bf16 v[168:171], a[164:167], v[36:39], v[168:171]
  ds_read_b64_tr_b16 a[150:151], v51 offset:18432
  buffer_load_dwordx4 v64, s[24:27], s1 offen offset:3072 lds
  v_mfma_f32_16x16x32_bf16 v[152:155], a[212:215], v[36:39], v[152:155]
  s_add_u32 m0, s0, 0x1000
  s_add_u32 s1, s48, 0x1b0100
  ds_read_b64_tr_b16 a[216:217], v52 offset:43008
  v_mfma_f32_16x16x32_bf16 v[188:191], a[212:215], v[12:15], v[188:191]
  ds_read_b64_tr_b16 a[218:219], v51 offset:59392
  v_lshl_add_u32 v49, v5, 5, v49
  v_mfma_f32_16x16x32_bf16 v[184:187], a[212:215], v[32:35], v[184:187]
  ds_read_b64_tr_b16 a[232:233], v67 offset:26624
  buffer_load_dwordx4 v63, s[24:27], s1 offen offset:0 lds
  v_mfma_f32_16x16x32_bf16 v[176:179], a[212:215], v[20:23], v[176:179]
  ds_read_b64_tr_b16 a[234:235], v69 offset:43008
  v_add_u32 v49, s0, v49
  v_mfma_f32_16x16x32_bf16 v[136:139], a[244:247], v[40:43], v[136:139]
  ds_read_b64_tr_b16 a[164:165], v69 offset:2048
  v_lshrrev_b32 v53, 6, v62
  v_mfma_f32_16x16x32_bf16 v[148:151], a[244:247], v[44:47], v[148:151]
  ds_read_b64_tr_b16 a[166:167], v70 offset:18432
  buffer_load_dwordx4 v56, s[24:27], s1 offen offset:1024 lds
  v_mfma_f32_16x16x32_bf16 v[164:167], a[244:247], v[88:91], v[164:167]
  v_mul_u32_u24 v53, 0x90, v53
  v_and_b32 v71, 3, v48
  v_mfma_f32_16x16x32_bf16 v[168:171], a[244:247], v[92:95], v[168:171]
  v_lshl_add_u32 v53, v71, 5, v53
  v_add_u32 v53, s0, v53
  v_mfma_f32_16x16x32_bf16 v[152:155], a[248:251], v[92:95], v[152:155]
  s_lshl_b32 s50, s3, 3
  buffer_load_dwordx4 v57, s[24:27], s1 offen offset:2048 lds
  v_add_u32 v71, s50, v53
  v_mfma_f32_16x16x32_bf16 v[188:191], a[248:251], v[88:91], v[188:191]
  s_waitcnt lgkmcnt(12)
  v_fma_f32 v2, v58, v183, v182
  v_fma_f32 v3, v60, v243, v242
  v_mfma_f32_16x16x32_bf16 v[184:187], a[248:251], v[44:47], v[184:187]
  s_waitcnt lgkmcnt(8)
  v_fma_f32 v4, v54, v247, v246
  v_fmac_f32_dpp v2, v183, v59 row_ror:8 row_mask:0xf bank_mask:0xf
  v_mfma_f32_16x16x32_bf16 v[176:179], a[248:251], v[40:43], v[176:179]
  s_waitcnt lgkmcnt(0)
  buffer_load_dwordx4 v64, s[24:27], s1 offen offset:3072 lds
  s_add_u32 m0, s0, 0x4000
  v_mfma_f32_16x16x32_bf16 v[136:139], a[148:151], v[100:103], v[136:139]
  s_add_u32 s1, s48, 0x240100
  v_fmac_f32_dpp v3, v243, v61 row_ror:8 row_mask:0xf bank_mask:0xf
  v_fmac_f32_dpp v4, v247, v55 row_ror:8 row_mask:0xf bank_mask:0xf
  v_mfma_f32_16x16x32_bf16 v[148:151], a[148:151], v[108:111], v[148:151]
  v_fma_f32 v6, v58, v2, v181
  v_fma_f32 v65, v60, v3, v241
  v_mfma_f32_16x16x32_bf16 v[164:167], a[148:151], v[120:123], v[164:167]
  ds_read_b64_tr_b16 a[212:213], v67 offset:0
  v_fma_f32 v66, v54, v4, v245
  v_mfma_f32_16x16x32_bf16 v[168:171], a[148:151], v[124:127], v[168:171]
  ds_read_b64_tr_b16 a[214:215], v69 offset:16384
  v_fmac_f32_dpp v6, v2, v59 row_ror:8 row_mask:0xf bank_mask:0xf
  v_mfma_f32_16x16x32_bf16 v[176:179], a[216:219], v[100:103], v[176:179]
  ds_read_b64_tr_b16 a[244:245], v67 offset:40960
  v_fmac_f32_dpp v65, v3, v61 row_ror:8 row_mask:0xf bank_mask:0xf
  v_mfma_f32_16x16x32_bf16 v[184:187], a[216:219], v[108:111], v[184:187]
  ds_read_b64_tr_b16 a[246:247], v69 offset:57344
  v_fmac_f32_dpp v66, v4, v55 row_ror:8 row_mask:0xf bank_mask:0xf
  v_mfma_f32_16x16x32_bf16 v[188:191], a[216:219], v[120:123], v[188:191]
  ds_read_b64_tr_b16 a[248:249], v67 offset:2048
  v_fma_f32 v4, v58, v6, v180
  v_mfma_f32_16x16x32_bf16 v[152:155], a[216:219], v[124:127], v[152:155]
  ds_read_b64_tr_b16 a[250:251], v69 offset:18432
  v_mul_f32 v136, v136, v176
  v_mfma_f32_16x16x32_bf16 v[72:75], a[232:235], v[20:23], v[72:75]
  ds_read_b64_tr_b16 a[148:149], v67 offset:43008
  v_mul_f32 v137, v137, v177
  v_mfma_f32_16x16x32_bf16 v[84:87], a[232:235], v[32:35], v[84:87]
  ds_read_b64_tr_b16 a[150:151], v69 offset:59392
  v_mul_f32 v138, v138, v178
  v_mfma_f32_16x16x32_bf16 v[156:159], a[232:235], v[12:15], v[156:159]
  v_mul_f32 v139, v139, v179
  v_cvt_pk_bf16_f32 v180, v136, v137
  v_mfma_f32_16x16x32_bf16 v[192:195], a[232:235], v[36:39], v[192:195]
  v_cvt_pk_bf16_f32 v181, v138, v139
  v_mul_f32 v148, v148, v184
  v_mfma_f32_16x16x32_bf16 v[208:211], a[164:167], v[36:39], v[208:211]
  v_mul_f32 v149, v149, v185
  v_mul_f32 v150, v150, v186
  v_mfma_f32_16x16x32_bf16 v[204:207], a[164:167], v[12:15], v[204:207]
  v_mul_f32 v151, v151, v187
  v_cvt_pk_bf16_f32 v248, v148, v149
  v_mfma_f32_16x16x32_bf16 v[200:203], a[164:167], v[32:35], v[200:203]
  v_cvt_pk_bf16_f32 v249, v150, v151
  v_mul_f32 v164, v164, v188
  v_mfma_f32_16x16x32_bf16 v[196:199], a[164:167], v[20:23], v[196:199]
  s_waitcnt lgkmcnt(0)
  v_mul_f32 v165, v165, v189
  v_mul_f32 v166, v166, v190
  v_mfma_f32_16x16x32_bf16 v[72:75], a[212:215], v[40:43], v[72:75]
  v_mul_f32 v167, v167, v191
  v_cvt_pk_bf16_f32 v136, v164, v165
  v_mfma_f32_16x16x32_bf16 v[84:87], a[212:215], v[44:47], v[84:87]
  s_waitcnt vmcnt(14)
  s_barrier
  v_mfma_f32_16x16x32_bf16 v[156:159], a[212:215], v[88:91], v[156:159]
  ds_read_b64_tr_b16 a[216:217], v52 offset:28672
  v_cvt_pk_bf16_f32 v137, v166, v167
  v_mfma_f32_16x16x32_bf16 v[192:195], a[212:215], v[92:95], v[192:195]
  ds_read_b64_tr_b16 a[218:219], v51 offset:45056
  v_mul_f32 v168, v168, v152
  v_mfma_f32_16x16x32_bf16 v[208:211], a[244:247], v[92:95], v[208:211]
  ds_read_b64_tr_b16 a[164:165], v51 offset:4096
  v_mul_f32 v169, v169, v153
  v_mfma_f32_16x16x32_bf16 v[204:207], a[244:247], v[88:91], v[204:207]
  s_add_u32 s50, s47, 0xffffd000
  s_add_u32 s60, s47, 0x45000
  ds_read_b64_tr_b16 a[166:167], v68 offset:20480
  v_mfma_f32_16x16x32_bf16 v[200:203], a[244:247], v[44:47], v[200:203]
  ds_read_b64_tr_b16 a[232:233], v52 offset:30720
  v_mul_f32 v170, v170, v154
  v_mfma_f32_16x16x32_bf16 v[196:199], a[244:247], v[40:43], v[196:199]
  ds_read_b64_tr_b16 a[234:235], v51 offset:47104
  v_mul_f32 v171, v171, v155
  v_mfma_f32_16x16x32_bf16 v[72:75], a[248:251], v[100:103], v[72:75]
  ds_read_b64_tr_b16 a[212:213], v51 offset:6144
  v_cvt_pk_bf16_f32 v148, v168, v169
  v_mfma_f32_16x16x32_bf16 v[84:87], a[248:251], v[108:111], v[84:87]
  ds_read_b64_tr_b16 a[214:215], v68 offset:22528
  v_cvt_pk_bf16_f32 v149, v170, v171
  v_mfma_f32_16x16x32_bf16 v[156:159], a[248:251], v[120:123], v[156:159]
  v_fma_f32 v2, v60, v65, v240
  v_fma_f32 v3, v54, v66, v244
  v_mfma_f32_16x16x32_bf16 v[192:195], a[248:251], v[124:127], v[192:195]
  v_fmac_f32_dpp v4, v6, v59 row_ror:8 row_mask:0xf bank_mask:0xf
  v_fmac_f32_dpp v2, v65, v61 row_ror:8 row_mask:0xf bank_mask:0xf
  v_mfma_f32_16x16x32_bf16 v[196:199], a[148:151], v[100:103], v[196:199]
  v_fmac_f32_dpp v3, v66, v55 row_ror:8 row_mask:0xf bank_mask:0xf
  v_fma_f32 v6, v80, v4, v224
  v_mfma_f32_16x16x32_bf16 v[200:203], a[148:151], v[108:111], v[200:203]
  v_fma_f32 v54, v96, v2, v228
  v_fma_f32 v55, v98, v3, v232
  v_mfma_f32_16x16x32_bf16 v[204:207], a[148:151], v[120:123], v[204:207]
  v_fmac_f32_dpp v6, v4, v81 row_ror:8 row_mask:0xf bank_mask:0xf
  v_fmac_f32_dpp v54, v2, v97 row_ror:8 row_mask:0xf bank_mask:0xf
  v_mfma_f32_16x16x32_bf16 v[208:211], a[148:151], v[124:127], v[208:211]
  s_waitcnt lgkmcnt(0)
  v_mul_f32 v72, v72, v196
  v_mul_f32 v73, v73, v197
  v_mfma_f32_16x16x32_bf16 v[152:155], a[216:219], a[0:3], 0
  v_mul_f32 v74, v74, v198
  v_mul_f32 v75, v75, v199
  v_mfma_f32_16x16x32_bf16 v[164:167], a[216:219], a[8:11], 0
  v_cvt_pk_bf16_f32 v182, v72, v73
  v_cvt_pk_bf16_f32 v183, v74, v75
  v_mfma_f32_16x16x32_bf16 v[168:171], a[216:219], a[12:15], 0
  ds_read_b64_tr_b16 a[244:245], v52 offset:8192
  v_mul_f32 v84, v84, v200
  v_mfma_f32_16x16x32_bf16 v[176:179], a[216:219], a[16:19], 0
  ds_read_b64_tr_b16 a[246:247], v51 offset:24576
  buffer_store_dwordx4 v[180:183], v62, s[36:39], s50 offen offset:0 sc1
  v_mfma_f32_16x16x32_bf16 v[184:187], a[164:167], a[0:3], 0
  ds_read_b64_tr_b16 a[148:149], v52 offset:49152
  v_mul_f32 v85, v85, v201
  v_mfma_f32_16x16x32_bf16 v[188:191], a[164:167], a[8:11], 0
  ds_read_b64_tr_b16 a[150:151], v68 offset:0
  v_mul_f32 v86, v86, v202
  v_mfma_f32_16x16x32_bf16 v[72:75], a[164:167], a[12:15], 0
  ds_read_b64_tr_b16 a[248:249], v67 offset:28672
  v_mul_f32 v87, v87, v203
  v_mfma_f32_16x16x32_bf16 v[196:199], a[164:167], a[16:19], 0
  ds_read_b64_tr_b16 a[250:251], v69 offset:45056
  v_cvt_pk_bf16_f32 v250, v84, v85
  v_mfma_f32_16x16x32_bf16 v[152:155], a[232:235], a[40:43], v[152:155]
  ds_read_b64_tr_b16 a[216:217], v69 offset:4096
  v_cvt_pk_bf16_f32 v251, v86, v87
  v_mfma_f32_16x16x32_bf16 v[164:167], a[232:235], a[4:7], v[164:167]
  ds_read_b64_tr_b16 a[218:219], v70 offset:20480
  v_mul_f32 v156, v156, v204
  v_mfma_f32_16x16x32_bf16 v[168:171], a[232:235], a[48:51], v[168:171]
  v_mul_f32 v157, v157, v205
  v_mul_f32 v158, v158, v206
  v_mfma_f32_16x16x32_bf16 v[176:179], a[232:235], a[52:55], v[176:179]
  v_mul_f32 v159, v159, v207
  v_cvt_pk_bf16_f32 v138, v156, v157
  v_mfma_f32_16x16x32_bf16 v[196:199], a[212:215], a[52:55], v[196:199]
  v_cvt_pk_bf16_f32 v139, v158, v159
  v_mul_f32 v192, v192, v208
  v_mfma_f32_16x16x32_bf16 v[72:75], a[212:215], a[48:51], v[72:75]
  buffer_load_dwordx4 v63, s[24:27], s1 offen offset:0 lds
  v_mul_f32 v193, v193, v209
  v_mfma_f32_16x16x32_bf16 v[188:191], a[212:215], a[4:7], v[188:191]
  v_mul_f32 v194, v194, v210
  v_mul_f32 v195, v195, v211
  v_mfma_f32_16x16x32_bf16 v[184:187], a[212:215], a[40:43], v[184:187]
  s_waitcnt lgkmcnt(0)
  buffer_store_dwordx4 v[248:251], v62, s[36:39], s50 offen offset:1024 sc1
  v_mfma_f32_16x16x32_bf16 v[152:155], a[244:247], a[32:35], v[152:155]
  v_cvt_pk_bf16_f32 v150, v192, v193
  v_cvt_pk_bf16_f32 v151, v194, v195
  v_mfma_f32_16x16x32_bf16 v[164:167], a[244:247], a[44:47], v[164:167]
  buffer_load_dwordx4 v56, s[24:27], s1 offen offset:1024 lds
  v_fmac_f32_dpp v55, v3, v99 row_ror:8 row_mask:0xf bank_mask:0xf
  v_mfma_f32_16x16x32_bf16 v[168:171], a[244:247], a[64:67], v[168:171]
  ds_read_b64_tr_b16 a[164:165], v67 offset:30720
  v_cndmask_b32 v4, v4, v6, s[74:75]
  v_mfma_f32_16x16x32_bf16 v[176:179], a[244:247], a[68:71], v[176:179]
  ds_read_b64_tr_b16 a[166:167], v69 offset:47104
  v_cndmask_b32 v2, v2, v54, s[74:75]
  v_mfma_f32_16x16x32_bf16 v[196:199], a[148:151], a[68:71], v[196:199]
  s_and_b32 s50, s63, 1
  ds_read_b64_tr_b16 a[212:213], v69 offset:6144
  buffer_store_dwordx4 v[136:139], v62, s[36:39], s60 offen offset:0 sc1
  v_mfma_f32_16x16x32_bf16 v[72:75], a[148:151], a[64:67], v[72:75]
  s_lshr_b32 s73, s63, 1
  ds_read_b64_tr_b16 a[214:215], v70 offset:22528
  v_cndmask_b32 v3, v3, v55, s[74:75]
  v_mfma_f32_16x16x32_bf16 v[188:191], a[148:151], a[44:47], v[188:191]
  s_xor_b32 s74, s42, s73
  ds_read_b64_tr_b16 a[232:233], v67 offset:8192
  buffer_load_dwordx4 v57, s[24:27], s1 offen offset:2048 lds
  v_mfma_f32_16x16x32_bf16 v[184:187], a[148:151], a[32:35], v[184:187]
  s_mul_i32 s75, s40, 0x24000
  ds_read_b64_tr_b16 a[234:235], v69 offset:24576
  v_fma_f32 v6, v80, v4, v225
  v_mfma_f32_16x16x32_bf16 v[84:87], a[248:251], a[0:3], 0
  s_lshl1_add_u32 s8, s51, s45
  ds_read_b64_tr_b16 a[244:245], v67 offset:49152
  v_fma_f32 v54, v96, v2, v229
  v_mfma_f32_16x16x32_bf16 v[136:139], a[248:251], a[8:11], 0
  s_lshl_b32 s8, s8, 7
  ds_read_b64_tr_b16 a[246:247], v70 offset:0
  buffer_load_dwordx4 v64, s[24:27], s1 offen offset:3072 lds
  v_mfma_f32_16x16x32_bf16 v[156:159], a[248:251], a[12:15], 0
  s_add_u32 m0, s0, 0
  s_add_u32 s1, s48, 0x2d0100
  v_fma_f32 v55, v98, v3, v233
  v_mfma_f32_16x16x32_bf16 v[180:183], a[248:251], a[16:19], 0
  s_add_u32 s9, s75, s8
  buffer_store_dwordx4 v[148:151], v62, s[36:39], s60 offen offset:1024 sc1
  v_mfma_f32_16x16x32_bf16 v[192:195], a[216:219], a[0:3], 0
  s_mul_i32 s60, s73, 0x12000
  v_fmac_f32_dpp v6, v4, v81 row_ror:8 row_mask:0xf bank_mask:0xf
  v_fmac_f32_dpp v54, v2, v97 row_ror:8 row_mask:0xf bank_mask:0xf
  v_mfma_f32_16x16x32_bf16 v[200:203], a[216:219], a[8:11], 0
  s_add_u32 s10, s9, s60
  buffer_load_dwordx4 v63, s[24:27], s1 offen offset:0 lds
  v_fmac_f32_dpp v55, v3, v99 row_ror:8 row_mask:0xf bank_mask:0xf
  v_mfma_f32_16x16x32_bf16 v[204:207], a[216:219], a[12:15], 0
  s_sub_u32 s11, 0x12000, s60
  v_cndmask_b32 v4, v4, v6, s[4:5]
  v_cndmask_b32 v2, v2, v54, s[4:5]
  v_mfma_f32_16x16x32_bf16 v[148:151], a[216:219], a[16:19], 0
  s_waitcnt lgkmcnt(0)
  v_cndmask_b32 v3, v3, v55, s[4:5]
  v_fma_f32 v6, v80, v4, v226
  v_mfma_f32_16x16x32_bf16 v[84:87], a[164:167], a[40:43], v[84:87]
  s_add_u32 s60, s9, s11
  buffer_load_dwordx4 v56, s[24:27], s1 offen offset:1024 lds
  v_fma_f32 v54, v96, v2, v230
  v_mfma_f32_16x16x32_bf16 v[136:139], a[164:167], a[4:7], v[136:139]
  s_lshl_b32 s4, s51, 5
  v_fma_f32 v55, v98, v3, v234
  v_fmac_f32_dpp v6, v4, v81 row_ror:8 row_mask:0xf bank_mask:0xf
  v_mfma_f32_16x16x32_bf16 v[156:159], a[164:167], a[48:51], v[156:159]
  s_add_u32 s75, s75, s4
  ds_read_b64_tr_b16 a[148:149], v52 offset:10240
  v_fmac_f32_dpp v54, v2, v97 row_ror:8 row_mask:0xf bank_mask:0xf
  v_mfma_f32_16x16x32_bf16 v[180:183], a[164:167], a[52:55], v[180:183]
  s_lshl_b32 s4, s50, 11
  ds_read_b64_tr_b16 a[150:151], v51 offset:26624
  buffer_load_dwordx4 v57, s[24:27], s1 offen offset:2048 lds
  v_mfma_f32_16x16x32_bf16 v[148:151], a[212:215], a[52:55], v[148:151]
  s_add_u32 s4, s0, s4
  ds_read_b64_tr_b16 a[216:217], v52 offset:51200
  v_fmac_f32_dpp v55, v3, v99 row_ror:8 row_mask:0xf bank_mask:0xf
  v_mfma_f32_16x16x32_bf16 v[204:207], a[212:215], a[48:51], v[204:207]
  s_xor_b32 s5, 0x800, s4
  ds_read_b64_tr_b16 a[218:219], v68 offset:2048
  v_cndmask_b32 v4, v4, v6, s[6:7]
  v_mfma_f32_16x16x32_bf16 v[200:203], a[212:215], a[4:7], v[200:203]
  s_mul_i32 s9, s40, 0x4800
  ds_read_b64_tr_b16 a[164:165], v67 offset:10240
  buffer_load_dwordx4 v64, s[24:27], s1 offen offset:3072 lds
  v_mfma_f32_16x16x32_bf16 v[192:195], a[212:215], a[40:43], v[192:195]
  s_add_u32 m0, s0, 0x5000
  s_add_u32 s1, s48, 0x360100
  ds_read_b64_tr_b16 a[166:167], v69 offset:26624
  v_mfma_f32_16x16x32_bf16 v[84:87], a[232:235], a[32:35], v[84:87]
  s_add_u32 s9, s9, 0x90000
  ds_read_b64_tr_b16 a[248:249], v67 offset:51200
  v_cndmask_b32 v2, v2, v54, s[6:7]
  v_mfma_f32_16x16x32_bf16 v[136:139], a[232:235], a[44:47], v[136:139]
  s_add_u32 s8, s9, s8
  ds_read_b64_tr_b16 a[250:251], v70 offset:2048
  v_cndmask_b32 v3, v3, v55, s[6:7]
  v_mfma_f32_16x16x32_bf16 v[156:159], a[232:235], a[64:67], v[156:159]
  s_xor_b32 s6, 0x80, s10
  v_fmac_f32 v216, v128, v4
  v_fmac_f32 v116, v130, v2
  v_mfma_f32_16x16x32_bf16 v[180:183], a[232:235], a[68:71], v[180:183]
  s_xor_b32 s7, 0x80, s60
  v_fmac_f32 v140, v132, v3
  v_fmac_f32_dpp v216, v4, v129 row_ror:8 row_mask:0xf bank_mask:0xf
  v_mfma_f32_16x16x32_bf16 v[148:151], a[244:247], a[68:71], v[148:151]
  s_xor_b32 s9, 0x80, s8
  v_fmac_f32_dpp v116, v2, v131 row_ror:8 row_mask:0xf bank_mask:0xf
  v_fmac_f32_dpp v140, v3, v133 row_ror:8 row_mask:0xf bank_mask:0xf
  v_mfma_f32_16x16x32_bf16 v[204:207], a[244:247], a[64:67], v[204:207]
  s_mul_i32 s11, s66, 0x48000
  v_fmac_f32 v217, v128, v216
  v_fmac_f32 v117, v130, v116
  v_mfma_f32_16x16x32_bf16 v[200:203], a[244:247], a[44:47], v[200:203]
  s_add_u32 s11, s11, 0x1b00000
  v_fmac_f32 v141, v132, v140
  v_fmac_f32_dpp v217, v216, v129 row_ror:8 row_mask:0xf bank_mask:0xf
  v_mfma_f32_16x16x32_bf16 v[192:195], a[244:247], a[32:35], v[192:195]
  s_waitcnt lgkmcnt(0)
  v_fmac_f32_dpp v117, v116, v131 row_ror:8 row_mask:0xf bank_mask:0xf
  v_fmac_f32_dpp v141, v140, v133 row_ror:8 row_mask:0xf bank_mask:0xf
  v_mfma_f32_16x16x32_bf16 v[152:155], a[148:151], a[36:39], v[152:155]
  s_mul_i32 s32, s42, 0x9000
  v_fmac_f32 v218, v128, v217
  v_fmac_f32 v118, v130, v117
  v_mfma_f32_16x16x32_bf16 v[164:167], a[148:151], a[76:79], v[164:167]
  s_waitcnt vmcnt(12)
  s_barrier
  v_mfma_f32_16x16x32_bf16 v[168:171], a[148:151], a[80:83], v[168:171]
  s_lshl_b32 s33, s74, 7
  ds_read_b64_tr_b16 a[212:213], v52 offset:12288
  v_fmac_f32 v142, v132, v141
  v_mfma_f32_16x16x32_bf16 v[176:179], a[148:151], a[56:59], v[176:179]
  s_sub_u32 s32, s32, s33
  ds_read_b64_tr_b16 a[214:215], v51 offset:28672
  buffer_load_dword v1, v50, s[12:15], s57 offen offset:0
  v_mfma_f32_16x16x32_bf16 v[196:199], a[216:219], a[56:59], v[196:199]
  s_lshl_b32 s73, s73, 7
  ds_read_b64_tr_b16 a[232:233], v52 offset:53248
  v_fmac_f32_dpp v218, v217, v129 row_ror:8 row_mask:0xf bank_mask:0xf
  v_mfma_f32_16x16x32_bf16 v[72:75], a[216:219], a[80:83], v[72:75]
  s_add_u32 s33, s32, s73
  ds_read_b64_tr_b16 a[234:235], v68 offset:4096
  buffer_load_dword v1, v50, s[12:15], s57 offen offset:128
  v_mfma_f32_16x16x32_bf16 v[188:191], a[216:219], a[76:79], v[188:191]
  s_xor_b32 s57, s73, 0x80
  ds_read_b64_tr_b16 a[148:149], v67 offset:12288
  v_fmac_f32_dpp v118, v117, v131 row_ror:8 row_mask:0xf bank_mask:0xf
  v_mfma_f32_16x16x32_bf16 v[184:187], a[216:219], a[36:39], v[184:187]
  s_add_u32 s57, s32, s57
  ds_read_b64_tr_b16 a[150:151], v69 offset:28672
  buffer_load_dword v1, v50, s[12:15], s56 offen offset:1024
  v_mfma_f32_16x16x32_bf16 v[84:87], a[164:167], a[36:39], v[84:87]
  s_add_u32 s56, s40, 0
  ds_read_b64_tr_b16 a[244:245], v67 offset:53248
  v_fmac_f32_dpp v142, v141, v133 row_ror:8 row_mask:0xf bank_mask:0xf
  v_mfma_f32_16x16x32_bf16 v[136:139], a[164:167], a[76:79], v[136:139]
  s_and_b32 s56, s56, 3
  ds_read_b64_tr_b16 a[246:247], v70 offset:4096
  v_fmac_f32 v219, v128, v218
  v_mfma_f32_16x16x32_bf16 v[156:159], a[164:167], a[80:83], v[156:159]
  s_and_b32 s73, s56, 1
  v_fmac_f32 v119, v130, v118
  v_fmac_f32 v143, v132, v142
  v_mfma_f32_16x16x32_bf16 v[180:183], a[164:167], a[56:59], v[180:183]
  s_lshl2_add_u32 s56, s51, s56
  v_fmac_f32_dpp v219, v218, v129 row_ror:8 row_mask:0xf bank_mask:0xf
  v_fmac_f32_dpp v119, v118, v131 row_ror:8 row_mask:0xf bank_mask:0xf
  v_mfma_f32_16x16x32_bf16 v[148:151], a[248:251], a[56:59], v[148:151]
  s_mul_i32 s34, s56, 0x4800
  v_fmac_f32_dpp v143, v142, v133 row_ror:8 row_mask:0xf bank_mask:0xf
  v_fmac_f32 v220, v128, v219
  v_mfma_f32_16x16x32_bf16 v[204:207], a[248:251], a[80:83], v[204:207]
  s_add_u32 s34, s34, s11
  v_fmac_f32 v144, v130, v119
  v_fmac_f32 v212, v132, v143
  v_mfma_f32_16x16x32_bf16 v[200:203], a[248:251], a[76:79], v[200:203]
  s_mul_i32 s35, s56, 9
  v_fmac_f32_dpp v220, v219, v129 row_ror:8 row_mask:0xf bank_mask:0xf
  v_fmac_f32_dpp v144, v119, v131 row_ror:8 row_mask:0xf bank_mask:0xf
  v_mfma_f32_16x16x32_bf16 v[192:195], a[248:251], a[36:39], v[192:195]
  s_waitcnt lgkmcnt(0)
  v_fmac_f32_dpp v212, v143, v133 row_ror:8 row_mask:0xf bank_mask:0xf
  v_fmac_f32 v221, v128, v220
  v_mfma_f32_16x16x32_bf16 v[152:155], a[212:215], a[60:63], v[152:155]
  s_add_u32 s56, s35, s73
  v_fmac_f32 v145, v130, v144
  v_fmac_f32 v213, v132, v212
  v_mfma_f32_16x16x32_bf16 v[164:167], a[212:215], a[92:95], v[164:167]
  s_mul_i32 s56, s56, 0x9000
  v_fmac_f32_dpp v221, v220, v129 row_ror:8 row_mask:0xf bank_mask:0xf
  v_fmac_f32_dpp v145, v144, v131 row_ror:8 row_mask:0xf bank_mask:0xf
  v_mfma_f32_16x16x32_bf16 v[168:171], a[212:215], a[96:99], v[168:171]
  s_xor_b32 s73, s73, 1
  ds_read_b64_tr_b16 a[164:165], v52 offset:14336
  v_fmac_f32_dpp v213, v212, v133 row_ror:8 row_mask:0xf bank_mask:0xf
  v_mfma_f32_16x16x32_bf16 v[176:179], a[212:215], a[20:23], v[176:179]
  s_lshl3_add_u32 s35, s73, s35
  ds_read_b64_tr_b16 a[166:167], v51 offset:30720
  v_fmac_f32 v222, v128, v221
  v_mfma_f32_16x16x32_bf16 v[196:199], a[232:235], a[20:23], v[196:199]
  s_mul_i32 s35, s35, 0x9000
  ds_read_b64_tr_b16 a[216:217], v52 offset:55296
  v_fmac_f32 v146, v130, v145
  v_mfma_f32_16x16x32_bf16 v[72:75], a[232:235], a[96:99], v[72:75]
  s_add_u32 s73, s40, 1
  ds_read_b64_tr_b16 a[218:219], v68 offset:6144
  v_fmac_f32 v214, v132, v213
  v_mfma_f32_16x16x32_bf16 v[188:191], a[232:235], a[92:95], v[188:191]
  s_and_b32 s73, s73, 3
  ds_read_b64_tr_b16 a[212:213], v67 offset:14336
  v_fmac_f32_dpp v222, v221, v129 row_ror:8 row_mask:0xf bank_mask:0xf
  v_mfma_f32_16x16x32_bf16 v[184:187], a[232:235], a[60:63], v[184:187]
  s_and_b32 s52, s73, 1
  ds_read_b64_tr_b16 a[214:215], v69 offset:30720
  v_fmac_f32_dpp v146, v145, v131 row_ror:8 row_mask:0xf bank_mask:0xf
  v_mfma_f32_16x16x32_bf16 v[84:87], a[148:151], a[60:63], v[84:87]
  s_lshl2_add_u32 s73, s51, s73
  ds_read_b64_tr_b16 a[248:249], v67 offset:55296
  v_fmac_f32_dpp v214, v213, v133 row_ror:8 row_mask:0xf bank_mask:0xf
  v_mfma_f32_16x16x32_bf16 v[136:139], a[148:151], a[92:95], v[136:139]
  s_mul_i32 s53, s73, 0x4800
  ds_read_b64_tr_b16 a[250:251], v70 offset:6144
  v_fmac_f32 v223, v128, v222
  v_mfma_f32_16x16x32_bf16 v[156:159], a[148:151], a[96:99], v[156:159]
  s_add_u32 s53, s53, s11
  v_fmac_f32 v147, v130, v146
  v_fmac_f32 v215, v132, v214
  v_mfma_f32_16x16x32_bf16 v[180:183], a[148:151], a[20:23], v[180:183]
  s_mul_i32 s73, s73, 9
  v_fmac_f32_dpp v223, v222, v129 row_ror:8 row_mask:0xf bank_mask:0xf
  v_fmac_f32_dpp v147, v146, v131 row_ror:8 row_mask:0xf bank_mask:0xf
  v_mfma_f32_16x16x32_bf16 v[148:151], a[244:247], a[20:23], v[148:151]
  s_add_u32 s54, s73, s52
  v_fmac_f32_dpp v215, v214, v133 row_ror:8 row_mask:0xf bank_mask:0xf
  v_fmac_f32 v104, v128, v223
  v_mfma_f32_16x16x32_bf16 v[204:207], a[244:247], a[96:99], v[204:207]
  s_mul_i32 s54, s54, 0x9000
  buffer_load_dwordx4 v63, s[24:27], s1 offen offset:0 lds
  v_fmac_f32 v172, v130, v147
  v_mfma_f32_16x16x32_bf16 v[200:203], a[244:247], a[92:95], v[200:203]
  s_xor_b32 s52, s52, 1
  v_fmac_f32 v76, v132, v215
  v_fmac_f32_dpp v104, v223, v129 row_ror:8 row_mask:0xf bank_mask:0xf
  v_mfma_f32_16x16x32_bf16 v[192:195], a[244:247], a[60:63], v[192:195]
  s_waitcnt lgkmcnt(0)
  v_fmac_f32_dpp v172, v147, v131 row_ror:8 row_mask:0xf bank_mask:0xf
  v_fmac_f32_dpp v76, v215, v133 row_ror:8 row_mask:0xf bank_mask:0xf
  v_mfma_f32_16x16x32_bf16 v[152:155], a[164:167], a[72:75], v[152:155]
  s_lshl3_add_u32 s73, s52, s73
  buffer_load_dwordx4 v56, s[24:27], s1 offen offset:1024 lds
  v_fmac_f32 v105, v128, v104
  v_mfma_f32_16x16x32_bf16 v[164:167], a[164:167], a[108:111], v[164:167]
  s_mul_i32 s73, s73, 0x9000
  v_fmac_f32 v173, v130, v172
  v_fmac_f32 v77, v132, v76
  v_mfma_f32_16x16x32_bf16 v[168:171], a[164:167], a[112:115], v[168:171]
  s_add_u32 s52, s54, s33
  ds_read_b64_tr_b16 a[148:149], v52 offset:4096
  v_fmac_f32_dpp v105, v104, v129 row_ror:8 row_mask:0xf bank_mask:0xf
  v_mfma_f32_16x16x32_bf16 v[176:179], a[164:167], a[100:103], v[176:179]
  s_add_u32 s55, s54, s57
  ds_read_b64_tr_b16 a[150:151], v51 offset:20480
  buffer_load_dwordx4 v57, s[24:27], s1 offen offset:2048 lds
  v_mfma_f32_16x16x32_bf16 v[196:199], a[216:219], a[100:103], v[196:199]
  s_add_u32 s68, s40, 2
  ds_read_b64_tr_b16 a[232:233], v52 offset:45056
  v_fmac_f32_dpp v173, v172, v131 row_ror:8 row_mask:0xf bank_mask:0xf
  v_mfma_f32_16x16x32_bf16 v[72:75], a[216:219], a[112:115], v[72:75]
  s_and_b32 s68, s68, 3
  ds_read_b64_tr_b16 a[234:235], v51 offset:61440
  v_fmac_f32_dpp v77, v76, v133 row_ror:8 row_mask:0xf bank_mask:0xf
  v_mfma_f32_16x16x32_bf16 v[188:191], a[216:219], a[108:111], v[188:191]
  s_and_b32 s69, s68, 1
  ds_read_b64_tr_b16 a[164:165], v67 offset:4096
  buffer_load_dwordx4 v64, s[24:27], s1 offen offset:3072 lds
  v_mfma_f32_16x16x32_bf16 v[184:187], a[216:219], a[72:75], v[184:187]
  s_add_u32 m0, s0, 0x6000
  s_add_u32 s1, s48, 0x3f0100
  ds_read_b64_tr_b16 a[166:167], v69 offset:20480
  v_mfma_f32_16x16x32_bf16 v[84:87], a[212:215], a[72:75], v[84:87]
  s_lshl2_add_u32 s68, s51, s68
  ds_read_b64_tr_b16 a[244:245], v67 offset:45056
  v_cvt_pk_bf16_f32 v80, v216, v217
  v_mfma_f32_16x16x32_bf16 v[136:139], a[212:215], a[108:111], v[136:139]
  s_mul_i32 s70, s68, 0x4800
  ds_read_b64_tr_b16 a[246:247], v69 offset:61440
  buffer_load_dwordx4 v63, s[24:27], s1 offen offset:0 lds
  v_mfma_f32_16x16x32_bf16 v[156:159], a[212:215], a[112:115], v[156:159]
  s_add_u32 s70, s70, s11
  v_cvt_pk_bf16_f32 v96, v116, v117
  v_cvt_pk_bf16_f32 v208, v140, v141
  v_mfma_f32_16x16x32_bf16 v[180:183], a[212:215], a[100:103], v[180:183]
  s_mul_i32 s68, s68, 9
  v_cvt_pk_bf16_f32 v81, v218, v219
  v_cvt_pk_bf16_f32 v97, v118, v119
  v_mfma_f32_16x16x32_bf16 v[148:151], a[248:251], a[100:103], v[148:151]
  s_add_u32 s71, s68, s69
  buffer_load_dwordx4 v56, s[24:27], s1 offen offset:1024 lds
  v_cvt_pk_bf16_f32 v209, v142, v143
  v_mfma_f32_16x16x32_bf16 v[204:207], a[248:251], a[112:115], v[204:207]
  s_mul_i32 s71, s71, 0x9000
  v_cvt_pk_bf16_f32 v82, v220, v221
  v_cvt_pk_bf16_f32 v98, v144, v145
  v_mfma_f32_16x16x32_bf16 v[200:203], a[248:251], a[108:111], v[200:203]
  s_xor_b32 s69, s69, 1
  v_cvt_pk_bf16_f32 v210, v212, v213
  v_cvt_pk_bf16_f32 v83, v222, v223
  v_mfma_f32_16x16x32_bf16 v[192:195], a[248:251], a[72:75], v[192:195]
  s_waitcnt lgkmcnt(0)
  buffer_load_dwordx4 v57, s[24:27], s1 offen offset:2048 lds
  v_cvt_pk_bf16_f32 v99, v146, v147
  v_mfma_f32_16x16x32_bf16 v[152:155], a[148:151], a[88:91], v[152:155]
  s_lshl3_add_u32 s68, s69, s68
  v_cvt_pk_bf16_f32 v211, v214, v215
  v_fmac_f32 v106, v128, v105
  v_mfma_f32_16x16x32_bf16 v[164:167], a[148:151], a[124:127], v[164:167]
  s_mul_i32 s68, s68, 0x9000
  v_fmac_f32 v174, v130, v173
  v_fmac_f32 v78, v132, v77
  v_mfma_f32_16x16x32_bf16 v[168:171], a[148:151], a[116:119], v[168:171]
  s_add_u32 s69, s71, s33
  ds_read_b64_tr_b16 a[212:213], v52 offset:6144
  buffer_load_dwordx4 v64, s[24:27], s1 offen offset:3072 lds
  v_mfma_f32_16x16x32_bf16 v[176:179], a[148:151], a[24:27], v[176:179]
  s_add_u32 m0, s0, 0x2000
  s_add_u32 s1, s48, 0x480100
  ds_read_b64_tr_b16 a[214:215], v51 offset:22528
  v_mfma_f32_16x16x32_bf16 v[196:199], a[232:235], a[24:27], v[196:199]
  s_add_u32 s76, s71, s57
  ds_read_b64_tr_b16 a[216:217], v52 offset:47104
  v_fmac_f32_dpp v106, v105, v129 row_ror:8 row_mask:0xf bank_mask:0xf
  v_mfma_f32_16x16x32_bf16 v[72:75], a[232:235], a[116:119], v[72:75]
  s_add_u32 s77, s40, 3
  ds_read_b64_tr_b16 a[218:219], v51 offset:63488
  buffer_load_dwordx4 v63, s[24:27], s1 offen offset:0 lds
  v_mfma_f32_16x16x32_bf16 v[188:191], a[232:235], a[124:127], v[188:191]
  s_and_b32 s77, s77, 3
  ds_read_b64_tr_b16 a[148:149], v67 offset:6144
  v_fmac_f32_dpp v174, v173, v131 row_ror:8 row_mask:0xf bank_mask:0xf
  v_mfma_f32_16x16x32_bf16 v[184:187], a[232:235], a[88:91], v[184:187]
  s_and_b32 s78, s77, 1
  ds_read_b64_tr_b16 a[150:151], v69 offset:22528
  v_fmac_f32_dpp v78, v77, v133 row_ror:8 row_mask:0xf bank_mask:0xf
  v_mfma_f32_16x16x32_bf16 v[84:87], a[164:167], a[88:91], v[84:87]
  s_lshl2_add_u32 s77, s51, s77
  ds_read_b64_tr_b16 a[248:249], v67 offset:47104
  buffer_load_dwordx4 v56, s[24:27], s1 offen offset:1024 lds
  v_mfma_f32_16x16x32_bf16 v[136:139], a[164:167], a[124:127], v[136:139]
  s_mul_i32 s79, s77, 0x4800
  ds_read_b64_tr_b16 a[250:251], v69 offset:63488
  v_fmac_f32 v107, v128, v106
  v_mfma_f32_16x16x32_bf16 v[156:159], a[164:167], a[116:119], v[156:159]
  s_add_u32 s11, s79, s11
  v_fmac_f32 v175, v130, v174
  v_fmac_f32 v79, v132, v78
  v_mfma_f32_16x16x32_bf16 v[180:183], a[164:167], a[24:27], v[180:183]
  s_mul_i32 s77, s77, 9
  buffer_load_dwordx4 v57, s[24:27], s1 offen offset:2048 lds
  v_fmac_f32_dpp v107, v106, v129 row_ror:8 row_mask:0xf bank_mask:0xf
  v_mfma_f32_16x16x32_bf16 v[148:151], a[244:247], a[24:27], v[148:151]
  s_add_u32 s79, s77, s78
  v_fmac_f32_dpp v175, v174, v131 row_ror:8 row_mask:0xf bank_mask:0xf
  v_fmac_f32_dpp v79, v78, v133 row_ror:8 row_mask:0xf bank_mask:0xf
  v_mfma_f32_16x16x32_bf16 v[204:207], a[244:247], a[116:119], v[204:207]
  s_mul_i32 s79, s79, 0x9000
  v_fmac_f32 v112, v128, v107
  v_fmac_f32 v160, v130, v175
  v_mfma_f32_16x16x32_bf16 v[200:203], a[244:247], a[124:127], v[200:203]
  s_xor_b32 s78, s78, 1
  buffer_load_dwordx4 v64, s[24:27], s1 offen offset:3072 lds
  s_add_u32 m0, s0, 0x7000
  v_mfma_f32_16x16x32_bf16 v[192:195], a[244:247], a[88:91], v[192:195]
  s_waitcnt lgkmcnt(0)
  s_add_u32 s1, s48, 0x180
  v_fmac_f32 v236, v132, v79
  v_mfma_f32_16x16x32_bf16 v[152:155], a[212:215], a[104:107], v[152:155]
  s_lshl3_add_u32 s77, s78, s77
  v_fmac_f32_dpp v112, v107, v129 row_ror:8 row_mask:0xf bank_mask:0xf
  v_fmac_f32_dpp v160, v175, v131 row_ror:8 row_mask:0xf bank_mask:0xf
  v_mfma_f32_16x16x32_bf16 v[164:167], a[212:215], a[140:143], v[164:167]
  s_waitcnt vmcnt(15)
  s_barrier
  v_mfma_f32_16x16x32_bf16 v[168:171], a[212:215], a[144:147], v[168:171]
  s_mul_i32 s77, s77, 0x9000
  ds_read_b64_tr_b16 a[164:165], v52 offset:16384
  v_fmac_f32_dpp v236, v79, v133 row_ror:8 row_mask:0xf bank_mask:0xf
  v_mfma_f32_16x16x32_bf16 v[176:179], a[212:215], a[28:31], v[176:179]
  s_add_u32 s33, s79, s33
  ds_read_b64_tr_b16 a[166:167], v51 offset:32768
  v_fmac_f32 v113, v128, v112
  v_mfma_f32_16x16x32_bf16 v[196:199], a[216:219], a[28:31], v[196:199]
  s_add_u32 s57, s79, s57
  ds_read_b64_tr_b16 a[232:233], v52 offset:57344
  v_fmac_f32 v161, v130, v160
  v_mfma_f32_16x16x32_bf16 v[72:75], a[216:219], a[144:147], v[72:75]
  s_lshl_b32 s78, s40, 8
  ds_read_b64_tr_b16 a[234:235], v68 offset:8192
  v_fmac_f32 v237, v132, v236
  v_mfma_f32_16x16x32_bf16 v[188:191], a[216:219], a[140:143], v[188:191]
  s_sub_u32 s78, 0x400, s78
  ds_read_b64_tr_b16 a[212:213], v67 offset:16384
  v_fmac_f32_dpp v113, v112, v129 row_ror:8 row_mask:0xf bank_mask:0xf
  v_mfma_f32_16x16x32_bf16 v[184:187], a[216:219], a[104:107], v[184:187]
  s_add_u32 s32, s78, s32
  ds_read_b64_tr_b16 a[214:215], v69 offset:32768
  v_fmac_f32_dpp v161, v160, v131 row_ror:8 row_mask:0xf bank_mask:0xf
  v_mfma_f32_16x16x32_bf16 v[84:87], a[148:151], a[104:107], v[84:87]
  s_add_u32 s78, s56, s32
  ds_read_b64_tr_b16 a[244:245], v67 offset:57344
  v_fmac_f32_dpp v237, v236, v133 row_ror:8 row_mask:0xf bank_mask:0xf
  v_mfma_f32_16x16x32_bf16 v[136:139], a[148:151], a[140:143], v[136:139]
  s_lshl_b32 s80, s42, 30
  ds_read_b64_tr_b16 a[246:247], v70 offset:8192
  v_fmac_f32 v114, v128, v113
  v_mfma_f32_16x16x32_bf16 v[156:159], a[148:151], a[144:147], v[156:159]
  s_add_u32 s32, s32, s80
  v_fmac_f32 v162, v130, v161
  v_fmac_f32 v238, v132, v237
  v_mfma_f32_16x16x32_bf16 v[180:183], a[148:151], a[28:31], v[180:183]
  s_add_u32 s32, s35, s32
  v_fmac_f32_dpp v114, v113, v129 row_ror:8 row_mask:0xf bank_mask:0xf
  v_fmac_f32_dpp v162, v161, v131 row_ror:8 row_mask:0xf bank_mask:0xf
  v_mfma_f32_16x16x32_bf16 v[148:151], a[248:251], a[28:31], v[148:151]
  v_fmac_f32_dpp v238, v237, v133 row_ror:8 row_mask:0xf bank_mask:0xf
  v_fmac_f32 v115, v128, v114
  v_mfma_f32_16x16x32_bf16 v[204:207], a[248:251], a[144:147], v[204:207]
  v_fmac_f32 v163, v130, v162
  v_fmac_f32 v239, v132, v238
  v_mfma_f32_16x16x32_bf16 v[200:203], a[248:251], a[140:143], v[200:203]
  v_fmac_f32_dpp v115, v114, v129 row_ror:8 row_mask:0xf bank_mask:0xf
  v_fmac_f32_dpp v163, v162, v131 row_ror:8 row_mask:0xf bank_mask:0xf
  v_mfma_f32_16x16x32_bf16 v[192:195], a[248:251], a[104:107], v[192:195]
  s_waitcnt lgkmcnt(0)
  v_fmac_f32_dpp v239, v238, v133 row_ror:8 row_mask:0xf bank_mask:0xf
  v_cvt_pk_bf16_f32 v116, v104, v105
  v_mfma_f32_16x16x32_bf16 v[152:155], a[164:167], a[120:123], v[152:155]
  v_cvt_pk_bf16_f32 v140, v172, v173
  v_cvt_pk_bf16_f32 v144, v76, v77
  v_mfma_f32_16x16x32_bf16 v[164:167], a[164:167], a[156:159], v[164:167]
  v_cvt_pk_bf16_f32 v117, v106, v107
  v_cvt_pk_bf16_f32 v141, v174, v175
  v_mfma_f32_16x16x32_bf16 v[168:171], a[164:167], a[160:163], v[168:171]
  ds_read_b64_tr_b16 a[148:149], v52 offset:18432
  v_cvt_pk_bf16_f32 v145, v78, v79
  v_mfma_f32_16x16x32_bf16 v[176:179], a[164:167], a[84:87], v[176:179]
  ds_read_b64_tr_b16 a[150:151], v51 offset:34816
  v_cvt_pk_bf16_f32 v118, v112, v113
  v_mfma_f32_16x16x32_bf16 v[196:199], a[232:235], a[84:87], v[196:199]
  ds_read_b64_tr_b16 a[216:217], v52 offset:59392
  v_cvt_pk_bf16_f32 v142, v160, v161
  v_mfma_f32_16x16x32_bf16 v[72:75], a[232:235], a[160:163], v[72:75]
  ds_read_b64_tr_b16 a[218:219], v68 offset:10240
  v_cvt_pk_bf16_f32 v146, v236, v237
  v_mfma_f32_16x16x32_bf16 v[188:191], a[232:235], a[156:159], v[188:191]
  ds_read_b64_tr_b16 a[248:249], v67 offset:18432
  v_cvt_pk_bf16_f32 v119, v114, v115
  v_mfma_f32_16x16x32_bf16 v[184:187], a[232:235], a[120:123], v[184:187]
  ds_read_b64_tr_b16 a[250:251], v69 offset:34816
  v_cvt_pk_bf16_f32 v143, v162, v163
  v_mfma_f32_16x16x32_bf16 v[84:87], a[212:215], a[120:123], v[84:87]
  ds_read_b64_tr_b16 a[164:165], v67 offset:59392
  v_cvt_pk_bf16_f32 v147, v238, v239
  v_mfma_f32_16x16x32_bf16 v[136:139], a[212:215], a[156:159], v[136:139]
  ds_read_b64_tr_b16 a[166:167], v70 offset:10240
  v_mfma_f32_16x16x32_bf16 v[156:159], a[212:215], a[160:163], v[156:159]
  ds_write_b128 v49, v[80:83] offset:36864
  v_mfma_f32_16x16x32_bf16 v[180:183], a[212:215], a[84:87], v[180:183]
  ds_write_b128 v49, v[116:119] offset:36880
  v_mfma_f32_16x16x32_bf16 v[148:151], a[244:247], a[84:87], v[148:151]
  ds_read_b64_tr_b16 v[76:77], v53 offset:36864
  v_mfma_f32_16x16x32_bf16 v[204:207], a[244:247], a[160:163], v[204:207]
  ds_read_b64_tr_b16 v[104:105], v53 offset:36872
  v_mfma_f32_16x16x32_bf16 v[200:203], a[244:247], a[156:159], v[200:203]
  ds_read_b64_tr_b16 v[112:113], v53 offset:36880
  v_mfma_f32_16x16x32_bf16 v[192:195], a[244:247], a[120:123], v[192:195]
  s_waitcnt lgkmcnt(5)
  buffer_load_dwordx4 v63, s[24:27], s1 offen offset:0 lds
  ds_read_b64_tr_b16 v[80:81], v53 offset:36888
  v_mfma_f32_16x16x32_bf16 v[152:155], a[148:151], a[136:139], v[152:155]
  ds_write_b128 v49, v[96:99] offset:36864
  v_mfma_f32_16x16x32_bf16 v[164:167], a[148:151], a[172:175], v[164:167]
  ds_write_b128 v49, v[140:143] offset:36880
  v_mfma_f32_16x16x32_bf16 v[168:171], a[148:151], a[176:179], v[168:171]
  ds_read_b64_tr_b16 a[212:213], v52 offset:0
  buffer_load_dwordx4 v56, s[24:27], s1 offen offset:1024 lds
  v_mfma_f32_16x16x32_bf16 v[176:179], a[148:151], a[128:131], v[176:179]
  ds_read_b64_tr_b16 a[214:215], v51 offset:16384
  v_mfma_f32_16x16x32_bf16 v[196:199], a[216:219], a[128:131], v[196:199]
  ds_read_b64_tr_b16 a[232:233], v52 offset:40960
  v_mfma_f32_16x16x32_bf16 v[72:75], a[216:219], a[176:179], v[72:75]
  ds_read_b64_tr_b16 a[234:235], v51 offset:57344
  v_mfma_f32_16x16x32_bf16 v[188:191], a[216:219], a[172:175], v[188:191]
  ds_read_b64_tr_b16 a[244:245], v67 offset:0
  v_mfma_f32_16x16x32_bf16 v[184:187], a[216:219], a[136:139], v[184:187]
  ds_read_b64_tr_b16 a[246:247], v69 offset:16384
  buffer_load_dwordx4 v57, s[24:27], s1 offen offset:2048 lds
  v_mfma_f32_16x16x32_bf16 v[84:87], a[248:251], a[136:139], v[84:87]
  ds_read_b64_tr_b16 a[148:149], v67 offset:40960
  v_mfma_f32_16x16x32_bf16 v[136:139], a[248:251], a[172:175], v[136:139]
  ds_read_b64_tr_b16 a[150:151], v69 offset:57344
  v_mfma_f32_16x16x32_bf16 v[156:159], a[248:251], a[176:179], v[156:159]
  ds_read_b64_tr_b16 v[78:79], v53 offset:36864
  v_mfma_f32_16x16x32_bf16 v[180:183], a[248:251], a[128:131], v[180:183]
  buffer_load_dwordx4 v64, s[24:27], s1 offen offset:3072 lds
  s_add_u32 m0, s0, 0x1000
  v_mfma_f32_16x16x32_bf16 v[148:151], a[164:167], a[128:131], v[148:151]
  s_add_u32 s1, s48, 0x90180
  ds_read_b64_tr_b16 v[106:107], v53 offset:36872
  v_mfma_f32_16x16x32_bf16 v[204:207], a[164:167], a[176:179], v[204:207]
  ds_read_b64_tr_b16 v[114:115], v53 offset:36880
  v_mfma_f32_16x16x32_bf16 v[200:203], a[164:167], a[172:175], v[200:203]
  ds_read_b64_tr_b16 v[82:83], v53 offset:36888
  v_mfma_f32_16x16x32_bf16 v[192:195], a[164:167], a[136:139], v[192:195]
  s_waitcnt lgkmcnt(4)
  ds_write_b128 v49, v[208:211] offset:36864
  v_mfma_f32_16x16x32_bf16 v[152:155], a[212:215], a[152:155], v[152:155]
  buffer_load_dwordx4 v63, s[24:27], s1 offen offset:0 lds
  v_mfma_f32_16x16x32_bf16 v[164:167], a[212:215], a[188:191], v[164:167]
  ds_write_b128 v49, v[144:147] offset:36880
  v_mfma_f32_16x16x32_bf16 v[168:171], a[212:215], a[192:195], v[168:171]
  ds_read_b64_tr_b16 a[216:217], v52 offset:2048
  v_mfma_f32_16x16x32_bf16 v[176:179], a[212:215], a[180:183], v[176:179]
  ds_read_b64_tr_b16 a[218:219], v51 offset:18432
  buffer_load_dwordx4 v56, s[24:27], s1 offen offset:1024 lds
  v_mfma_f32_16x16x32_bf16 v[196:199], a[232:235], a[180:183], v[196:199]
  ds_read_b64_tr_b16 a[164:165], v52 offset:43008
  v_mfma_f32_16x16x32_bf16 v[72:75], a[232:235], a[192:195], v[72:75]
  ds_read_b64_tr_b16 a[166:167], v51 offset:59392
  v_mfma_f32_16x16x32_bf16 v[188:191], a[232:235], a[188:191], v[188:191]
  ds_read_b64_tr_b16 a[248:249], v67 offset:2048
  v_mfma_f32_16x16x32_bf16 v[184:187], a[232:235], a[152:155], v[184:187]
  ds_read_b64_tr_b16 a[250:251], v69 offset:18432
  v_mfma_f32_16x16x32_bf16 v[84:87], a[244:247], a[152:155], v[84:87]
  ds_read_b64_tr_b16 a[212:213], v67 offset:43008
  buffer_load_dwordx4 v57, s[24:27], s1 offen offset:2048 lds
  v_mfma_f32_16x16x32_bf16 v[136:139], a[244:247], a[188:191], v[136:139]
  ds_read_b64_tr_b16 a[214:215], v69 offset:59392
  v_mfma_f32_16x16x32_bf16 v[156:159], a[244:247], a[192:195], v[156:159]
  ds_read_b64_tr_b16 v[2:3], v71 offset:36864
  s_lshl1_add_u32 s80, s41, s43
  v_mfma_f32_16x16x32_bf16 v[180:183], a[244:247], a[180:183], v[180:183]
  s_lshl_b32 s80, s80, 6
  s_add_u32 s49, s80, s49
  s_lshl_b32 s49, s49, 11
  v_mfma_f32_16x16x32_bf16 v[148:151], a[148:151], a[180:183], v[148:151]
  s_add_u32 s80, s49, 0x100000
  buffer_load_dwordx4 v64, s[24:27], s1 offen offset:3072 lds
  s_add_u32 m0, s0, 0x3000
  v_mfma_f32_16x16x32_bf16 v[204:207], a[148:151], a[192:195], v[204:207]
  s_add_u32 s1, s48, 0x120180
  s_add_u32 s49, s49, 0x110000
  s_lshl1_add_u32 s81, s41, s44
  v_mfma_f32_16x16x32_bf16 v[200:203], a[148:151], a[188:191], v[200:203]
  s_lshl1_add_u32 s81, s81, s43
  s_lshl2_add_u32 s81, s81, s51
  s_lshl1_add_u32 s42, s81, s42
  v_mfma_f32_16x16x32_bf16 v[192:195], a[148:151], a[152:155], v[192:195]
  s_waitcnt lgkmcnt(1)
  s_lshl_b32 s42, s42, 10
  s_lshl_b32 s45, s45, 9
  v_mfma_f32_16x16x32_bf16 v[152:155], a[216:219], a[168:171], v[152:155]
  s_add_u32 s42, s45, s42
  s_add_u32 s42, s42, 0x500000
  v_lshrrev_b32 v71, 1, v62
  v_mfma_f32_16x16x32_bf16 v[164:167], a[216:219], a[204:207], v[164:167]
  s_waitcnt vmcnt(8)
  s_barrier
  v_mfma_f32_16x16x32_bf16 v[168:171], a[216:219], a[196:199], v[168:171]
  ds_read_b64_tr_b16 a[148:149], v52 offset:20480
  buffer_store_dwordx4 v[76:79], v62, s[36:39], s80 offen offset:0 sc1
  v_mfma_f32_16x16x32_bf16 v[176:179], a[216:219], a[208:211], v[176:179]
  ds_read_b64_tr_b16 a[150:151], v51 offset:36864
  v_mfma_f32_16x16x32_bf16 v[196:199], a[164:167], a[208:211], v[196:199]
  ds_read_b64_tr_b16 a[232:233], v52 offset:61440
  v_mfma_f32_16x16x32_bf16 v[72:75], a[164:167], a[196:199], v[72:75]
  ds_read_b64_tr_b16 a[234:235], v68 offset:12288
  v_mfma_f32_16x16x32_bf16 v[188:191], a[164:167], a[204:207], v[188:191]
  ds_read_b64_tr_b16 a[244:245], v67 offset:20480
  buffer_load_dwordx4 v63, s[24:27], s1 offen offset:0 lds
  v_mfma_f32_16x16x32_bf16 v[184:187], a[164:167], a[168:171], v[184:187]
  ds_read_b64_tr_b16 a[246:247], v69 offset:36864
  v_mfma_f32_16x16x32_bf16 v[84:87], a[248:251], a[168:171], v[84:87]
  ds_read_b64_tr_b16 a[216:217], v67 offset:61440
  v_mfma_f32_16x16x32_bf16 v[136:139], a[248:251], a[204:207], v[136:139]
  ds_read_b64_tr_b16 a[218:219], v70 offset:12288
  buffer_store_dwordx4 v[104:107], v62, s[36:39], s80 offen offset:1024 sc1
  v_mfma_f32_16x16x32_bf16 v[156:159], a[248:251], a[196:199], v[156:159]
  v_mfma_f32_16x16x32_bf16 v[180:183], a[248:251], a[208:211], v[180:183]
  v_mfma_f32_16x16x32_bf16 v[148:151], a[212:215], a[208:211], v[148:151]
  v_mfma_f32_16x16x32_bf16 v[204:207], a[212:215], a[196:199], v[204:207]
  v_mfma_f32_16x16x32_bf16 v[200:203], a[212:215], a[204:207], v[200:203]
  v_mfma_f32_16x16x32_bf16 v[192:195], a[212:215], a[168:171], v[192:195]
  s_waitcnt lgkmcnt(0)
  v_mfma_f32_16x16x32_bf16 v[152:155], a[148:151], a[184:187], v[152:155]
  buffer_load_dwordx4 v56, s[24:27], s1 offen offset:1024 lds
  v_mfma_f32_16x16x32_bf16 v[164:167], a[148:151], a[220:223], v[164:167]
  v_mfma_f32_16x16x32_bf16 v[168:171], a[148:151], a[224:227], v[168:171]
  ds_read_b64_tr_b16 a[164:165], v52 offset:22528
  v_mfma_f32_16x16x32_bf16 v[176:179], a[148:151], a[132:135], v[176:179]
  ds_read_b64_tr_b16 a[166:167], v51 offset:38912
  buffer_store_dwordx4 v[112:115], v62, s[36:39], s49 offen offset:0 sc1
  v_mfma_f32_16x16x32_bf16 v[196:199], a[232:235], a[132:135], v[196:199]
  ds_read_b64_tr_b16 a[248:249], v52 offset:63488
  v_mfma_f32_16x16x32_bf16 v[72:75], a[232:235], a[224:227], v[72:75]
  ds_read_b64_tr_b16 a[250:251], v68 offset:14336
  v_mfma_f32_16x16x32_bf16 v[188:191], a[232:235], a[220:223], v[188:191]
  ds_read_b64_tr_b16 a[212:213], v67 offset:22528
  v_mfma_f32_16x16x32_bf16 v[184:187], a[232:235], a[184:187], v[184:187]
  ds_read_b64_tr_b16 a[214:215], v69 offset:38912
  v_mfma_f32_16x16x32_bf16 v[84:87], a[244:247], a[184:187], v[84:87]
  ds_read_b64_tr_b16 a[148:149], v67 offset:63488
  v_mfma_f32_16x16x32_bf16 v[136:139], a[244:247], a[220:223], v[136:139]
  ds_read_b64_tr_b16 a[150:151], v70 offset:14336
  v_mfma_f32_16x16x32_bf16 v[156:159], a[244:247], a[224:227], v[156:159]
  v_mfma_f32_16x16x32_bf16 v[180:183], a[244:247], a[132:135], v[180:183]
  buffer_load_dwordx4 v57, s[24:27], s1 offen offset:2048 lds
  v_mfma_f32_16x16x32_bf16 v[148:151], a[216:219], a[132:135], v[148:151]
  v_mfma_f32_16x16x32_bf16 v[204:207], a[216:219], a[224:227], v[204:207]
  v_mfma_f32_16x16x32_bf16 v[200:203], a[216:219], a[220:223], v[200:203]
  v_mfma_f32_16x16x32_bf16 v[192:195], a[216:219], a[184:187], v[192:195]
  s_waitcnt lgkmcnt(0)
  buffer_load_dwordx4 v64, s[24:27], s1 offen offset:3072 lds
  s_add_u32 m0, s0, 0
  v_mfma_f32_16x16x32_bf16 v[152:155], a[164:167], a[200:203], v[152:155]
  s_add_u32 s1, s48, 0x1b0180
  v_mfma_f32_16x16x32_bf16 v[164:167], a[164:167], a[236:239], v[164:167]
  buffer_store_dwordx4 v[80:83], v62, s[36:39], s49 offen offset:1024 sc1
  v_mfma_f32_16x16x32_bf16 v[168:171], a[164:167], a[240:243], v[168:171]
  ds_read_b64_tr_b16 a[232:233], v52 offset:24576
  v_mfma_f32_16x16x32_bf16 v[176:179], a[164:167], a[228:231], v[176:179]
  ds_read_b64_tr_b16 a[234:235], v51 offset:40960
  v_mfma_f32_16x16x32_bf16 v[196:199], a[248:251], a[228:231], v[196:199]
  ds_read_b64_tr_b16 a[216:217], v51 offset:0
  v_mfma_f32_16x16x32_bf16 v[72:75], a[248:251], a[240:243], v[72:75]
  ds_read_b64_tr_b16 a[218:219], v68 offset:16384
  v_mfma_f32_16x16x32_bf16 v[188:191], a[248:251], a[236:239], v[188:191]
  ds_read_b64_tr_b16 a[244:245], v67 offset:24576
  v_mfma_f32_16x16x32_bf16 v[184:187], a[248:251], a[200:203], v[184:187]
  ds_read_b64_tr_b16 a[246:247], v69 offset:40960
  v_mfma_f32_16x16x32_bf16 v[84:87], a[212:215], a[200:203], v[84:87]
  ds_read_b64_tr_b16 a[252:253], v69 offset:0
  v_mfma_f32_16x16x32_bf16 v[136:139], a[212:215], a[236:239], v[136:139]
  ds_read_b64_tr_b16 a[254:255], v70 offset:16384
  v_mfma_f32_16x16x32_bf16 v[156:159], a[212:215], a[240:243], v[156:159]
  v_mfma_f32_16x16x32_bf16 v[180:183], a[212:215], a[228:231], v[180:183]
  v_mfma_f32_16x16x32_bf16 v[148:151], a[148:151], a[228:231], v[148:151]
  v_mfma_f32_16x16x32_bf16 v[204:207], a[148:151], a[240:243], v[204:207]
  v_mfma_f32_16x16x32_bf16 v[200:203], a[148:151], a[236:239], v[200:203]
  v_mfma_f32_16x16x32_bf16 v[192:195], a[148:151], a[200:203], v[192:195]
  s_waitcnt lgkmcnt(0)
  buffer_load_dwordx4 v63, s[24:27], s1 offen offset:0 lds
  v_mfma_f32_16x16x32_bf16 v[152:155], a[232:235], v[24:27], v[152:155]
  v_mfma_f32_16x16x32_bf16 v[164:167], a[232:235], v[8:11], v[164:167]
  buffer_store_dwordx2 v[2:3], v71, s[36:39], s42 offen sc1
  v_mfma_f32_16x16x32_bf16 v[168:171], a[232:235], v[16:19], v[168:171]
  ds_read_b64_tr_b16 a[164:165], v52 offset:26624
  v_mfma_f32_16x16x32_bf16 v[176:179], a[232:235], v[28:31], v[176:179]
  ds_read_b64_tr_b16 a[166:167], v51 offset:43008
  v_mfma_f32_16x16x32_bf16 v[196:199], a[216:219], v[28:31], v[196:199]
  ds_read_b64_tr_b16 a[212:213], v51 offset:2048
  v_and_b32 v71, 7, v48
  v_mfma_f32_16x16x32_bf16 v[72:75], a[216:219], v[16:19], v[72:75]
  ds_read_b64_tr_b16 a[214:215], v68 offset:18432
  v_xor_b32 v71, v71, v5
  v_mfma_f32_16x16x32_bf16 v[188:191], a[216:219], v[8:11], v[188:191]
  ds_read_b64_tr_b16 a[148:149], v52 offset:8192
  v_lshlrev_b32 v71, 4, v71
  v_mfma_f32_16x16x32_bf16 v[184:187], a[216:219], v[24:27], v[184:187]
  s_lshl_b32 s42, s43, 6
  s_mul_i32 s45, s43, 0x2400
  ds_read_b64_tr_b16 a[150:151], v51 offset:24576
  v_mfma_f32_16x16x32_bf16 v[84:87], a[244:247], v[24:27], v[84:87]
  ds_read_b64_tr_b16 a[232:233], v52 offset:49152
  buffer_load_dwordx4 v56, s[24:27], s1 offen offset:1024 lds
  v_mfma_f32_16x16x32_bf16 v[136:139], a[244:247], v[8:11], v[136:139]
  ds_read_b64_tr_b16 a[234:235], v68 offset:0
  v_lshrrev_b32 v2, 7, v62
  v_mfma_f32_16x16x32_bf16 v[156:159], a[244:247], v[16:19], v[156:159]
  v_mul_u32_u24 v2, 0x480, v2
  v_xad_u32 v71, v71, s42, v2
  v_mfma_f32_16x16x32_bf16 v[180:183], a[244:247], v[28:31], v[180:183]
  v_add_u32 v71, s45, v71
  v_add_u32 v2, 0x4400, v71
  v_mfma_f32_16x16x32_bf16 v[148:151], a[252:255], v[28:31], v[148:151]
  v_lshrrev_b32 v3, 1, v48
  v_mul_u32_u24 v3, 0x480, v3
  v_mfma_f32_16x16x32_bf16 v[204:207], a[252:255], v[16:19], v[204:207]
  buffer_load_dwordx4 v57, s[24:27], s1 offen offset:2048 lds
  v_and_b32 v4, 16, v62
  v_mfma_f32_16x16x32_bf16 v[200:203], a[252:255], v[8:11], v[200:203]
  v_add3_u32 v3, v3, v4, s45
  s_lshl_b32 s42, s63, 1
  v_mfma_f32_16x16x32_bf16 v[192:195], a[252:255], v[24:27], v[192:195]
  s_waitcnt lgkmcnt(0)
  v_xor_b32 v4, s42, v5
  v_xor_b32 v6, 4, v4
  v_mfma_f32_16x16x32_bf16 v[152:155], a[164:167], v[20:23], v[152:155]
  buffer_load_dwordx4 v64, s[24:27], s1 offen offset:3072 lds
  s_add_u32 m0, s0, 0x4000
  v_mfma_f32_16x16x32_bf16 v[164:167], a[164:167], v[32:35], v[164:167]
  s_add_u32 s1, s48, 0x240180
  v_mul_u32_u24 v4, 0x4800, v4
  v_mul_u32_u24 v6, 0x4800, v6
  v_mfma_f32_16x16x32_bf16 v[168:171], a[164:167], v[12:15], v[168:171]
  ds_read_b64_tr_b16 a[216:217], v52 offset:10240
  v_add_u32 v4, 0x400, v4
  v_mfma_f32_16x16x32_bf16 v[176:179], a[164:167], v[36:39], v[176:179]
  ds_read_b64_tr_b16 a[218:219], v51 offset:26624
  v_add_u32 v4, v3, v4
  v_mfma_f32_16x16x32_bf16 v[196:199], a[212:215], v[36:39], v[196:199]
  ds_read_b64_tr_b16 a[244:245], v52 offset:51200
  v_add_u32 v6, v3, v6
  v_mfma_f32_16x16x32_bf16 v[72:75], a[212:215], v[12:15], v[72:75]
  s_mul_i32 s42, s40, 0x1f800
  s_sub_u32 s42, 0x8fc00, s42
  ds_read_b64_tr_b16 a[246:247], v68 offset:2048
  v_mfma_f32_16x16x32_bf16 v[188:191], a[212:215], v[32:35], v[188:191]
  ds_read_b64_tr_b16 a[248:249], v67 offset:26624
  v_lshlrev_b32 v49, 24, v5
  v_mfma_f32_16x16x32_bf16 v[184:187], a[212:215], v[20:23], v[184:187]
  ds_read_b64_tr_b16 a[250:251], v69 offset:43008
  v_add3_u32 v3, s42, v3, v49
  v_mfma_f32_16x16x32_bf16 v[152:155], a[148:151], v[40:43], v[152:155]
  s_lshl1_add_u32 s42, s40, s74
  s_lshl_b32 s42, s42, 7
  ds_read_b64_tr_b16 a[164:165], v69 offset:2048
  v_mfma_f32_16x16x32_bf16 v[164:167], a[148:151], v[44:47], v[164:167]
  s_mul_i32 s43, s43, 0x4800
  ds_read_b64_tr_b16 a[166:167], v70 offset:18432
  buffer_load_dwordx4 v63, s[24:27], s1 offen offset:0 lds
  v_mfma_f32_16x16x32_bf16 v[168:171], a[148:151], v[88:91], v[168:171]
  s_add_u32 s45, s42, s43
  v_bfe_u32 v49, v62, 6, 3
  v_mul_u32_u24 v49, 0x480, v49
  v_mfma_f32_16x16x32_bf16 v[176:179], a[148:151], v[92:95], v[176:179]
  v_and_b32 v50, 0x7f, v63
  s_lshl_b32 s74, s50, 6
  v_mfma_f32_16x16x32_bf16 v[196:199], a[232:235], v[92:95], v[196:199]
  v_xad_u32 v49, v50, s74, v49
  v_add_u32 v49, s45, v49
  v_mfma_f32_16x16x32_bf16 v[72:75], a[232:235], v[88:91], v[72:75]
  s_lshl_b32 s45, s51, 2
  s_lshl_b32 s42, 15, s45
  s_mov_b32 s43, 0
  v_mfma_f32_16x16x32_bf16 v[188:191], a[232:235], v[44:47], v[188:191]
  v_add_u32 v50, 0x2000, v49
  v_add_u32 v58, 0x8800, v49
  v_mfma_f32_16x16x32_bf16 v[184:187], a[232:235], v[40:43], v[184:187]
  s_waitcnt lgkmcnt(0)
  buffer_load_dwordx4 v56, s[24:27], s1 offen offset:1024 lds
  v_add_u32 v59, 0xa800, v49
  v_mfma_f32_16x16x32_bf16 v[152:155], a[216:219], v[100:103], v[152:155]
  v_bfe_u32 v60, v48, 1, 3
  v_and_b32 v61, 1, v5
  v_mfma_f32_16x16x32_bf16 v[164:167], a[216:219], v[108:111], v[164:167]
  v_xor_b32 v60, v60, v61
  v_lshlrev_b32 v60, 4, v60
  v_mfma_f32_16x16x32_bf16 v[168:171], a[216:219], v[120:123], v[168:171]
  ds_read_b64_tr_b16 a[148:149], v67 offset:8192
  v_and_b32 v65, 7, v48
  v_mfma_f32_16x16x32_bf16 v[176:179], a[216:219], v[124:127], v[176:179]
  ds_read_b64_tr_b16 a[150:151], v69 offset:24576
  v_lshl_add_u32 v60, v65, 7, v60
  v_mfma_f32_16x16x32_bf16 v[184:187], a[244:247], v[100:103], v[184:187]
  ds_read_b64_tr_b16 a[212:213], v67 offset:49152
  v_lshrrev_b32 v66, 3, v48
  v_mfma_f32_16x16x32_bf16 v[188:191], a[244:247], v[108:111], v[188:191]
  ds_read_b64_tr_b16 a[214:215], v70 offset:0
  buffer_load_dwordx4 v57, s[24:27], s1 offen offset:2048 lds
  v_mfma_f32_16x16x32_bf16 v[72:75], a[244:247], v[120:123], v[72:75]
  ds_read_b64_tr_b16 a[232:233], v67 offset:10240
  v_lshrrev_b32 v53, 1, v5
  v_mfma_f32_16x16x32_bf16 v[196:199], a[244:247], v[124:127], v[196:199]
  s_lshl2_add_u32 s45, s66, s51
  ds_read_b64_tr_b16 a[234:235], v69 offset:26624
  v_mul_f32 v152, v152, v184
  v_mfma_f32_16x16x32_bf16 v[84:87], a[248:251], v[20:23], v[84:87]
  s_lshl2_add_u32 s66, s45, s40
  ds_read_b64_tr_b16 a[216:217], v67 offset:51200
  v_mul_f32 v153, v153, v185
  v_mfma_f32_16x16x32_bf16 v[136:139], a[248:251], v[32:35], v[136:139]
  s_lshl_b32 s66, s66, 12
  ds_read_b64_tr_b16 a[218:219], v70 offset:2048
  v_mul_f32 v154, v154, v186
  v_mfma_f32_16x16x32_bf16 v[156:159], a[248:251], v[12:15], v[156:159]
  s_add_u32 s66, s66, 0x100000
  buffer_load_dwordx4 v64, s[24:27], s1 offen offset:3072 lds
  v_mul_f32 v155, v155, v187
  v_mfma_f32_16x16x32_bf16 v[180:183], a[248:251], v[36:39], v[180:183]
  s_lshl_b32 s1, s45, 11
  v_mov_b32 v54, 1
  v_cvt_pk_bf16_f32 v76, v152, v153
  v_mfma_f32_16x16x32_bf16 v[148:151], a[164:167], v[36:39], v[148:151]
  v_cvt_pk_bf16_f32 v77, v154, v155
  v_mul_f32 v164, v164, v188
  v_mfma_f32_16x16x32_bf16 v[204:207], a[164:167], v[12:15], v[204:207]
  v_mul_f32 v165, v165, v189
  v_mul_f32 v166, v166, v190
  v_mfma_f32_16x16x32_bf16 v[200:203], a[164:167], v[32:35], v[200:203]
  v_mul_f32 v167, v167, v191
  v_cvt_pk_bf16_f32 v80, v164, v165
  v_mfma_f32_16x16x32_bf16 v[192:195], a[164:167], v[20:23], v[192:195]
  s_waitcnt lgkmcnt(0)
  v_cvt_pk_bf16_f32 v81, v166, v167
  v_mul_f32 v168, v168, v72
  v_mfma_f32_16x16x32_bf16 v[84:87], a[148:151], v[40:43], v[84:87]
  v_mul_f32 v169, v169, v73
  v_mul_f32 v170, v170, v74
  v_mfma_f32_16x16x32_bf16 v[136:139], a[148:151], v[44:47], v[136:139]
  s_waitcnt vmcnt(7)
  s_barrier
  v_mfma_f32_16x16x32_bf16 v[156:159], a[148:151], v[88:91], v[156:159]
  s_add_u32 m0, s0, 0x2000
  s_add_u32 s45, s48, 0x2d0180
  ds_read_b64_tr_b16 a[164:165], v52 offset:28672
  v_mfma_f32_16x16x32_bf16 v[180:183], a[148:151], v[92:95], v[180:183]
  s_add_u32 s1, s1, 0x500000
  ds_read_b64_tr_b16 a[166:167], v51 offset:45056
  buffer_store_dword v54, v0, s[36:39], s59 offen offset:0 sc1
  v_mfma_f32_16x16x32_bf16 v[148:151], a[212:215], v[92:95], v[148:151]
  ds_read_b64_tr_b16 a[244:245], v51 offset:4096
  v_mul_f32 v171, v171, v75
  v_mfma_f32_16x16x32_bf16 v[204:207], a[212:215], v[88:91], v[204:207]
  s_add_u32 s74, s47, 0xffffe000
  ds_read_b64_tr_b16 a[246:247], v68 offset:20480
  buffer_load_dwordx4 v63, s[24:27], s45 offen offset:0 lds
  v_mfma_f32_16x16x32_bf16 v[200:203], a[212:215], v[44:47], v[200:203]
  s_add_u32 s49, s47, 0x46000
  ds_read_b64_tr_b16 a[148:149], v52 offset:30720
  v_cvt_pk_bf16_f32 v96, v168, v169
  v_mfma_f32_16x16x32_bf16 v[192:195], a[212:215], v[40:43], v[192:195]
  ds_read_b64_tr_b16 a[150:151], v51 offset:47104
  v_cvt_pk_bf16_f32 v97, v170, v171
  v_mfma_f32_16x16x32_bf16 v[84:87], a[232:235], v[100:103], v[84:87]
  ds_read_b64_tr_b16 a[248:249], v51 offset:6144
  buffer_load_dwordx4 v56, s[24:27], s45 offen offset:1024 lds
  v_mfma_f32_16x16x32_bf16 v[136:139], a[232:235], v[108:111], v[136:139]
  ds_read_b64_tr_b16 a[250:251], v68 offset:22528
  v_mul_f32 v176, v176, v196
  v_mfma_f32_16x16x32_bf16 v[156:159], a[232:235], v[120:123], v[156:159]
  v_mul_f32 v177, v177, v197
  v_mul_f32 v178, v178, v198
  v_mfma_f32_16x16x32_bf16 v[180:183], a[232:235], v[124:127], v[180:183]
  buffer_load_dwordx4 v57, s[24:27], s45 offen offset:2048 lds
  v_mul_f32 v179, v179, v199
  v_mfma_f32_16x16x32_bf16 v[192:195], a[216:219], v[100:103], v[192:195]
  v_cvt_pk_bf16_f32 v72, v176, v177
  v_cvt_pk_bf16_f32 v73, v178, v179
  v_mfma_f32_16x16x32_bf16 v[200:203], a[216:219], v[108:111], v[200:203]
  v_lshl_add_u32 v66, v66, 1, v53
  v_mul_u32_u24 v66, 0xa000, v66
  v_mfma_f32_16x16x32_bf16 v[204:207], a[216:219], v[120:123], v[204:207]
  s_lshl_b32 s44, s44, 6
  buffer_load_dwordx4 v64, s[24:27], s45 offen offset:3072 lds
  s_add_u32 m0, s0, 0x5000
  v_mfma_f32_16x16x32_bf16 v[148:151], a[216:219], v[124:127], v[148:151]
  s_waitcnt lgkmcnt(0)
  s_add_u32 s45, s48, 0x360180
  v_mul_f32 v84, v84, v192
  v_mfma_f32_16x16x32_bf16 v[104:107], a[164:167], a[0:3], 0
  v_mul_f32 v85, v85, v193
  v_mul_f32 v86, v86, v194
  v_mfma_f32_16x16x32_bf16 v[112:115], a[164:167], a[8:11], 0
  buffer_load_dwordx4 v63, s[24:27], s45 offen offset:0 lds
  v_mul_f32 v87, v87, v195
  v_mfma_f32_16x16x32_bf16 v[116:119], a[164:167], a[12:15], 0
  ds_read_b64_tr_b16 a[212:213], v52 offset:4096
  v_cvt_pk_bf16_f32 v78, v84, v85
  v_mfma_f32_16x16x32_bf16 v[128:131], a[164:167], a[16:19], 0
  ds_read_b64_tr_b16 a[214:215], v51 offset:20480
  v_cvt_pk_bf16_f32 v79, v86, v87
  v_mfma_f32_16x16x32_bf16 v[132:135], a[244:247], a[0:3], 0
  ds_read_b64_tr_b16 a[216:217], v52 offset:45056
  v_mul_f32 v136, v136, v200
  v_mfma_f32_16x16x32_bf16 v[140:143], a[244:247], a[8:11], 0
  ds_read_b64_tr_b16 a[218:219], v51 offset:61440
  buffer_store_dwordx4 v[76:79], v62, s[36:39], s74 offen offset:0 sc1
  v_mfma_f32_16x16x32_bf16 v[144:147], a[244:247], a[12:15], 0
  ds_read_b64_tr_b16 a[232:233], v67 offset:28672
  v_mul_f32 v137, v137, v201
  v_mfma_f32_16x16x32_bf16 v[152:155], a[244:247], a[16:19], 0
  ds_read_b64_tr_b16 a[234:235], v69 offset:45056
  buffer_load_dwordx4 v56, s[24:27], s45 offen offset:1024 lds
  v_mfma_f32_16x16x32_bf16 v[104:107], a[148:151], a[40:43], v[104:107]
  ds_read_b64_tr_b16 a[164:165], v69 offset:4096
  v_mul_f32 v138, v138, v202
  v_mfma_f32_16x16x32_bf16 v[112:115], a[148:151], a[4:7], v[112:115]
  ds_read_b64_tr_b16 a[166:167], v70 offset:20480
  v_mul_f32 v139, v139, v203
  v_mfma_f32_16x16x32_bf16 v[116:119], a[148:151], a[48:51], v[116:119]
  buffer_load_dwordx4 v57, s[24:27], s45 offen offset:2048 lds
  v_cvt_pk_bf16_f32 v82, v136, v137
  v_mfma_f32_16x16x32_bf16 v[128:131], a[148:151], a[52:55], v[128:131]
  v_cvt_pk_bf16_f32 v83, v138, v139
  v_mul_f32 v156, v156, v204
  v_mfma_f32_16x16x32_bf16 v[152:155], a[248:251], a[52:55], v[152:155]
  buffer_store_dwordx4 v[80:83], v62, s[36:39], s74 offen offset:1024 sc1
  v_mfma_f32_16x16x32_bf16 v[144:147], a[248:251], a[48:51], v[144:147]
  v_mul_f32 v157, v157, v205
  v_mul_f32 v158, v158, v206
  v_mfma_f32_16x16x32_bf16 v[140:143], a[248:251], a[4:7], v[140:143]
  v_mul_f32 v159, v159, v207
  v_cvt_pk_bf16_f32 v98, v156, v157
  v_mfma_f32_16x16x32_bf16 v[132:135], a[248:251], a[40:43], v[132:135]
  s_waitcnt lgkmcnt(0)
  v_cvt_pk_bf16_f32 v99, v158, v159
  v_mul_f32 v180, v180, v148
  v_mfma_f32_16x16x32_bf16 v[104:107], a[212:215], a[32:35], v[104:107]
  v_mul_f32 v181, v181, v149
  v_mul_f32 v182, v182, v150
  v_mfma_f32_16x16x32_bf16 v[112:115], a[212:215], a[44:47], v[112:115]
  v_mul_f32 v183, v183, v151
  v_cvt_pk_bf16_f32 v74, v180, v181
  v_mfma_f32_16x16x32_bf16 v[116:119], a[212:215], a[64:67], v[116:119]
  ds_read_b64_tr_b16 a[148:149], v67 offset:30720
  buffer_load_dwordx4 v64, s[24:27], s45 offen offset:3072 lds
  v_mfma_f32_16x16x32_bf16 v[128:131], a[212:215], a[68:71], v[128:131]
  s_add_u32 m0, s0, 0x6000
  s_add_u32 s45, s48, 0x3f0180
  ds_read_b64_tr_b16 a[150:151], v69 offset:47104
  v_mfma_f32_16x16x32_bf16 v[152:155], a[216:219], a[68:71], v[152:155]
  ds_read_b64_tr_b16 a[244:245], v69 offset:6144
  v_cvt_pk_bf16_f32 v75, v182, v183
  v_mfma_f32_16x16x32_bf16 v[144:147], a[216:219], a[64:67], v[144:147]
  ds_read_b64_tr_b16 a[246:247], v70 offset:22528
  buffer_store_dwordx4 v[96:99], v62, s[36:39], s49 offen offset:0 sc1
  v_mfma_f32_16x16x32_bf16 v[140:143], a[216:219], a[44:47], v[140:143]
  ds_read_b64_tr_b16 a[248:249], v67 offset:4096
  v_xad_u32 v60, v60, s44, v66
  v_mfma_f32_16x16x32_bf16 v[132:135], a[216:219], a[32:35], v[132:135]
  ds_read_b64_tr_b16 a[250:251], v69 offset:20480
  v_xor_b32 v53, 32, v60
  v_mfma_f32_16x16x32_bf16 v[76:79], a[232:235], a[0:3], 0
  ds_read_b64_tr_b16 a[212:213], v67 offset:45056
  v_xor_b32 v54, 64, v60
  v_mfma_f32_16x16x32_bf16 v[80:83], a[232:235], a[8:11], 0
  ds_read_b64_tr_b16 a[214:215], v69 offset:61440
  v_xor_b32 v55, 0x60, v60
  v_mfma_f32_16x16x32_bf16 v[84:87], a[232:235], a[12:15], 0
  v_lshl_add_u32 v61, v65, 1, v61
  v_lshl_add_u32 v61, v61, 4, v66
  v_mfma_f32_16x16x32_bf16 v[96:99], a[232:235], a[16:19], 0
  v_mfma_f32_16x16x32_bf16 v[136:139], a[164:167], a[0:3], 0
  buffer_load_dwordx4 v63, s[24:27], s45 offen offset:0 lds
  v_mfma_f32_16x16x32_bf16 v[148:151], a[164:167], a[8:11], 0
  v_mfma_f32_16x16x32_bf16 v[156:159], a[164:167], a[12:15], 0
  buffer_store_dwordx4 v[72:75], v62, s[36:39], s49 offen offset:1024 sc1
  v_mfma_f32_16x16x32_bf16 v[160:163], a[164:167], a[16:19], 0
  s_waitcnt lgkmcnt(0)
  v_mfma_f32_16x16x32_bf16 v[76:79], a[148:151], a[40:43], v[76:79]
  v_mfma_f32_16x16x32_bf16 v[80:83], a[148:151], a[4:7], v[80:83]
  v_mfma_f32_16x16x32_bf16 v[84:87], a[148:151], a[48:51], v[84:87]
  ds_read_b64_tr_b16 a[216:217], v52 offset:6144
  v_mfma_f32_16x16x32_bf16 v[96:99], a[148:151], a[52:55], v[96:99]
  ds_read_b64_tr_b16 a[218:219], v51 offset:22528
  v_mfma_f32_16x16x32_bf16 v[160:163], a[244:247], a[52:55], v[160:163]
  ds_read_b64_tr_b16 a[0:1], v52 offset:47104
  v_mfma_f32_16x16x32_bf16 v[156:159], a[244:247], a[48:51], v[156:159]
  ds_read_b64_tr_b16 a[2:3], v51 offset:63488
  v_mfma_f32_16x16x32_bf16 v[148:151], a[244:247], a[4:7], v[148:151]
  ds_read_b64_tr_b16 a[8:9], v67 offset:6144
  v_mfma_f32_16x16x32_bf16 v[136:139], a[244:247], a[40:43], v[136:139]
  ds_read_b64_tr_b16 a[10:11], v69 offset:22528
  v_mfma_f32_16x16x32_bf16 v[76:79], a[248:251], a[32:35], v[76:79]
  ds_read_b64_tr_b16 a[12:13], v67 offset:47104
  v_mfma_f32_16x16x32_bf16 v[80:83], a[248:251], a[44:47], v[80:83]
  ds_read_b64_tr_b16 a[14:15], v69 offset:63488
  v_mfma_f32_16x16x32_bf16 v[84:87], a[248:251], a[64:67], v[84:87]
  buffer_load_dwordx4 v56, s[24:27], s45 offen offset:1024 lds
  v_mfma_f32_16x16x32_bf16 v[96:99], a[248:251], a[68:71], v[96:99]
  v_mfma_f32_16x16x32_bf16 v[160:163], a[212:215], a[68:71], v[160:163]
  v_mfma_f32_16x16x32_bf16 v[156:159], a[212:215], a[64:67], v[156:159]
  v_mfma_f32_16x16x32_bf16 v[148:151], a[212:215], a[44:47], v[148:151]
  v_mfma_f32_16x16x32_bf16 v[136:139], a[212:215], a[32:35], v[136:139]
  s_waitcnt lgkmcnt(0)
  buffer_load_dwordx4 v57, s[24:27], s45 offen offset:2048 lds
  v_mfma_f32_16x16x32_bf16 v[104:107], a[216:219], a[36:39], v[104:107]
  v_mfma_f32_16x16x32_bf16 v[112:115], a[216:219], a[76:79], v[112:115]
  s_waitcnt vmcnt(20)
  s_barrier
  v_mfma_f32_16x16x32_bf16 v[116:119], a[216:219], a[80:83], v[116:119]
  ds_read_b64_tr_b16 a[4:5], v52 offset:12288
  buffer_load_dwordx4 a[16:19], v62, s[36:39], s66 offen offset:0 sc1
  v_mfma_f32_16x16x32_bf16 v[128:131], a[216:219], a[56:59], v[128:131]
  ds_read_b64_tr_b16 a[6:7], v51 offset:28672
  v_mfma_f32_16x16x32_bf16 v[152:155], a[0:3], a[56:59], v[152:155]
  ds_read_b64_tr_b16 a[32:33], v52 offset:53248
  v_mfma_f32_16x16x32_bf16 v[144:147], a[0:3], a[80:83], v[144:147]
  ds_read_b64_tr_b16 a[34:35], v68 offset:4096
  v_mfma_f32_16x16x32_bf16 v[140:143], a[0:3], a[76:79], v[140:143]
  ds_read_b64_tr_b16 a[40:41], v67 offset:12288
  v_mfma_f32_16x16x32_bf16 v[132:135], a[0:3], a[36:39], v[132:135]
  ds_read_b64_tr_b16 a[42:43], v69 offset:28672
  v_mfma_f32_16x16x32_bf16 v[76:79], a[8:11], a[36:39], v[76:79]
  ds_read_b64_tr_b16 a[44:45], v67 offset:53248
  v_mfma_f32_16x16x32_bf16 v[80:83], a[8:11], a[76:79], v[80:83]
  ds_read_b64_tr_b16 a[46:47], v70 offset:4096
  buffer_load_dwordx4 v64, s[24:27], s45 offen offset:3072 lds
  v_mfma_f32_16x16x32_bf16 v[84:87], a[8:11], a[80:83], v[84:87]
  s_add_u32 m0, s0, 0x1000
  s_add_u32 s74, s48, 0x480180
  v_mfma_f32_16x16x32_bf16 v[96:99], a[8:11], a[56:59], v[96:99]
  buffer_load_dwordx4 a[48:51], v62, s[36:39], s66 offen offset:1024 sc1
  v_mfma_f32_16x16x32_bf16 v[160:163], a[12:15], a[56:59], v[160:163]
  v_mfma_f32_16x16x32_bf16 v[156:159], a[12:15], a[80:83], v[156:159]
  v_mfma_f32_16x16x32_bf16 v[148:151], a[12:15], a[76:79], v[148:151]
  v_mfma_f32_16x16x32_bf16 v[136:139], a[12:15], a[36:39], v[136:139]
  s_waitcnt lgkmcnt(0)
  v_mfma_f32_16x16x32_bf16 v[104:107], a[4:7], a[60:63], v[104:107]
  v_mfma_f32_16x16x32_bf16 v[112:115], a[4:7], a[92:95], v[112:115]
  v_mfma_f32_16x16x32_bf16 v[116:119], a[4:7], a[96:99], v[116:119]
  ds_read_b64_tr_b16 a[0:1], v52 offset:14336
  v_mfma_f32_16x16x32_bf16 v[128:131], a[4:7], a[20:23], v[128:131]
  ds_read_b64_tr_b16 a[2:3], v51 offset:30720
  v_mfma_f32_16x16x32_bf16 v[152:155], a[32:35], a[20:23], v[152:155]
  ds_read_b64_tr_b16 a[8:9], v52 offset:55296
  v_mfma_f32_16x16x32_bf16 v[144:147], a[32:35], a[96:99], v[144:147]
  ds_read_b64_tr_b16 a[10:11], v68 offset:6144
  v_mfma_f32_16x16x32_bf16 v[140:143], a[32:35], a[92:95], v[140:143]
  ds_read_b64_tr_b16 a[12:13], v67 offset:14336
  buffer_load_dwordx4 v63, s[24:27], s74 offen offset:0 lds
  v_mfma_f32_16x16x32_bf16 v[132:135], a[32:35], a[60:63], v[132:135]
  ds_read_b64_tr_b16 a[14:15], v69 offset:30720
  v_mfma_f32_16x16x32_bf16 v[76:79], a[40:43], a[60:63], v[76:79]
  ds_read_b64_tr_b16 a[4:5], v67 offset:55296
  buffer_load_dwordx4 a[36:39], v62, s[36:39], s66 offen offset:2048 sc1
  v_mfma_f32_16x16x32_bf16 v[80:83], a[40:43], a[92:95], v[80:83]
  ds_read_b64_tr_b16 a[6:7], v70 offset:6144
  v_mfma_f32_16x16x32_bf16 v[84:87], a[40:43], a[96:99], v[84:87]
  v_mfma_f32_16x16x32_bf16 v[96:99], a[40:43], a[20:23], v[96:99]
  v_mfma_f32_16x16x32_bf16 v[160:163], a[44:47], a[20:23], v[160:163]
  v_mfma_f32_16x16x32_bf16 v[156:159], a[44:47], a[96:99], v[156:159]
  buffer_load_dword v63, v7, s[36:39], s58 offen offset:0 sc1
  v_mfma_f32_16x16x32_bf16 v[148:151], a[44:47], a[92:95], v[148:151]
  v_mfma_f32_16x16x32_bf16 v[136:139], a[44:47], a[60:63], v[136:139]
  s_waitcnt lgkmcnt(0)
  buffer_load_dwordx4 v56, s[24:27], s74 offen offset:1024 lds
  v_mfma_f32_16x16x32_bf16 v[104:107], a[0:3], a[72:75], v[104:107]
  v_mfma_f32_16x16x32_bf16 v[112:115], a[0:3], a[108:111], v[112:115]
  buffer_load_dwordx4 a[32:35], v62, s[36:39], s66 offen offset:3072 sc1
  s_add_u32 s44, s34, 0
  v_mfma_f32_16x16x32_bf16 v[116:119], a[0:3], a[112:115], v[116:119]
  ds_read_b64_tr_b16 a[20:21], v52 offset:0
  v_mfma_f32_16x16x32_bf16 v[128:131], a[0:3], a[100:103], v[128:131]
  ds_read_b64_tr_b16 a[22:23], v51 offset:16384
  buffer_load_dwordx4 a[40:43], v62, s[36:39], s44 offen offset:0 sc1
  v_mfma_f32_16x16x32_bf16 v[152:155], a[8:11], a[100:103], v[152:155]
  ds_read_b64_tr_b16 a[44:45], v52 offset:40960
  v_mfma_f32_16x16x32_bf16 v[144:147], a[8:11], a[112:115], v[144:147]
  ds_read_b64_tr_b16 a[46:47], v51 offset:57344
  buffer_load_dwordx4 v57, s[24:27], s74 offen offset:2048 lds
  v_mfma_f32_16x16x32_bf16 v[140:143], a[8:11], a[108:111], v[140:143]
  ds_read_b64_tr_b16 a[52:53], v67 offset:0
  v_mfma_f32_16x16x32_bf16 v[132:135], a[8:11], a[72:75], v[132:135]
  ds_read_b64_tr_b16 a[54:55], v69 offset:16384
  buffer_load_dwordx4 a[0:3], v62, s[36:39], s44 offen offset:1024 sc1
  v_mfma_f32_16x16x32_bf16 v[76:79], a[12:15], a[72:75], v[76:79]
  ds_read_b64_tr_b16 a[56:57], v67 offset:40960
  v_mfma_f32_16x16x32_bf16 v[80:83], a[12:15], a[108:111], v[80:83]
  ds_read_b64_tr_b16 a[58:59], v69 offset:57344
  buffer_load_dwordx4 v64, s[24:27], s74 offen offset:3072 lds
  v_mfma_f32_16x16x32_bf16 v[84:87], a[12:15], a[112:115], v[84:87]
  s_add_u32 m0, s4, 0x7000
  s_add_u32 s45, s10, 0
  v_mfma_f32_16x16x32_bf16 v[96:99], a[12:15], a[100:103], v[96:99]
  buffer_load_dwordx4 a[8:11], v62, s[36:39], s44 offen offset:2048 sc1
  v_mfma_f32_16x16x32_bf16 v[160:163], a[4:7], a[100:103], v[160:163]
  v_mfma_f32_16x16x32_bf16 v[156:159], a[4:7], a[112:115], v[156:159]
  v_mfma_f32_16x16x32_bf16 v[148:151], a[4:7], a[108:111], v[148:151]
  v_mfma_f32_16x16x32_bf16 v[136:139], a[4:7], a[72:75], v[136:139]
  s_waitcnt lgkmcnt(0)
  v_mfma_f32_16x16x32_bf16 v[104:107], a[20:23], a[88:91], v[104:107]
  v_mfma_f32_16x16x32_bf16 v[112:115], a[20:23], a[124:127], v[112:115]
  v_mfma_f32_16x16x32_bf16 v[116:119], a[20:23], a[116:119], v[116:119]
  ds_read_b64_tr_b16 a[60:61], v52 offset:2048
  v_mfma_f32_16x16x32_bf16 v[128:131], a[20:23], a[24:27], v[128:131]
  ds_read_b64_tr_b16 a[62:63], v51 offset:18432
  v_mfma_f32_16x16x32_bf16 v[152:155], a[44:47], a[24:27], v[152:155]
  ds_read_b64_tr_b16 a[12:13], v52 offset:43008
  v_mfma_f32_16x16x32_bf16 v[144:147], a[44:47], a[116:119], v[144:147]
  ds_read_b64_tr_b16 a[14:15], v51 offset:59392
  v_mfma_f32_16x16x32_bf16 v[140:143], a[44:47], a[124:127], v[140:143]
  ds_read_b64_tr_b16 a[4:5], v67 offset:2048
  v_mfma_f32_16x16x32_bf16 v[132:135], a[44:47], a[88:91], v[132:135]
  ds_read_b64_tr_b16 a[6:7], v69 offset:18432
  v_mfma_f32_16x16x32_bf16 v[76:79], a[52:55], a[88:91], v[76:79]
  ds_read_b64_tr_b16 a[64:65], v67 offset:43008
  v_mfma_f32_16x16x32_bf16 v[80:83], a[52:55], a[124:127], v[80:83]
  ds_read_b64_tr_b16 a[66:67], v69 offset:59392
  v_mfma_f32_16x16x32_bf16 v[84:87], a[52:55], a[116:119], v[84:87]
  v_mfma_f32_16x16x32_bf16 v[96:99], a[52:55], a[24:27], v[96:99]
  v_mfma_f32_16x16x32_bf16 v[160:163], a[56:59], a[24:27], v[160:163]
  v_mfma_f32_16x16x32_bf16 v[156:159], a[56:59], a[116:119], v[156:159]
  v_mfma_f32_16x16x32_bf16 v[148:151], a[56:59], a[124:127], v[148:151]
  v_mfma_f32_16x16x32_bf16 v[136:139], a[56:59], a[88:91], v[136:139]
  s_waitcnt lgkmcnt(0)
  v_mfma_f32_16x16x32_bf16 v[104:107], a[60:63], a[104:107], v[104:107]
  v_mfma_f32_16x16x32_bf16 v[112:115], a[60:63], a[140:143], v[112:115]
  s_waitcnt vmcnt(24)
  s_barrier
  v_mfma_f32_16x16x32_bf16 v[116:119], a[60:63], a[144:147], v[116:119]
  ds_read_b64_tr_b16 a[20:21], v52 offset:16384
  v_mfma_f32_16x16x32_bf16 v[128:131], a[60:63], a[28:31], v[128:131]
  ds_read_b64_tr_b16 a[22:23], v51 offset:32768
  v_mfma_f32_16x16x32_bf16 v[152:155], a[12:15], a[28:31], v[152:155]
  ds_read_b64_tr_b16 a[24:25], v52 offset:57344
  v_mfma_f32_16x16x32_bf16 v[144:147], a[12:15], a[144:147], v[144:147]
  ds_read_b64_tr_b16 a[26:27], v68 offset:8192
  v_mfma_f32_16x16x32_bf16 v[140:143], a[12:15], a[140:143], v[140:143]
  ds_read_b64_tr_b16 a[44:45], v67 offset:16384
  v_mfma_f32_16x16x32_bf16 v[132:135], a[12:15], a[104:107], v[132:135]
  ds_read_b64_tr_b16 a[46:47], v69 offset:32768
  v_mfma_f32_16x16x32_bf16 v[76:79], a[4:7], a[104:107], v[76:79]
  ds_read_b64_tr_b16 a[52:53], v67 offset:57344
  v_mfma_f32_16x16x32_bf16 v[80:83], a[4:7], a[140:143], v[80:83]
  ds_read_b64_tr_b16 a[54:55], v70 offset:8192
  v_mfma_f32_16x16x32_bf16 v[84:87], a[4:7], a[144:147], v[84:87]
  s_waitcnt vmcnt(7)
  buffer_load_dwordx4 v71, s[12:15], s45 offen offset:0 lds
  v_cmp_gt_i32 vcc, 1, v63
  v_mfma_f32_16x16x32_bf16 v[96:99], a[4:7], a[28:31], v[96:99]
  s_nop 3
  s_and_b64 vcc, vcc, s[42:43]
  v_mfma_f32_16x16x32_bf16 v[160:163], a[64:67], a[28:31], v[160:163]
  s_cbranch_vccnz L_rf1
L_bf1:
  buffer_load_dwordx4 a[12:15], v62, s[36:39], s44 offen offset:3072 sc1
  s_add_u32 s44, s34, 0x1000
  v_mfma_f32_16x16x32_bf16 v[156:159], a[64:67], a[144:147], v[156:159]
  s_add_u32 s74, s53, 0x4000
  v_lshrrev_b32 v56, 1, v62
  v_mfma_f32_16x16x32_bf16 v[148:151], a[64:67], a[140:143], v[148:151]
  buffer_load_dwordx4 a[4:7], v62, s[36:39], s44 offen offset:0 sc1
  v_mfma_f32_16x16x32_bf16 v[136:139], a[64:67], a[104:107], v[136:139]
  s_waitcnt lgkmcnt(0)
  v_mfma_f32_16x16x32_bf16 v[104:107], a[20:23], a[120:123], v[104:107]
  v_mfma_f32_16x16x32_bf16 v[112:115], a[20:23], a[156:159], v[112:115]
  v_mfma_f32_16x16x32_bf16 v[116:119], a[20:23], a[160:163], v[116:119]
  ds_read_b64_tr_b16 a[28:29], v52 offset:18432
  v_mfma_f32_16x16x32_bf16 v[128:131], a[20:23], a[84:87], v[128:131]
  ds_read_b64_tr_b16 a[30:31], v51 offset:34816
  v_mfma_f32_16x16x32_bf16 v[152:155], a[24:27], a[84:87], v[152:155]
  ds_read_b64_tr_b16 a[56:57], v52 offset:59392
  v_mfma_f32_16x16x32_bf16 v[144:147], a[24:27], a[160:163], v[144:147]
  ds_read_b64_tr_b16 a[58:59], v68 offset:10240
  v_mfma_f32_16x16x32_bf16 v[140:143], a[24:27], a[156:159], v[140:143]
  ds_read_b64_tr_b16 a[60:61], v67 offset:18432
  buffer_load_dwordx4 v2, s[12:15], s45 offen offset:1024 lds
  v_mfma_f32_16x16x32_bf16 v[132:135], a[24:27], a[120:123], v[132:135]
  s_add_u32 m0, s5, 0x7000
  s_add_u32 s10, s10, 0x9000
  ds_read_b64_tr_b16 a[62:63], v69 offset:34816
  v_mfma_f32_16x16x32_bf16 v[76:79], a[44:47], a[120:123], v[76:79]
  ds_read_b64_tr_b16 a[20:21], v67 offset:59392
  buffer_load_dwordx4 a[64:67], v62, s[36:39], s44 offen offset:1024 sc1
  v_mfma_f32_16x16x32_bf16 v[80:83], a[44:47], a[156:159], v[80:83]
  ds_read_b64_tr_b16 a[22:23], v70 offset:10240
  v_mfma_f32_16x16x32_bf16 v[84:87], a[44:47], a[160:163], v[84:87]
  v_mfma_f32_16x16x32_bf16 v[96:99], a[44:47], a[84:87], v[96:99]
  v_mfma_f32_16x16x32_bf16 v[160:163], a[52:55], a[84:87], v[160:163]
  v_mfma_f32_16x16x32_bf16 v[156:159], a[52:55], a[160:163], v[156:159]
  v_mfma_f32_16x16x32_bf16 v[148:151], a[52:55], a[156:159], v[148:151]
  v_mfma_f32_16x16x32_bf16 v[136:139], a[52:55], a[120:123], v[136:139]
  s_waitcnt lgkmcnt(0)
  v_mfma_f32_16x16x32_bf16 v[104:107], a[28:31], a[136:139], v[104:107]
  v_mfma_f32_16x16x32_bf16 v[112:115], a[28:31], a[172:175], v[112:115]
  v_mfma_f32_16x16x32_bf16 v[116:119], a[28:31], a[176:179], v[116:119]
  ds_read_b64_tr_b16 a[24:25], v52 offset:8192
  buffer_load_dwordx4 v71, s[12:15], s10 offen offset:0 lds
  v_mfma_f32_16x16x32_bf16 v[128:131], a[28:31], a[128:131], v[128:131]
  ds_read_b64_tr_b16 a[26:27], v51 offset:24576
  v_mfma_f32_16x16x32_bf16 v[152:155], a[56:59], a[128:131], v[152:155]
  ds_read_b64_tr_b16 a[44:45], v52 offset:49152
  v_mfma_f32_16x16x32_bf16 v[144:147], a[56:59], a[176:179], v[144:147]
  ds_read_b64_tr_b16 a[46:47], v68 offset:0
  v_mfma_f32_16x16x32_bf16 v[140:143], a[56:59], a[172:175], v[140:143]
  ds_read_b64_tr_b16 a[52:53], v67 offset:8192
  v_mfma_f32_16x16x32_bf16 v[132:135], a[56:59], a[136:139], v[132:135]
  ds_read_b64_tr_b16 a[54:55], v69 offset:24576
  v_mfma_f32_16x16x32_bf16 v[76:79], a[60:63], a[136:139], v[76:79]
  ds_read_b64_tr_b16 a[68:69], v67 offset:49152
  buffer_load_dwordx4 v2, s[12:15], s10 offen offset:1024 lds
  v_mfma_f32_16x16x32_bf16 v[80:83], a[60:63], a[172:175], v[80:83]
  s_add_u32 m0, s4, 0
  s_add_u32 s10, s6, 0
  ds_read_b64_tr_b16 a[70:71], v70 offset:0
  v_mfma_f32_16x16x32_bf16 v[84:87], a[60:63], a[176:179], v[84:87]
  buffer_load_dwordx4 a[28:31], v62, s[36:39], s44 offen offset:2048 sc1
  v_mfma_f32_16x16x32_bf16 v[96:99], a[60:63], a[128:131], v[96:99]
  v_mfma_f32_16x16x32_bf16 v[160:163], a[20:23], a[128:131], v[160:163]
  v_mfma_f32_16x16x32_bf16 v[156:159], a[20:23], a[176:179], v[156:159]
  v_mfma_f32_16x16x32_bf16 v[148:151], a[20:23], a[172:175], v[148:151]
  v_mfma_f32_16x16x32_bf16 v[136:139], a[20:23], a[136:139], v[136:139]
  s_waitcnt lgkmcnt(0)
  v_mfma_f32_16x16x32_bf16 v[104:107], a[24:27], a[152:155], v[104:107]
  v_mfma_f32_16x16x32_bf16 v[112:115], a[24:27], a[188:191], v[112:115]
  v_mfma_f32_16x16x32_bf16 v[116:119], a[24:27], a[192:195], v[116:119]
  ds_read_b64_tr_b16 a[56:57], v52 offset:10240
  v_mfma_f32_16x16x32_bf16 v[128:131], a[24:27], a[180:183], v[128:131]
  ds_read_b64_tr_b16 a[58:59], v51 offset:26624
  v_mfma_f32_16x16x32_bf16 v[152:155], a[44:47], a[180:183], v[152:155]
  ds_read_b64_tr_b16 a[60:61], v52 offset:51200
  v_mfma_f32_16x16x32_bf16 v[144:147], a[44:47], a[192:195], v[144:147]
  ds_read_b64_tr_b16 a[62:63], v68 offset:2048
  buffer_load_dwordx4 v71, s[12:15], s10 offen offset:0 lds
  v_mfma_f32_16x16x32_bf16 v[140:143], a[44:47], a[188:191], v[140:143]
  ds_read_b64_tr_b16 a[20:21], v67 offset:10240
  v_mfma_f32_16x16x32_bf16 v[132:135], a[44:47], a[152:155], v[132:135]
  ds_read_b64_tr_b16 a[22:23], v69 offset:26624
  buffer_load_dwordx4 a[72:75], v62, s[36:39], s44 offen offset:3072 sc1
  v_mfma_f32_16x16x32_bf16 v[76:79], a[52:55], a[152:155], v[76:79]
  ds_read_b64_tr_b16 a[24:25], v67 offset:51200
  v_mfma_f32_16x16x32_bf16 v[80:83], a[52:55], a[188:191], v[80:83]
  ds_read_b64_tr_b16 a[26:27], v70 offset:2048
  v_mfma_f32_16x16x32_bf16 v[84:87], a[52:55], a[192:195], v[84:87]
  v_mfma_f32_16x16x32_bf16 v[96:99], a[52:55], a[180:183], v[96:99]
  v_mfma_f32_16x16x32_bf16 v[160:163], a[68:71], a[180:183], v[160:163]
  v_mfma_f32_16x16x32_bf16 v[156:159], a[68:71], a[192:195], v[156:159]
  v_mfma_f32_16x16x32_bf16 v[148:151], a[68:71], a[188:191], v[148:151]
  v_mfma_f32_16x16x32_bf16 v[136:139], a[68:71], a[152:155], v[136:139]
  s_waitcnt lgkmcnt(0)
  v_mfma_f32_16x16x32_bf16 v[104:107], a[56:59], a[168:171], v[104:107]
  v_mfma_f32_16x16x32_bf16 v[112:115], a[56:59], a[204:207], v[112:115]
  s_waitcnt vmcnt(11)
  s_barrier
  v_mfma_f32_16x16x32_bf16 v[116:119], a[56:59], a[196:199], v[116:119]
  s_add_u32 s44, s34, 0x2000
  ds_read_b64_tr_b16 a[44:45], v52 offset:20480
  buffer_load_dwordx4 v2, s[12:15], s10 offen offset:1024 lds
  v_mfma_f32_16x16x32_bf16 v[128:131], a[56:59], a[208:211], v[128:131]
  s_add_u32 m0, s5, 0
  s_add_u32 s6, s6, 0x9000
  ds_read_b64_tr_b16 a[46:47], v51 offset:36864
  v_mfma_f32_16x16x32_bf16 v[152:155], a[60:63], a[208:211], v[152:155]
  ds_read_b64_tr_b16 a[52:53], v52 offset:61440
  buffer_load_dwordx2 a[68:69], v56, s[36:39], s1 offen offset:0 sc1
  v_mfma_f32_16x16x32_bf16 v[144:147], a[60:63], a[196:199], v[144:147]
  ds_read_b64_tr_b16 a[54:55], v68 offset:12288
  v_mfma_f32_16x16x32_bf16 v[140:143], a[60:63], a[204:207], v[140:143]
  ds_read_b64_tr_b16 a[76:77], v67 offset:20480
  buffer_load_dwordx2 a[70:71], v56, s[36:39], s1 offen offset:512 sc1
  v_mfma_f32_16x16x32_bf16 v[132:135], a[60:63], a[168:171], v[132:135]
  ds_read_b64_tr_b16 a[78:79], v69 offset:36864
  v_mfma_f32_16x16x32_bf16 v[76:79], a[20:23], a[168:171], v[76:79]
  ds_read_b64_tr_b16 a[56:57], v67 offset:61440
  buffer_load_dwordx2 a[80:81], v56, s[36:39], s1 offen offset:1024 sc1
  v_mfma_f32_16x16x32_bf16 v[80:83], a[20:23], a[204:207], v[80:83]
  ds_read_b64_tr_b16 a[58:59], v70 offset:12288
  v_mfma_f32_16x16x32_bf16 v[84:87], a[20:23], a[196:199], v[84:87]
  buffer_load_dwordx2 a[82:83], v56, s[36:39], s1 offen offset:1536 sc1
  s_xor_b32 s1, s66, 0x1000
  v_mfma_f32_16x16x32_bf16 v[96:99], a[20:23], a[208:211], v[96:99]
  v_mfma_f32_16x16x32_bf16 v[160:163], a[24:27], a[208:211], v[160:163]
  buffer_load_dwordx4 a[60:63], v62, s[36:39], s1 offen offset:0 sc1
  v_mfma_f32_16x16x32_bf16 v[156:159], a[24:27], a[196:199], v[156:159]
  v_mfma_f32_16x16x32_bf16 v[148:151], a[24:27], a[204:207], v[148:151]
  buffer_load_dwordx4 a[84:87], v62, s[36:39], s1 offen offset:1024 sc1
  v_mfma_f32_16x16x32_bf16 v[136:139], a[24:27], a[168:171], v[136:139]
  s_waitcnt lgkmcnt(0)
  v_mfma_f32_16x16x32_bf16 v[104:107], a[44:47], a[184:187], v[104:107]
  buffer_load_dwordx4 a[88:91], v62, s[36:39], s1 offen offset:2048 sc1
  v_mfma_f32_16x16x32_bf16 v[112:115], a[44:47], a[220:223], v[112:115]
  v_mfma_f32_16x16x32_bf16 v[116:119], a[44:47], a[224:227], v[116:119]
  ds_read_b64_tr_b16 a[20:21], v52 offset:22528
  buffer_load_dwordx4 a[92:95], v62, s[36:39], s1 offen offset:3072 sc1
  v_mfma_f32_16x16x32_bf16 v[128:131], a[44:47], a[132:135], v[128:131]
  s_xor_b32 s1, s66, 0x2000
  ds_read_b64_tr_b16 a[22:23], v51 offset:38912
  v_mfma_f32_16x16x32_bf16 v[152:155], a[52:55], a[132:135], v[152:155]
  ds_read_b64_tr_b16 a[24:25], v52 offset:63488
  buffer_load_dwordx4 a[96:99], v62, s[36:39], s1 offen offset:0 sc1
  v_mfma_f32_16x16x32_bf16 v[144:147], a[52:55], a[224:227], v[144:147]
  ds_read_b64_tr_b16 a[26:27], v68 offset:14336
  v_mfma_f32_16x16x32_bf16 v[140:143], a[52:55], a[220:223], v[140:143]
  ds_read_b64_tr_b16 a[100:101], v67 offset:22528
  buffer_load_dwordx4 a[104:107], v62, s[36:39], s1 offen offset:1024 sc1
  v_mfma_f32_16x16x32_bf16 v[132:135], a[52:55], a[184:187], v[132:135]
  ds_read_b64_tr_b16 a[102:103], v69 offset:38912
  v_mfma_f32_16x16x32_bf16 v[76:79], a[76:79], a[184:187], v[76:79]
  ds_read_b64_tr_b16 a[44:45], v67 offset:63488
  buffer_load_dwordx4 a[108:111], v62, s[36:39], s1 offen offset:2048 sc1
  v_mfma_f32_16x16x32_bf16 v[80:83], a[76:79], a[220:223], v[80:83]
  ds_read_b64_tr_b16 a[46:47], v70 offset:14336
  v_mfma_f32_16x16x32_bf16 v[84:87], a[76:79], a[224:227], v[84:87]
  buffer_load_dwordx4 a[112:115], v62, s[36:39], s1 offen offset:3072 sc1
  s_xor_b32 s1, s66, 0x3000
  v_mfma_f32_16x16x32_bf16 v[96:99], a[76:79], a[132:135], v[96:99]
  v_mfma_f32_16x16x32_bf16 v[160:163], a[56:59], a[132:135], v[160:163]
  buffer_load_dwordx4 a[52:55], v62, s[36:39], s1 offen offset:0 sc1
  v_mfma_f32_16x16x32_bf16 v[156:159], a[56:59], a[224:227], v[156:159]
  v_mfma_f32_16x16x32_bf16 v[148:151], a[56:59], a[220:223], v[148:151]
  buffer_load_dwordx4 a[116:119], v62, s[36:39], s1 offen offset:1024 sc1
  v_mfma_f32_16x16x32_bf16 v[136:139], a[56:59], a[184:187], v[136:139]
  s_waitcnt lgkmcnt(0)
  v_mfma_f32_16x16x32_bf16 v[104:107], a[20:23], a[200:203], v[104:107]
  buffer_load_dwordx4 a[120:123], v62, s[36:39], s1 offen offset:2048 sc1
  v_mfma_f32_16x16x32_bf16 v[112:115], a[20:23], a[236:239], v[112:115]
  v_mfma_f32_16x16x32_bf16 v[116:119], a[20:23], a[240:243], v[116:119]
  ds_read_b64_tr_b16 a[76:77], v52 offset:24576
  buffer_load_dwordx4 a[124:127], v62, s[36:39], s1 offen offset:3072 sc1
  v_mfma_f32_16x16x32_bf16 v[128:131], a[20:23], a[228:231], v[128:131]
  s_add_u32 s1, s53, 0
  ds_read_b64_tr_b16 a[78:79], v51 offset:40960
  v_mfma_f32_16x16x32_bf16 v[152:155], a[24:27], a[228:231], v[152:155]
  ds_read_b64_tr_b16 a[56:57], v51 offset:0
  buffer_load_dwordx4 a[128:131], v62, s[36:39], s44 offen offset:0 sc1
  v_mfma_f32_16x16x32_bf16 v[144:147], a[24:27], a[240:243], v[144:147]
  ds_read_b64_tr_b16 a[58:59], v68 offset:16384
  v_mfma_f32_16x16x32_bf16 v[140:143], a[24:27], a[236:239], v[140:143]
  ds_read_b64_tr_b16 a[132:133], v67 offset:24576
  buffer_load_dwordx4 v71, s[12:15], s6 offen offset:0 lds
  v_mfma_f32_16x16x32_bf16 v[132:135], a[24:27], a[200:203], v[132:135]
  ds_read_b64_tr_b16 a[134:135], v69 offset:40960
  v_mfma_f32_16x16x32_bf16 v[76:79], a[100:103], a[200:203], v[76:79]
  ds_read_b64_tr_b16 a[20:21], v69 offset:0
  v_mfma_f32_16x16x32_bf16 v[80:83], a[100:103], a[236:239], v[80:83]
  ds_read_b64_tr_b16 a[22:23], v70 offset:16384
  buffer_load_dwordx4 v2, s[12:15], s6 offen offset:1024 lds
  v_mfma_f32_16x16x32_bf16 v[84:87], a[100:103], a[240:243], v[84:87]
  s_add_u32 m0, s0, 0x3000
  s_add_u32 s6, s75, 0
  v_mfma_f32_16x16x32_bf16 v[96:99], a[100:103], a[228:231], v[96:99]
  buffer_load_dwordx4 a[136:139], v62, s[36:39], s44 offen offset:1024 sc1
  v_mfma_f32_16x16x32_bf16 v[160:163], a[44:47], a[228:231], v[160:163]
  v_mfma_f32_16x16x32_bf16 v[156:159], a[44:47], a[240:243], v[156:159]
  buffer_load_dwordx4 v4, s[12:15], s6 offen offset:0 lds
  v_mfma_f32_16x16x32_bf16 v[148:151], a[44:47], a[236:239], v[148:151]
  v_mfma_f32_16x16x32_bf16 v[136:139], a[44:47], a[200:203], v[136:139]
  s_waitcnt lgkmcnt(0)
  buffer_load_dwordx4 a[24:27], v62, s[36:39], s44 offen offset:2048 sc1
  v_mfma_f32_16x16x32_bf16 v[104:107], a[76:79], v[24:27], v[104:107]
  v_mfma_f32_16x16x32_bf16 v[112:115], a[76:79], v[8:11], v[112:115]
  buffer_load_dwordx4 v6, s[12:15], s6 offen offset:1024 lds
  v_mfma_f32_16x16x32_bf16 v[116:119], a[76:79], v[16:19], v[116:119]
  ds_read_b64_tr_b16 a[100:101], v52 offset:26624
  v_mfma_f32_16x16x32_bf16 v[128:131], a[76:79], v[28:31], v[128:131]
  ds_read_b64_tr_b16 a[102:103], v51 offset:43008
  buffer_load_dwordx4 a[140:143], v62, s[36:39], s44 offen offset:3072 sc1
  v_mfma_f32_16x16x32_bf16 v[152:155], a[56:59], v[28:31], v[152:155]
  s_add_u32 s10, s34, 0x4000
  ds_read_b64_tr_b16 a[44:45], v51 offset:2048
  v_mfma_f32_16x16x32_bf16 v[144:147], a[56:59], v[16:19], v[144:147]
  ds_read_b64_tr_b16 a[46:47], v68 offset:18432
  buffer_load_dwordx4 v3, s[12:15], s6 offen offset:2048 lds
  v_mfma_f32_16x16x32_bf16 v[140:143], a[56:59], v[8:11], v[140:143]
  s_add_u32 m0, s4, 0x2000
  s_add_u32 s6, s60, 0
  ds_read_b64_tr_b16 a[76:77], v52 offset:4096
  v_mfma_f32_16x16x32_bf16 v[132:135], a[56:59], v[24:27], v[132:135]
  ds_read_b64_tr_b16 a[78:79], v51 offset:20480
  v_mfma_f32_16x16x32_bf16 v[76:79], a[132:135], v[24:27], v[76:79]
  ds_read_b64_tr_b16 a[144:145], v52 offset:45056
  v_mfma_f32_16x16x32_bf16 v[80:83], a[132:135], v[8:11], v[80:83]
  ds_read_b64_tr_b16 a[146:147], v51 offset:61440
  v_mfma_f32_16x16x32_bf16 v[84:87], a[132:135], v[16:19], v[84:87]
  v_mfma_f32_16x16x32_bf16 v[96:99], a[132:135], v[28:31], v[96:99]
  v_mfma_f32_16x16x32_bf16 v[160:163], a[20:23], v[28:31], v[160:163]
  v_mfma_f32_16x16x32_bf16 v[156:159], a[20:23], v[16:19], v[156:159]
  v_mfma_f32_16x16x32_bf16 v[148:151], a[20:23], v[8:11], v[148:151]
  v_mfma_f32_16x16x32_bf16 v[136:139], a[20:23], v[24:27], v[136:139]
  s_waitcnt lgkmcnt(0)
  v_mfma_f32_16x16x32_bf16 v[104:107], a[100:103], v[20:23], v[104:107]
  v_mfma_f32_16x16x32_bf16 v[112:115], a[100:103], v[32:35], v[112:115]
  v_mfma_f32_16x16x32_bf16 v[116:119], a[100:103], v[12:15], v[116:119]
  ds_read_b64_tr_b16 a[56:57], v52 offset:6144
  v_mfma_f32_16x16x32_bf16 v[128:131], a[100:103], v[36:39], v[128:131]
  ds_read_b64_tr_b16 a[58:59], v51 offset:22528
  v_mfma_f32_16x16x32_bf16 v[152:155], a[44:47], v[36:39], v[152:155]
  ds_read_b64_tr_b16 a[132:133], v52 offset:47104
  v_mfma_f32_16x16x32_bf16 v[144:147], a[44:47], v[12:15], v[144:147]
  ds_read_b64_tr_b16 a[134:135], v51 offset:63488
  v_mfma_f32_16x16x32_bf16 v[140:143], a[44:47], v[32:35], v[140:143]
  ds_read_b64_tr_b16 a[20:21], v67 offset:26624
  v_mfma_f32_16x16x32_bf16 v[132:135], a[44:47], v[20:23], v[132:135]
  ds_read_b64_tr_b16 a[22:23], v69 offset:43008
  v_mfma_f32_16x16x32_bf16 v[104:107], a[76:79], v[40:43], v[104:107]
  ds_read_b64_tr_b16 a[148:149], v69 offset:2048
  v_mfma_f32_16x16x32_bf16 v[112:115], a[76:79], v[44:47], v[112:115]
  ds_read_b64_tr_b16 a[150:151], v70 offset:18432
  v_mfma_f32_16x16x32_bf16 v[116:119], a[76:79], v[88:91], v[116:119]
  buffer_load_dwordx4 v71, s[12:15], s6 offen offset:0 lds
  v_mfma_f32_16x16x32_bf16 v[128:131], a[76:79], v[92:95], v[128:131]
  v_mfma_f32_16x16x32_bf16 v[152:155], a[144:147], v[92:95], v[152:155]
  v_mfma_f32_16x16x32_bf16 v[144:147], a[144:147], v[88:91], v[144:147]
  buffer_load_dwordx4 v2, s[12:15], s6 offen offset:1024 lds
  s_add_u32 m0, s5, 0x2000
  v_mfma_f32_16x16x32_bf16 v[140:143], a[144:147], v[44:47], v[140:143]
  s_add_u32 s6, s60, 0x9000
  v_mfma_f32_16x16x32_bf16 v[132:135], a[144:147], v[40:43], v[132:135]
  s_waitcnt lgkmcnt(0)
  v_mfma_f32_16x16x32_bf16 v[104:107], a[56:59], v[100:103], v[104:107]
  buffer_load_dwordx4 v71, s[12:15], s6 offen offset:0 lds
  v_mfma_f32_16x16x32_bf16 v[112:115], a[56:59], v[108:111], v[112:115]
  v_mfma_f32_16x16x32_bf16 v[116:119], a[56:59], v[120:123], v[116:119]
  ds_read_b64_tr_b16 a[44:45], v67 offset:4096
  v_mfma_f32_16x16x32_bf16 v[128:131], a[56:59], v[124:127], v[128:131]
  ds_read_b64_tr_b16 a[46:47], v69 offset:20480
  buffer_load_dwordx4 v2, s[12:15], s6 offen offset:1024 lds
  v_mfma_f32_16x16x32_bf16 v[132:135], a[132:135], v[100:103], v[132:135]
  s_add_u32 m0, s4, 0x4000
  s_add_u32 s60, s7, 0
  ds_read_b64_tr_b16 a[76:77], v67 offset:45056
  v_mfma_f32_16x16x32_bf16 v[140:143], a[132:135], v[108:111], v[140:143]
  ds_read_b64_tr_b16 a[78:79], v69 offset:61440
  v_mfma_f32_16x16x32_bf16 v[144:147], a[132:135], v[120:123], v[144:147]
  ds_read_b64_tr_b16 a[100:101], v67 offset:6144
  buffer_load_dwordx4 v71, s[12:15], s60 offen offset:0 lds
  v_mfma_f32_16x16x32_bf16 v[152:155], a[132:135], v[124:127], v[152:155]
  ds_read_b64_tr_b16 a[102:103], v69 offset:22528
  v_mul_f32 v104, v104, v132
  v_mfma_f32_16x16x32_bf16 v[76:79], a[20:23], v[20:23], v[76:79]
  ds_read_b64_tr_b16 a[56:57], v67 offset:47104
  v_mul_f32 v105, v105, v133
  v_mfma_f32_16x16x32_bf16 v[80:83], a[20:23], v[32:35], v[80:83]
  ds_read_b64_tr_b16 a[58:59], v69 offset:63488
  buffer_load_dwordx4 v2, s[12:15], s60 offen offset:1024 lds
  v_mfma_f32_16x16x32_bf16 v[84:87], a[20:23], v[12:15], v[84:87]
  s_add_u32 m0, s5, 0x4000
  s_add_u32 s60, s7, 0x9000
  v_mul_f32 v106, v106, v134
  v_mfma_f32_16x16x32_bf16 v[96:99], a[20:23], v[36:39], v[96:99]
  v_mul_f32 v107, v107, v135
  v_cvt_pk_bf16_f32 v8, v104, v105
  v_mfma_f32_16x16x32_bf16 v[160:163], a[148:151], v[36:39], v[160:163]
  buffer_load_dwordx4 v71, s[12:15], s60 offen offset:0 lds
  v_cvt_pk_bf16_f32 v9, v106, v107
  v_mfma_f32_16x16x32_bf16 v[156:159], a[148:151], v[12:15], v[156:159]
  v_mul_f32 v112, v112, v140
  v_mul_f32 v113, v113, v141
  v_mfma_f32_16x16x32_bf16 v[148:151], a[148:151], v[32:35], v[148:151]
  v_mul_f32 v114, v114, v142
  v_mul_f32 v115, v115, v143
  v_mfma_f32_16x16x32_bf16 v[136:139], a[148:151], v[20:23], v[136:139]
  s_waitcnt lgkmcnt(0)
  buffer_load_dwordx4 v2, s[12:15], s60 offen offset:1024 lds
  s_add_u32 m0, s0, 0x3c00
  v_mfma_f32_16x16x32_bf16 v[76:79], a[44:47], v[40:43], v[76:79]
  s_add_u32 s8, s8, 0
  v_cvt_pk_bf16_f32 v12, v112, v113
  v_cvt_pk_bf16_f32 v13, v114, v115
  v_mfma_f32_16x16x32_bf16 v[80:83], a[44:47], v[44:47], v[80:83]
  v_mul_f32 v116, v116, v144
  v_mul_f32 v117, v117, v145
  v_mfma_f32_16x16x32_bf16 v[84:87], a[44:47], v[88:91], v[84:87]
  buffer_load_dwordx4 v71, s[12:15], s8 offen offset:0 lds
  s_add_u32 m0, s0, 0x8000
  v_mfma_f32_16x16x32_bf16 v[96:99], a[44:47], v[92:95], v[96:99]
  s_add_u32 s60, s9, 0
  v_mul_f32 v118, v118, v146
  v_mul_f32 v119, v119, v147
  v_mfma_f32_16x16x32_bf16 v[160:163], a[76:79], v[92:95], v[160:163]
  v_cvt_pk_bf16_f32 v16, v116, v117
  v_cvt_pk_bf16_f32 v17, v118, v119
  v_mfma_f32_16x16x32_bf16 v[156:159], a[76:79], v[88:91], v[156:159]
  s_add_u32 s66, s47, 0xfffff000
  s_add_u32 s75, s47, 0x47000
  buffer_load_dwordx4 v71, s[12:15], s60 offen offset:0 lds
  v_mfma_f32_16x16x32_bf16 v[148:151], a[76:79], v[44:47], v[148:151]
  s_waitcnt vmcnt(10)
  s_barrier
  v_mfma_f32_16x16x32_bf16 v[136:139], a[76:79], v[40:43], v[136:139]
  s_add_u32 m0, s0, 0x1000
  s_add_u32 s35, s35, 0
  ds_read_b128 a[20:23], v60 offset:28672
  v_mfma_f32_16x16x32_bf16 v[76:79], a[100:103], v[100:103], v[76:79]
  ds_read_b128 a[44:47], v53 offset:28672
  buffer_load_dwordx4 v49, s[28:31], s35 offen offset:0 lds
  v_mfma_f32_16x16x32_bf16 v[80:83], a[100:103], v[108:111], v[80:83]
  ds_read_b128 a[132:135], v54 offset:28672
  v_mul_f32 v128, v128, v152
  v_mfma_f32_16x16x32_bf16 v[84:87], a[100:103], v[120:123], v[84:87]
  v_mul_f32 v129, v129, v153
  v_mul_f32 v130, v130, v154
  v_mfma_f32_16x16x32_bf16 v[96:99], a[100:103], v[124:127], v[96:99]
  v_mul_f32 v131, v131, v155
  v_cvt_pk_bf16_f32 v20, v128, v129
  v_mfma_f32_16x16x32_bf16 v[136:139], a[56:59], v[100:103], v[136:139]
  buffer_load_dwordx4 v50, s[28:31], s35 offen offset:1024 lds
  s_add_u32 m0, s0, 0x1800
  v_mfma_f32_16x16x32_bf16 v[148:151], a[56:59], v[108:111], v[148:151]
  s_add_u32 s60, s32, 0
  ds_read_b128 a[76:79], v55 offset:28672
  v_cvt_pk_bf16_f32 v21, v130, v131
  v_mfma_f32_16x16x32_bf16 v[156:159], a[56:59], v[120:123], v[156:159]
  ds_read_b128 a[144:147], v60 offset:0
  v_mfma_f32_16x16x32_bf16 v[160:163], a[56:59], v[124:127], v[160:163]
  s_waitcnt lgkmcnt(2)
  ds_read_b128 a[100:103], v53 offset:0
  v_mul_f32 v76, v76, v136
  v_mfma_f32_16x16x32_bf16 v[24:27], a[16:19], a[20:23], 0
  buffer_load_dwordx4 v49, s[28:31], s60 offen offset:0 lds
  v_mul_f32 v77, v77, v137
  v_mfma_f32_16x16x32_bf16 v[28:31], a[48:51], a[20:23], 0
  v_mul_f32 v78, v78, v138
  v_mul_f32 v79, v79, v139
  v_mfma_f32_16x16x32_bf16 v[24:27], a[36:39], a[44:47], v[24:27]
  v_cvt_pk_bf16_f32 v10, v76, v77
  v_cvt_pk_bf16_f32 v11, v78, v79
  v_mfma_f32_16x16x32_bf16 v[28:31], a[32:35], a[44:47], v[28:31]
  ds_read_b128 a[56:59], v54 offset:0
  v_mul_f32 v80, v80, v148
  v_mfma_f32_16x16x32_bf16 v[24:27], a[60:63], a[132:135], v[24:27]
  ds_read_b128 a[148:151], v55 offset:0
  buffer_store_dwordx4 v[8:11], v62, s[36:39], s66 offen offset:0 sc1
  v_mfma_f32_16x16x32_bf16 v[28:31], a[84:87], a[132:135], v[28:31]
  s_waitcnt lgkmcnt(2)
  ds_read_b128 a[20:23], v61 offset:12288
  v_mul_f32 v81, v81, v149
  v_mfma_f32_16x16x32_bf16 v[24:27], a[88:91], a[76:79], v[24:27]
  v_mul_f32 v82, v82, v150
  v_mul_f32 v83, v83, v151
  v_mfma_f32_16x16x32_bf16 v[28:31], a[92:95], a[76:79], v[28:31]
  v_cvt_pk_bf16_f32 v14, v80, v81
  v_cvt_pk_bf16_f32 v15, v82, v83
  v_mfma_f32_16x16x32_bf16 v[24:27], a[96:99], a[144:147], v[24:27]
  v_mul_f32 v84, v84, v156
  v_mul_f32 v85, v85, v157
  v_mfma_f32_16x16x32_bf16 v[28:31], a[104:107], a[144:147], v[28:31]
  ds_read_b128 a[44:47], v60 offset:29696
  v_mul_f32 v86, v86, v158
  v_mfma_f32_16x16x32_bf16 v[24:27], a[108:111], a[100:103], v[24:27]
  ds_read_b128 a[132:135], v53 offset:29696
  buffer_load_dwordx4 v50, s[28:31], s60 offen offset:1024 lds
  v_mfma_f32_16x16x32_bf16 v[28:31], a[112:115], a[100:103], v[28:31]
  s_waitcnt lgkmcnt(2)
  s_add_u32 m0, s0, 0x5000
  ds_read_b128 a[76:79], v54 offset:29696
  v_mfma_f32_16x16x32_bf16 v[24:27], a[52:55], a[56:59], v[24:27]
  s_add_u32 s60, s56, 0
  buffer_store_dwordx4 v[12:15], v62, s[36:39], s66 offen offset:1024 sc1
  v_mfma_f32_16x16x32_bf16 v[28:31], a[116:119], a[56:59], v[28:31]
  v_mul_f32 v87, v87, v159
  v_cvt_pk_bf16_f32 v18, v84, v85
  v_mfma_f32_16x16x32_bf16 v[24:27], a[120:123], a[148:151], v[24:27]
  v_cvt_pk_bf16_f32 v19, v86, v87
  v_mul_f32 v96, v96, v160
  v_mfma_f32_16x16x32_bf16 v[28:31], a[124:127], a[148:151], v[28:31]
  ds_read_b128 a[100:103], v55 offset:29696
  v_mul_f32 v97, v97, v161
  v_mfma_f32_16x16x32_bf16 v[24:27], a[68:71], a[20:23], v[24:27]
  ds_read_b128 a[144:147], v60 offset:1024
  v_mul_f32 v98, v98, v162
  v_mfma_f32_16x16x32_bf16 v[28:31], a[80:83], a[20:23], v[28:31]
  s_waitcnt lgkmcnt(2)
  ds_read_b128 a[56:59], v53 offset:1024
  v_mul_f32 v99, v99, v163
  v_mfma_f32_16x16x32_bf16 v[8:11], a[16:19], a[44:47], 0
  v_cvt_pk_bf16_f32 v22, v96, v97
  v_cvt_pk_bf16_f32 v23, v98, v99
  v_mfma_f32_16x16x32_bf16 v[12:15], a[48:51], a[44:47], 0
  v_subrev_u32 v52, s67, v52
  v_subrev_u32 v51, s67, v51
  v_mfma_f32_16x16x32_bf16 v[8:11], a[36:39], a[132:135], v[8:11]
  buffer_load_dwordx4 v49, s[28:31], s60 offen offset:0 lds
  v_cvt_pk_bf16_f32 v32, v24, v25
  v_mfma_f32_16x16x32_bf16 v[12:15], a[32:35], a[132:135], v[12:15]
  ds_read_b128 a[20:23], v54 offset:1024
  v_cvt_pk_bf16_f32 v33, v26, v27
  v_mfma_f32_16x16x32_bf16 v[8:11], a[60:63], a[76:79], v[8:11]
  ds_read_b128 a[148:151], v55 offset:1024
  v_cvt_pk_bf16_f32 v34, v28, v29
  v_mfma_f32_16x16x32_bf16 v[12:15], a[84:87], a[76:79], v[12:15]
  s_waitcnt lgkmcnt(2)
  ds_read_b128 a[44:47], v61 offset:12544
  buffer_load_dwordx4 v50, s[28:31], s60 offen offset:1024 lds
  v_mfma_f32_16x16x32_bf16 v[8:11], a[88:91], a[100:103], v[8:11]
  v_cvt_pk_bf16_f32 v35, v30, v31
  v_subrev_u32 v2, s67, v68
  v_mfma_f32_16x16x32_bf16 v[12:15], a[92:95], a[100:103], v[12:15]
  buffer_store_dwordx4 v[16:19], v62, s[36:39], s75 offen offset:0 sc1
  v_mfma_f32_16x16x32_bf16 v[8:11], a[96:99], a[144:147], v[8:11]
  v_subrev_u32 v3, s67, v67
  v_subrev_u32 v4, s67, v69
  v_mfma_f32_16x16x32_bf16 v[12:15], a[104:107], a[144:147], v[12:15]
  ds_read_b128 a[76:79], v60 offset:30720
  buffer_load_dwordx4 v58, s[28:31], s60 offen offset:2048 lds
  v_mfma_f32_16x16x32_bf16 v[8:11], a[108:111], a[56:59], v[8:11]
  ds_read_b128 a[132:135], v53 offset:30720
  v_subrev_u32 v6, s67, v70
  v_mfma_f32_16x16x32_bf16 v[12:15], a[112:115], a[56:59], v[12:15]
  s_waitcnt lgkmcnt(2)
  ds_read_b128 a[100:103], v54 offset:30720
  v_add_u32 v56, 0x11800, v49
  v_mfma_f32_16x16x32_bf16 v[8:11], a[52:55], a[20:23], v[8:11]
  buffer_load_dwordx4 v[24:27], v62, s[36:39], s10 offen offset:0 sc1
  v_add_u32 v57, 0x13800, v49
  v_mfma_f32_16x16x32_bf16 v[12:15], a[116:119], a[20:23], v[12:15]
  v_mfma_f32_16x16x32_bf16 v[8:11], a[120:123], a[148:151], v[8:11]
  buffer_load_dwordx4 v59, s[28:31], s60 offen offset:3072 lds
  s_add_u32 m0, s0, 0x6000
  v_mfma_f32_16x16x32_bf16 v[12:15], a[124:127], a[148:151], v[12:15]
  s_add_u32 s60, s78, 0
  ds_read_b128 a[56:59], v55 offset:30720
  v_mfma_f32_16x16x32_bf16 v[8:11], a[68:71], a[44:47], v[8:11]
  ds_read_b128 a[144:147], v60 offset:2048
  buffer_load_dwordx4 v[28:31], v62, s[36:39], s10 offen offset:1024 sc1
  v_mfma_f32_16x16x32_bf16 v[12:15], a[80:83], a[44:47], v[12:15]
  s_waitcnt lgkmcnt(2)
  ds_read_b128 a[20:23], v53 offset:2048
  v_mfma_f32_16x16x32_bf16 v[16:19], a[16:19], a[76:79], 0
  buffer_load_dwordx4 v49, s[28:31], s60 offen offset:0 lds
  v_mfma_f32_16x16x32_bf16 v[36:39], a[48:51], a[76:79], 0
  v_mfma_f32_16x16x32_bf16 v[16:19], a[36:39], a[132:135], v[16:19]
  buffer_store_dwordx4 v[20:23], v62, s[36:39], s75 offen offset:1024 sc1
  v_mfma_f32_16x16x32_bf16 v[36:39], a[32:35], a[132:135], v[36:39]
  ds_read_b128 a[148:151], v54 offset:2048
  v_cvt_pk_bf16_f32 v40, v8, v9
  v_mfma_f32_16x16x32_bf16 v[16:19], a[60:63], a[100:103], v[16:19]
  ds_read_b128 a[44:47], v55 offset:2048
  buffer_load_dwordx4 v50, s[28:31], s60 offen offset:1024 lds
  v_mfma_f32_16x16x32_bf16 v[36:39], a[84:87], a[100:103], v[36:39]
  s_waitcnt lgkmcnt(2)
  ds_read_b128 a[152:155], v61 offset:12800
  v_cvt_pk_bf16_f32 v41, v10, v11
  v_mfma_f32_16x16x32_bf16 v[16:19], a[88:91], a[56:59], v[16:19]
  v_cvt_pk_bf16_f32 v42, v12, v13
  v_cvt_pk_bf16_f32 v43, v14, v15
  v_mfma_f32_16x16x32_bf16 v[36:39], a[92:95], a[56:59], v[36:39]
  v_mfma_f32_16x16x32_bf16 v[16:19], a[96:99], a[144:147], v[16:19]
  v_mfma_f32_16x16x32_bf16 v[36:39], a[104:107], a[144:147], v[36:39]
  ds_read_b128 a[76:79], v60 offset:31744
  v_mfma_f32_16x16x32_bf16 v[16:19], a[108:111], a[20:23], v[16:19]
  ds_read_b128 a[100:103], v53 offset:31744
  v_mfma_f32_16x16x32_bf16 v[36:39], a[112:115], a[20:23], v[36:39]
  s_waitcnt lgkmcnt(2)
  ds_read_b128 a[132:135], v54 offset:31744
  v_mfma_f32_16x16x32_bf16 v[16:19], a[52:55], a[148:151], v[16:19]
  v_mfma_f32_16x16x32_bf16 v[36:39], a[116:119], a[148:151], v[36:39]
  v_mfma_f32_16x16x32_bf16 v[16:19], a[120:123], a[44:47], v[16:19]
  v_mfma_f32_16x16x32_bf16 v[36:39], a[124:127], a[44:47], v[36:39]
  ds_read_b128 a[56:59], v55 offset:31744
  v_mfma_f32_16x16x32_bf16 v[16:19], a[68:71], a[152:155], v[16:19]
  ds_read_b128 a[144:147], v60 offset:3072
  v_mfma_f32_16x16x32_bf16 v[36:39], a[80:83], a[152:155], v[36:39]
  s_waitcnt lgkmcnt(2)
  ds_read_b128 a[20:23], v53 offset:3072
  v_mfma_f32_16x16x32_bf16 v[8:11], a[16:19], a[76:79], 0
  v_mfma_f32_16x16x32_bf16 v[12:15], a[48:51], a[76:79], 0
  v_mfma_f32_16x16x32_bf16 v[8:11], a[36:39], a[100:103], v[8:11]
  ds_read_b128 a[148:151], v54 offset:3072
  v_cvt_pk_bf16_f32 v20, v16, v17
  v_mfma_f32_16x16x32_bf16 v[12:15], a[32:35], a[100:103], v[12:15]
  ds_read_b128 a[44:47], v55 offset:3072
  v_cvt_pk_bf16_f32 v21, v18, v19
  v_mfma_f32_16x16x32_bf16 v[8:11], a[60:63], a[132:135], v[8:11]
  v_cvt_pk_bf16_f32 v22, v36, v37
  v_cvt_pk_bf16_f32 v23, v38, v39
  v_mfma_f32_16x16x32_bf16 v[12:15], a[84:87], a[132:135], v[12:15]
  s_waitcnt lgkmcnt(2)
  ds_read_b128 a[76:79], v61 offset:13056
  v_mfma_f32_16x16x32_bf16 v[8:11], a[88:91], a[56:59], v[8:11]
  v_mfma_f32_16x16x32_bf16 v[12:15], a[92:95], a[56:59], v[12:15]
  v_mfma_f32_16x16x32_bf16 v[8:11], a[96:99], a[144:147], v[8:11]
  s_waitcnt vmcnt(16) lgkmcnt(0)
  s_barrier
  v_mfma_f32_16x16x32_bf16 v[12:15], a[104:107], a[144:147], v[12:15]
  s_add_u32 m0, s0, 0
  s_add_u32 s60, s56, 0x12000
  ds_read_b128 a[100:103], v60 offset:8192
  v_mfma_f32_16x16x32_bf16 v[8:11], a[108:111], a[20:23], v[8:11]
  ds_read_b128 a[132:135], v53 offset:8192
  v_mfma_f32_16x16x32_bf16 v[12:15], a[112:115], a[20:23], v[12:15]
  ds_read_b128 a[56:59], v54 offset:8192
  v_mfma_f32_16x16x32_bf16 v[8:11], a[52:55], a[148:151], v[8:11]
  v_mfma_f32_16x16x32_bf16 v[12:15], a[116:119], a[148:151], v[12:15]
  v_mfma_f32_16x16x32_bf16 v[8:11], a[120:123], a[44:47], v[8:11]
  v_mfma_f32_16x16x32_bf16 v[12:15], a[124:127], a[44:47], v[12:15]
  ds_read_b128 a[144:147], v55 offset:8192
  buffer_load_dwordx4 v49, s[28:31], s60 offen offset:0 lds
  v_mfma_f32_16x16x32_bf16 v[8:11], a[68:71], a[76:79], v[8:11]
  s_waitcnt vmcnt(4)
  ds_read_b128 a[152:155], v60 offset:16384
  v_swap_b32 v26, v28
  v_mfma_f32_16x16x32_bf16 v[12:15], a[80:83], a[76:79], v[12:15]
  s_waitcnt lgkmcnt(2)
  ds_read_b128 a[20:23], v53 offset:16384
  v_swap_b32 v27, v29
  v_mfma_f32_16x16x32_bf16 v[16:19], a[16:19], a[100:103], 0
  buffer_store_dwordx4 v[32:35], v62, s[36:39], s64 offen offset:0 sc1
  v_mfma_f32_16x16x32_bf16 v[36:39], a[48:51], a[100:103], 0
  v_mfma_f32_16x16x32_bf16 v[16:19], a[36:39], a[132:135], v[16:19]
  buffer_load_dwordx4 v50, s[28:31], s60 offen offset:1024 lds
  v_cvt_pk_bf16_f32 v44, v8, v9
  v_mfma_f32_16x16x32_bf16 v[36:39], a[32:35], a[132:135], v[36:39]
  ds_read_b128 a[44:47], v54 offset:16384
  v_cvt_pk_bf16_f32 v45, v10, v11
  v_mfma_f32_16x16x32_bf16 v[16:19], a[60:63], a[56:59], v[16:19]
  ds_read_b128 a[76:79], v55 offset:16384
  v_cvt_pk_bf16_f32 v46, v12, v13
  v_mfma_f32_16x16x32_bf16 v[36:39], a[84:87], a[56:59], v[36:39]
  s_waitcnt lgkmcnt(2)
  ds_read_b128 a[100:103], v61 offset:13312
  buffer_store_dwordx4 v[40:43], v62, s[36:39], s64 offen offset:1024 sc1
  v_mfma_f32_16x16x32_bf16 v[16:19], a[88:91], a[144:147], v[16:19]
  v_cvt_pk_bf16_f32 v47, v14, v15
  v_mfma_f32_16x16x32_bf16 v[36:39], a[92:95], a[144:147], v[36:39]
  buffer_load_dwordx4 v58, s[28:31], s60 offen offset:2048 lds
  v_mfma_f32_16x16x32_bf16 v[16:19], a[96:99], a[152:155], v[16:19]
  v_mfma_f32_16x16x32_bf16 v[36:39], a[104:107], a[152:155], v[36:39]
  ds_read_b128 a[132:135], v60 offset:9216
  buffer_load_dwordx4 v[64:67], v62, s[36:39], s74 offen offset:0 sc1
  v_mfma_f32_16x16x32_bf16 v[16:19], a[108:111], a[20:23], v[16:19]
  ds_read_b128 a[56:59], v53 offset:9216
  v_mfma_f32_16x16x32_bf16 v[36:39], a[112:115], a[20:23], v[36:39]
  s_waitcnt lgkmcnt(2)
  ds_read_b128 a[148:151], v54 offset:9216
  v_mfma_f32_16x16x32_bf16 v[16:19], a[52:55], a[44:47], v[16:19]
  ds_read_b128 a[144:147], v55 offset:9216
  buffer_store_dwordx4 v[20:23], v62, s[36:39], s65 offen offset:0 sc1
  v_mfma_f32_16x16x32_bf16 v[36:39], a[116:119], a[44:47], v[36:39]
  ds_read_b128 a[152:155], v60 offset:17408
  v_mfma_f32_16x16x32_bf16 v[16:19], a[120:123], a[76:79], v[16:19]
  ds_read_b128 a[156:159], v53 offset:17408
  buffer_load_dwordx4 v59, s[28:31], s60 offen offset:3072 lds
  v_mfma_f32_16x16x32_bf16 v[36:39], a[124:127], a[76:79], v[36:39]
  s_add_u32 m0, s0, 0x6800
  s_add_u32 s60, s78, 0x12000
  ds_read_b128 a[20:23], v54 offset:17408
  v_mfma_f32_16x16x32_bf16 v[16:19], a[68:71], a[100:103], v[16:19]
  ds_read_b128 a[160:163], v55 offset:17408
  v_mfma_f32_16x16x32_bf16 v[36:39], a[80:83], a[100:103], v[36:39]
  s_waitcnt lgkmcnt(5)
  ds_read_b128 a[44:47], v61 offset:13568
  buffer_store_dwordx4 v[44:47], v62, s[36:39], s65 offen offset:1024 sc1
  v_mfma_f32_16x16x32_bf16 v[8:11], a[16:19], a[132:135], 0
  ds_read_b128 a[164:167], v60 offset:10240
  v_mfma_f32_16x16x32_bf16 v[12:15], a[48:51], a[132:135], 0
  ds_read_b128 a[76:79], v53 offset:10240
  v_mfma_f32_16x16x32_bf16 v[8:11], a[36:39], a[56:59], v[8:11]
  ds_read_b128 a[168:171], v54 offset:10240
  v_cvt_pk_bf16_f32 v20, v16, v17
  v_mfma_f32_16x16x32_bf16 v[12:15], a[32:35], a[56:59], v[12:15]
  ds_read_b128 a[100:103], v55 offset:10240
  v_cvt_pk_bf16_f32 v21, v18, v19
  v_mfma_f32_16x16x32_bf16 v[8:11], a[60:63], a[148:151], v[8:11]
  ds_read_b128 a[172:175], v60 offset:18432
  v_cvt_pk_bf16_f32 v22, v36, v37
  v_mfma_f32_16x16x32_bf16 v[12:15], a[84:87], a[148:151], v[12:15]
  s_waitcnt lgkmcnt(8)
  ds_read_b128 a[132:135], v53 offset:18432
  v_cvt_pk_bf16_f32 v23, v38, v39
  v_mfma_f32_16x16x32_bf16 v[8:11], a[88:91], a[144:147], v[8:11]
  ds_read_b128 a[176:179], v54 offset:18432
  v_mfma_f32_16x16x32_bf16 v[12:15], a[92:95], a[144:147], v[12:15]
  ds_read_b128 a[56:59], v55 offset:18432
  v_mfma_f32_16x16x32_bf16 v[8:11], a[96:99], a[152:155], v[8:11]
  ds_read_b128 a[180:183], v61 offset:13824
  buffer_load_dwordx4 v49, s[28:31], s60 offen offset:0 lds
  v_mfma_f32_16x16x32_bf16 v[12:15], a[104:107], a[152:155], v[12:15]
  ds_read_b128 a[148:151], v60 offset:11264
  v_mfma_f32_16x16x32_bf16 v[8:11], a[108:111], a[156:159], v[8:11]
  ds_read_b128 a[184:187], v53 offset:11264
  v_mfma_f32_16x16x32_bf16 v[12:15], a[112:115], a[156:159], v[12:15]
  s_waitcnt lgkmcnt(11)
  ds_read_b128 a[144:147], v54 offset:11264
  buffer_store_dwordx4 v[20:23], v62, s[36:39], s61 offen offset:0 sc1
  v_mfma_f32_16x16x32_bf16 v[8:11], a[52:55], a[20:23], v[8:11]
  ds_read_b128 a[188:191], v55 offset:11264
  v_mfma_f32_16x16x32_bf16 v[12:15], a[116:119], a[20:23], v[12:15]
  ds_read_b128 a[152:155], v60 offset:19456
  buffer_load_dwordx4 v50, s[28:31], s60 offen offset:1024 lds
  v_mfma_f32_16x16x32_bf16 v[8:11], a[120:123], a[160:163], v[8:11]
  s_add_u32 m0, s0, 0x7000
  s_add_u32 s60, s56, 0x24000
  ds_read_b128 a[156:159], v53 offset:19456
  v_mfma_f32_16x16x32_bf16 v[12:15], a[124:127], a[160:163], v[12:15]
  ds_read_b128 a[192:195], v54 offset:19456
  v_mfma_f32_16x16x32_bf16 v[8:11], a[68:71], a[44:47], v[8:11]
  ds_read_b128 a[196:199], v55 offset:19456
  buffer_load_dwordx4 v49, s[28:31], s60 offen offset:0 lds
  v_mfma_f32_16x16x32_bf16 v[12:15], a[80:83], a[44:47], v[12:15]
  s_waitcnt lgkmcnt(14)
  ds_read_b128 a[20:23], v61 offset:14080
  v_mfma_f32_16x16x32_bf16 v[16:19], a[16:19], a[164:167], 0
  ds_read_b128 a[200:203], v60 offset:15360
  v_mfma_f32_16x16x32_bf16 v[20:23], a[48:51], a[164:167], 0
  ds_read_b128 a[204:207], v53 offset:15360
  buffer_load_dwordx4 v50, s[28:31], s60 offen offset:1024 lds
  v_mfma_f32_16x16x32_bf16 v[16:19], a[36:39], a[76:79], v[16:19]
  ds_read_b128 a[160:163], v54 offset:15360
  v_cvt_pk_bf16_f32 v32, v8, v9
  v_mfma_f32_16x16x32_bf16 v[20:23], a[32:35], a[76:79], v[20:23]
  ds_read_b128 a[44:47], v55 offset:15360
  v_cvt_pk_bf16_f32 v33, v10, v11
  v_mfma_f32_16x16x32_bf16 v[16:19], a[60:63], a[168:171], v[16:19]
  ds_read_b128 a[208:211], v60 offset:32768
  buffer_load_dwordx4 v58, s[28:31], s60 offen offset:2048 lds
  v_mfma_f32_16x16x32_bf16 v[20:23], a[84:87], a[168:171], v[20:23]
  s_waitcnt lgkmcnt(15)
  ds_read_b128 a[164:167], v53 offset:32768
  v_cvt_pk_bf16_f32 v34, v12, v13
  v_mfma_f32_16x16x32_bf16 v[16:19], a[88:91], a[100:103], v[16:19]
  ds_read_b128 a[212:215], v54 offset:32768
  v_cvt_pk_bf16_f32 v35, v14, v15
  v_mfma_f32_16x16x32_bf16 v[20:23], a[92:95], a[100:103], v[20:23]
  ds_read_b128 a[76:79], v55 offset:32768
  v_mfma_f32_16x16x32_bf16 v[16:19], a[96:99], a[172:175], v[16:19]
  ds_read_b128 a[216:219], v61 offset:14336
  buffer_store_dwordx4 v[32:35], v62, s[36:39], s61 offen offset:1024 sc1
  v_mfma_f32_16x16x32_bf16 v[20:23], a[104:107], a[172:175], v[20:23]
  v_mfma_f32_16x16x32_bf16 v[16:19], a[108:111], a[132:135], v[16:19]
  buffer_load_dwordx4 v59, s[28:31], s60 offen offset:3072 lds
  v_mfma_f32_16x16x32_bf16 v[20:23], a[112:115], a[132:135], v[20:23]
  s_waitcnt lgkmcnt(15)
  v_mfma_f32_16x16x32_bf16 v[16:19], a[52:55], a[176:179], v[16:19]
  v_mfma_f32_16x16x32_bf16 v[20:23], a[116:119], a[176:179], v[20:23]
  s_waitcnt vmcnt(17) lgkmcnt(0)
  s_barrier
  v_mfma_f32_16x16x32_bf16 v[16:19], a[120:123], a[56:59], v[16:19]
  s_add_u32 m0, s0, 0x2000
  s_add_u32 s60, s78, 0x24000
  ds_read_b64_tr_b16 a[100:101], v52 offset:4096
  v_mfma_f32_16x16x32_bf16 v[20:23], a[124:127], a[56:59], v[20:23]
  ds_read_b64_tr_b16 a[102:103], v51 offset:20480
  v_mfma_f32_16x16x32_bf16 v[16:19], a[68:71], a[180:183], v[16:19]
  ds_read_b64_tr_b16 a[132:133], v3 offset:4096
  v_mfma_f32_16x16x32_bf16 v[20:23], a[80:83], a[180:183], v[20:23]
  ds_read_b64_tr_b16 a[134:135], v4 offset:20480
  v_mfma_f32_16x16x32_bf16 v[8:11], a[16:19], a[148:151], 0
  ds_read_b64_tr_b16 a[168:169], v52 offset:4608
  v_mfma_f32_16x16x32_bf16 v[12:15], a[48:51], a[148:151], 0
  ds_read_b64_tr_b16 a[170:171], v51 offset:20992
  v_mfma_f32_16x16x32_bf16 v[8:11], a[36:39], a[184:187], v[8:11]
  ds_read_b64_tr_b16 a[56:57], v3 offset:4608
  v_mfma_f32_16x16x32_bf16 v[12:15], a[32:35], a[184:187], v[12:15]
  ds_read_b64_tr_b16 a[58:59], v4 offset:20992
  v_mfma_f32_16x16x32_bf16 v[8:11], a[60:63], a[144:147], v[8:11]
  ds_read_b64_tr_b16 a[172:173], v52 offset:45056
  v_mfma_f32_16x16x32_bf16 v[12:15], a[84:87], a[144:147], v[12:15]
  ds_read_b64_tr_b16 a[174:175], v51 offset:61440
  v_mfma_f32_16x16x32_bf16 v[8:11], a[88:91], a[188:191], v[8:11]
  ds_read_b64_tr_b16 a[148:149], v3 offset:45056
  v_mfma_f32_16x16x32_bf16 v[12:15], a[92:95], a[188:191], v[12:15]
  ds_read_b64_tr_b16 a[150:151], v4 offset:61440
  v_mfma_f32_16x16x32_bf16 v[8:11], a[96:99], a[152:155], v[8:11]
  ds_read_b64_tr_b16 a[176:177], v52 offset:45568
  v_mfma_f32_16x16x32_bf16 v[12:15], a[104:107], a[152:155], v[12:15]
  ds_read_b64_tr_b16 a[178:179], v51 offset:61952
  v_mfma_f32_16x16x32_bf16 v[8:11], a[108:111], a[156:159], v[8:11]
  ds_read_b64_tr_b16 a[144:145], v3 offset:45568
  v_mfma_f32_16x16x32_bf16 v[12:15], a[112:115], a[156:159], v[12:15]
  ds_read_b64_tr_b16 a[146:147], v4 offset:61952
  v_mfma_f32_16x16x32_bf16 v[8:11], a[52:55], a[192:195], v[8:11]
  ds_read_b64_tr_b16 a[180:181], v52 offset:6144
  v_mfma_f32_16x16x32_bf16 v[12:15], a[116:119], a[192:195], v[12:15]
  ds_read_b64_tr_b16 a[182:183], v51 offset:22528
  v_mfma_f32_16x16x32_bf16 v[8:11], a[120:123], a[196:199], v[8:11]
  ds_read_b64_tr_b16 a[152:153], v3 offset:6144
  v_mfma_f32_16x16x32_bf16 v[12:15], a[124:127], a[196:199], v[12:15]
  ds_read_b64_tr_b16 a[154:155], v4 offset:22528
  buffer_load_dwordx4 v49, s[28:31], s60 offen offset:0 lds
  v_mfma_f32_16x16x32_bf16 v[8:11], a[68:71], a[20:23], v[8:11]
  ds_read_b64_tr_b16 a[156:157], v52 offset:6656
  v_mfma_f32_16x16x32_bf16 v[12:15], a[80:83], a[20:23], v[12:15]
  ds_read_b64_tr_b16 a[158:159], v51 offset:23040
  v_mfma_f32_16x16x32_bf16 v[32:35], a[16:19], a[200:203], 0
  ds_read_b64_tr_b16 a[184:185], v3 offset:6656
  v_mfma_f32_16x16x32_bf16 v[36:39], a[48:51], a[200:203], 0
  ds_read_b64_tr_b16 a[186:187], v4 offset:23040
  v_mfma_f32_16x16x32_bf16 v[32:35], a[36:39], a[204:207], v[32:35]
  ds_read_b64_tr_b16 a[188:189], v52 offset:20480
  v_mfma_f32_16x16x32_bf16 v[36:39], a[32:35], a[204:207], v[36:39]
  ds_read_b64_tr_b16 a[190:191], v51 offset:36864
  v_mfma_f32_16x16x32_bf16 v[32:35], a[60:63], a[160:163], v[32:35]
  ds_read_b64_tr_b16 a[20:21], v3 offset:20480
  buffer_load_dwordx4 v50, s[28:31], s60 offen offset:1024 lds
  v_mfma_f32_16x16x32_bf16 v[36:39], a[84:87], a[160:163], v[36:39]
  s_add_u32 m0, s0, 0x3000
  ds_read_b64_tr_b16 a[22:23], v4 offset:36864
  v_mfma_f32_16x16x32_bf16 v[32:35], a[88:91], a[44:47], v[32:35]
  s_add_u32 s56, s56, 0x36000
  ds_read_b64_tr_b16 a[16:17], v52 offset:20992
  v_mfma_f32_16x16x32_bf16 v[36:39], a[92:95], a[44:47], v[36:39]
  ds_read_b64_tr_b16 a[18:19], v51 offset:37376
  v_mfma_f32_16x16x32_bf16 v[32:35], a[96:99], a[208:211], v[32:35]
  ds_read_b64_tr_b16 a[32:33], v3 offset:20992
  buffer_load_dwordx4 v49, s[28:31], s56 offen offset:0 lds
  v_mfma_f32_16x16x32_bf16 v[36:39], a[104:107], a[208:211], v[36:39]
  ds_read_b64_tr_b16 a[34:35], v4 offset:37376
  v_mfma_f32_16x16x32_bf16 v[32:35], a[108:111], a[164:167], v[32:35]
  ds_read_b64_tr_b16 a[36:37], v52 offset:61440
  v_mfma_f32_16x16x32_bf16 v[36:39], a[112:115], a[164:167], v[36:39]
  ds_read_b64_tr_b16 a[38:39], v2 offset:12288
  v_mfma_f32_16x16x32_bf16 v[32:35], a[52:55], a[212:215], v[32:35]
  ds_read_b64_tr_b16 a[44:45], v3 offset:61440
  buffer_load_dwordx4 v50, s[28:31], s56 offen offset:1024 lds
  v_mfma_f32_16x16x32_bf16 v[36:39], a[116:119], a[212:215], v[36:39]
  ds_read_b64_tr_b16 a[46:47], v6 offset:12288
  v_mfma_f32_16x16x32_bf16 v[32:35], a[120:123], a[76:79], v[32:35]
  ds_read_b64_tr_b16 a[48:49], v52 offset:61952
  v_mfma_f32_16x16x32_bf16 v[36:39], a[124:127], a[76:79], v[36:39]
  ds_read_b64_tr_b16 a[50:51], v2 offset:12800
  v_mfma_f32_16x16x32_bf16 v[32:35], a[68:71], a[216:219], v[32:35]
  ds_read_b64_tr_b16 a[60:61], v3 offset:61952
  buffer_load_dwordx4 v58, s[28:31], s56 offen offset:2048 lds
  v_mfma_f32_16x16x32_bf16 v[36:39], a[80:83], a[216:219], v[36:39]
  s_waitcnt lgkmcnt(15)
  ds_read_b64_tr_b16 a[62:63], v6 offset:12800
  v_mfma_f32_16x16x32_bf16 v[40:43], v[24:27], a[100:103], 0
  ds_read_b64_tr_b16 a[52:53], v52 offset:24576
  v_mfma_f32_16x16x32_bf16 v[44:47], v[28:31], a[100:103], 0
  ds_read_b64_tr_b16 a[54:55], v51 offset:40960
  buffer_load_dwordx4 v59, s[28:31], s56 offen offset:3072 lds
  v_mfma_f32_16x16x32_bf16 v[72:75], v[28:31], a[132:135], 0
  s_add_u32 m0, s0, 0x2800
  s_add_u32 s56, s78, 0x36000
  ds_read_b64_tr_b16 a[68:69], v3 offset:24576
  v_mfma_f32_16x16x32_bf16 v[76:79], v[24:27], a[132:135], 0
  ds_read_b64_tr_b16 a[70:71], v4 offset:40960
  v_cvt_pk_bf16_f32 v80, v32, v33
  v_mfma_f32_16x16x32_bf16 v[84:87], v[24:27], a[168:171], 0
  ds_read_b64_tr_b16 a[76:77], v52 offset:25088
  buffer_load_dwordx4 v49, s[28:31], s56 offen offset:0 lds
  v_mfma_f32_16x16x32_bf16 v[88:91], v[28:31], a[168:171], 0
  ds_read_b64_tr_b16 a[78:79], v51 offset:41472
  v_cvt_pk_bf16_f32 v81, v34, v35
  v_mfma_f32_16x16x32_bf16 v[92:95], v[28:31], a[56:59], 0
  ds_read_b64_tr_b16 a[80:81], v3 offset:25088
  v_cvt_pk_bf16_f32 v82, v36, v37
  v_mfma_f32_16x16x32_bf16 v[96:99], v[24:27], a[56:59], 0
  ds_read_b64_tr_b16 a[82:83], v4 offset:41472
  buffer_load_dwordx4 v50, s[28:31], s56 offen offset:1024 lds
  v_mfma_f32_16x16x32_bf16 v[100:103], v[24:27], a[172:175], 0
  s_add_u32 m0, s0, 0x4000
  s_add_u32 s56, s73, 0
  ds_read_b64_tr_b16 a[84:85], v52 offset:22528
  v_mfma_f32_16x16x32_bf16 v[32:35], v[28:31], a[172:175], 0
  ds_read_b64_tr_b16 a[86:87], v51 offset:38912
  v_cvt_pk_bf16_f32 v83, v38, v39
  v_mfma_f32_16x16x32_bf16 v[104:107], v[28:31], a[148:151], 0
  ds_read_b64_tr_b16 a[56:57], v3 offset:22528
  v_mfma_f32_16x16x32_bf16 v[108:111], v[24:27], a[148:151], 0
  ds_read_b64_tr_b16 a[58:59], v4 offset:38912
  buffer_store_dwordx4 v[80:83], v62, s[36:39], s62 offen offset:0 sc1
  v_mfma_f32_16x16x32_bf16 v[112:115], v[24:27], a[176:179], 0
  s_mul_i32 s60, s40, 0x13c00
  s_sub_u32 s78, s62, s60
  ds_read_b64_tr_b16 a[88:89], v52 offset:23040
  v_mfma_f32_16x16x32_bf16 v[116:119], v[28:31], a[176:179], 0
  s_and_b32 s32, s63, 1
  s_lshl_b32 s32, s32, 1
  ds_read_b64_tr_b16 a[90:91], v51 offset:39424
  v_mfma_f32_16x16x32_bf16 v[36:39], v[28:31], a[144:147], 0
  s_xor_b32 s35, s32, 0
  s_mul_i32 s35, s35, 0x14000
  ds_read_b64_tr_b16 a[92:93], v3 offset:23040
  v_mfma_f32_16x16x32_bf16 v[80:83], v[24:27], a[144:147], 0
  s_add_u32 s35, s35, s78
  ds_read_b64_tr_b16 a[94:95], v4 offset:39424
  v_mfma_f32_16x16x32_bf16 v[120:123], v[24:27], a[180:183], 0
  ds_read_b64_tr_b16 a[96:97], v52 offset:63488
  v_mfma_f32_16x16x32_bf16 v[124:127], v[28:31], a[180:183], 0
  ds_read_b64_tr_b16 a[98:99], v2 offset:14336
  v_mfma_f32_16x16x32_bf16 v[128:131], v[28:31], a[152:155], 0
  ds_read_b64_tr_b16 a[100:101], v3 offset:63488
  v_mfma_f32_16x16x32_bf16 v[132:135], v[24:27], a[152:155], 0
  ds_read_b64_tr_b16 a[102:103], v6 offset:14336
  v_mfma_f32_16x16x32_bf16 v[136:139], v[24:27], a[156:159], 0
  ds_read_b64_tr_b16 a[104:105], v52 offset:64000
  v_mfma_f32_16x16x32_bf16 v[140:143], v[28:31], a[156:159], 0
  ds_read_b64_tr_b16 a[106:107], v2 offset:14848
  v_mfma_f32_16x16x32_bf16 v[144:147], v[28:31], a[184:187], 0
  ds_read_b64_tr_b16 a[108:109], v3 offset:64000
  v_mfma_f32_16x16x32_bf16 v[148:151], v[24:27], a[184:187], 0
  s_waitcnt lgkmcnt(15)
  ds_read_b64_tr_b16 a[110:111], v6 offset:14848
  v_mfma_f32_16x16x32_bf16 v[40:43], a[40:43], a[188:191], v[40:43]
  ds_read_b64_tr_b16 a[112:113], v51 offset:0
  v_mfma_f32_16x16x32_bf16 v[44:47], a[0:3], a[188:191], v[44:47]
  ds_read_b64_tr_b16 a[114:115], v2 offset:16384
  v_mfma_f32_16x16x32_bf16 v[72:75], a[0:3], a[20:23], v[72:75]
  ds_read_b64_tr_b16 a[116:117], v4 offset:0
  buffer_load_dwordx4 v[68:71], v62, s[36:39], s74 offen offset:1024 sc1
  v_mfma_f32_16x16x32_bf16 v[76:79], a[40:43], a[20:23], v[76:79]
  s_add_u32 s66, s70, 0x4000
  ds_read_b64_tr_b16 a[118:119], v6 offset:16384
  v_mfma_f32_16x16x32_bf16 v[84:87], a[40:43], a[16:19], v[84:87]
  ds_read_b64_tr_b16 a[120:121], v51 offset:512
  v_mfma_f32_16x16x32_bf16 v[88:91], a[0:3], a[16:19], v[88:91]
  ds_read_b64_tr_b16 a[122:123], v2 offset:16896
  v_mfma_f32_16x16x32_bf16 v[92:95], a[0:3], a[32:35], v[92:95]
  ds_read_b64_tr_b16 a[124:125], v4 offset:512
  buffer_load_dwordx4 v49, s[28:31], s56 offen offset:0 lds
  v_mfma_f32_16x16x32_bf16 v[96:99], a[40:43], a[32:35], v[96:99]
  ds_read_b64_tr_b16 a[126:127], v6 offset:16896
  v_mov_b32 v1, 2
  v_mfma_f32_16x16x32_bf16 v[100:103], a[40:43], a[36:39], v[100:103]
  v_mfma_f32_16x16x32_bf16 v[32:35], a[0:3], a[36:39], v[32:35]
  v_mfma_f32_16x16x32_bf16 v[104:107], a[0:3], a[44:47], v[104:107]
  buffer_load_dwordx4 v50, s[28:31], s56 offen offset:1024 lds
  v_mfma_f32_16x16x32_bf16 v[108:111], a[40:43], a[44:47], v[108:111]
  v_mfma_f32_16x16x32_bf16 v[112:115], a[40:43], a[48:51], v[112:115]
  s_waitcnt vmcnt(12) lgkmcnt(0)
  s_barrier
  v_mfma_f32_16x16x32_bf16 v[116:119], a[0:3], a[48:51], v[116:119]
  s_add_u32 m0, s0, 0x1000
  s_add_u32 s56, s54, 0
  ds_read_b64_tr_b16 a[16:17], v52 offset:0
  v_mfma_f32_16x16x32_bf16 v[36:39], a[0:3], a[60:63], v[36:39]
  s_add_u32 s34, s34, 0x3000
  ds_read_b64_tr_b16 a[18:19], v51 offset:16384
  buffer_store_dword v1, v0, s[36:39], s59 offen offset:0 sc1
  v_mfma_f32_16x16x32_bf16 v[80:83], a[40:43], a[60:63], v[80:83]
  s_lshl_b32 s67, 0x1111, s40
  ds_read_b64_tr_b16 a[20:21], v3 offset:0
  v_mfma_f32_16x16x32_bf16 v[120:123], a[40:43], a[52:55], v[120:123]
  s_or_b32 s42, s42, s67
  ds_read_b64_tr_b16 a[22:23], v4 offset:16384
  buffer_load_dwordx4 a[32:35], v62, s[36:39], s34 offen offset:0 sc1
  v_mfma_f32_16x16x32_bf16 v[124:127], a[0:3], a[52:55], v[124:127]
  ds_read_b64_tr_b16 a[36:37], v52 offset:512
  v_mfma_f32_16x16x32_bf16 v[128:131], a[0:3], a[68:71], v[128:131]
  ds_read_b64_tr_b16 a[38:39], v51 offset:16896
  buffer_load_dwordx4 v49, s[28:31], s56 offen offset:0 lds
  v_mfma_f32_16x16x32_bf16 v[132:135], a[40:43], a[68:71], v[132:135]
  ds_read_b64_tr_b16 a[44:45], v3 offset:512
  v_mfma_f32_16x16x32_bf16 v[136:139], a[40:43], a[76:79], v[136:139]
  ds_read_b64_tr_b16 a[46:47], v4 offset:16896
  v_mfma_f32_16x16x32_bf16 v[140:143], a[0:3], a[76:79], v[140:143]
  ds_read_b64_tr_b16 a[48:49], v52 offset:40960
  v_mfma_f32_16x16x32_bf16 v[144:147], a[0:3], a[80:83], v[144:147]
  ds_read_b64_tr_b16 a[50:51], v51 offset:57344
  buffer_load_dwordx4 v50, s[28:31], s56 offen offset:1024 lds
  v_mfma_f32_16x16x32_bf16 v[148:151], a[40:43], a[80:83], v[148:151]
  ds_read_b64_tr_b16 a[52:53], v3 offset:40960
  v_mfma_f32_16x16x32_bf16 v[40:43], a[8:11], a[84:87], v[40:43]
  ds_read_b64_tr_b16 a[54:55], v4 offset:57344
  buffer_load_dwordx4 a[60:63], v62, s[36:39], s34 offen offset:1024 sc1
  v_mfma_f32_16x16x32_bf16 v[44:47], a[12:15], a[84:87], v[44:47]
  ds_read_b64_tr_b16 a[68:69], v52 offset:41472
  v_mfma_f32_16x16x32_bf16 v[72:75], a[12:15], a[56:59], v[72:75]
  ds_read_b64_tr_b16 a[70:71], v51 offset:57856
  v_mfma_f32_16x16x32_bf16 v[76:79], a[8:11], a[56:59], v[76:79]
  ds_read_b64_tr_b16 a[0:1], v3 offset:41472
  v_mfma_f32_16x16x32_bf16 v[84:87], a[8:11], a[88:91], v[84:87]
  ds_read_b64_tr_b16 a[2:3], v4 offset:57856
  v_mfma_f32_16x16x32_bf16 v[88:91], a[12:15], a[88:91], v[88:91]
  ds_read_b64_tr_b16 a[40:41], v52 offset:26624
  v_mfma_f32_16x16x32_bf16 v[92:95], a[12:15], a[92:95], v[92:95]
  ds_read_b64_tr_b16 a[42:43], v51 offset:43008
  v_mfma_f32_16x16x32_bf16 v[96:99], a[8:11], a[92:95], v[96:99]
  ds_read_b64_tr_b16 a[76:77], v3 offset:26624
  v_mfma_f32_16x16x32_bf16 v[100:103], a[8:11], a[96:99], v[100:103]
  ds_read_b64_tr_b16 a[78:79], v4 offset:43008
  v_mfma_f32_16x16x32_bf16 v[32:35], a[12:15], a[96:99], v[32:35]
  ds_read_b64_tr_b16 a[56:57], v52 offset:27136
  v_mfma_f32_16x16x32_bf16 v[104:107], a[12:15], a[100:103], v[104:107]
  ds_read_b64_tr_b16 a[58:59], v51 offset:43520
  v_mfma_f32_16x16x32_bf16 v[108:111], a[8:11], a[100:103], v[108:111]
  ds_read_b64_tr_b16 a[80:81], v3 offset:27136
  v_mfma_f32_16x16x32_bf16 v[112:115], a[8:11], a[104:107], v[112:115]
  ds_read_b64_tr_b16 a[82:83], v4 offset:43520
  v_mfma_f32_16x16x32_bf16 v[116:119], a[12:15], a[104:107], v[116:119]
  s_waitcnt vmcnt(7)
  ds_read_b64_tr_b16 a[84:85], v52 offset:2048
  v_swap_b32 v66, v68
  v_mfma_f32_16x16x32_bf16 v[36:39], a[12:15], a[108:111], v[36:39]
  ds_read_b64_tr_b16 a[86:87], v51 offset:18432
  buffer_load_dwordx4 v58, s[28:31], s56 offen offset:2048 lds
  v_mfma_f32_16x16x32_bf16 v[80:83], a[8:11], a[108:111], v[80:83]
  ds_read_b64_tr_b16 a[88:89], v3 offset:2048
  v_swap_b32 v67, v69
  v_mfma_f32_16x16x32_bf16 v[120:123], a[8:11], a[112:115], v[120:123]
  ds_read_b64_tr_b16 a[90:91], v4 offset:18432
  buffer_load_dwordx4 a[92:95], v62, s[36:39], s34 offen offset:2048 sc1
  v_mfma_f32_16x16x32_bf16 v[124:127], a[12:15], a[112:115], v[124:127]
  ds_read_b64_tr_b16 a[96:97], v52 offset:2560
  v_mfma_f32_16x16x32_bf16 v[128:131], a[12:15], a[116:119], v[128:131]
  ds_read_b64_tr_b16 a[98:99], v51 offset:18944
  buffer_load_dwordx4 v59, s[28:31], s56 offen offset:3072 lds
  v_mfma_f32_16x16x32_bf16 v[132:135], a[8:11], a[116:119], v[132:135]
  s_add_u32 m0, s0, 0x5000
  s_add_u32 s54, s54, 0x12000
  ds_read_b64_tr_b16 a[100:101], v3 offset:2560
  v_mfma_f32_16x16x32_bf16 v[136:139], a[8:11], a[120:123], v[136:139]
  ds_read_b64_tr_b16 a[102:103], v4 offset:18944
  buffer_load_dwordx4 a[104:107], v62, s[36:39], s34 offen offset:3072 sc1
  v_mfma_f32_16x16x32_bf16 v[140:143], a[12:15], a[120:123], v[140:143]
  ds_read_b64_tr_b16 a[108:109], v52 offset:43008
  v_mfma_f32_16x16x32_bf16 v[144:147], a[12:15], a[124:127], v[144:147]
  ds_read_b64_tr_b16 a[110:111], v51 offset:59392
  v_mfma_f32_16x16x32_bf16 v[148:151], a[8:11], a[124:127], v[148:151]
  s_waitcnt lgkmcnt(15)
  ds_read_b64_tr_b16 a[112:113], v3 offset:43008
  v_mfma_f32_16x16x32_bf16 v[40:43], a[4:7], a[16:19], v[40:43]
  ds_read_b64_tr_b16 a[114:115], v4 offset:59392
  v_mfma_f32_16x16x32_bf16 v[44:47], a[64:67], a[16:19], v[44:47]
  ds_read_b64_tr_b16 a[116:117], v52 offset:43520
  buffer_load_dwordx4 v49, s[28:31], s54 offen offset:0 lds
  v_mfma_f32_16x16x32_bf16 v[72:75], a[64:67], a[20:23], v[72:75]
  ds_read_b64_tr_b16 a[118:119], v51 offset:59904
  v_mfma_f32_16x16x32_bf16 v[76:79], a[4:7], a[20:23], v[76:79]
  ds_read_b64_tr_b16 a[12:13], v3 offset:43520
  v_mfma_f32_16x16x32_bf16 v[84:87], a[4:7], a[36:39], v[84:87]
  ds_read_b64_tr_b16 a[14:15], v4 offset:59904
  v_mfma_f32_16x16x32_bf16 v[88:91], a[64:67], a[36:39], v[88:91]
  ds_read_b64_tr_b16 a[8:9], v51 offset:2048
  buffer_load_dwordx4 v50, s[28:31], s54 offen offset:1024 lds
  v_mfma_f32_16x16x32_bf16 v[92:95], a[64:67], a[44:47], v[92:95]
  ds_read_b64_tr_b16 a[10:11], v2 offset:18432
  v_mfma_f32_16x16x32_bf16 v[96:99], a[4:7], a[44:47], v[96:99]
  ds_read_b64_tr_b16 a[16:17], v4 offset:2048
  v_mfma_f32_16x16x32_bf16 v[100:103], a[4:7], a[48:51], v[100:103]
  ds_read_b64_tr_b16 a[18:19], v6 offset:18432
  v_mfma_f32_16x16x32_bf16 v[32:35], a[64:67], a[48:51], v[32:35]
  ds_read_b64_tr_b16 a[20:21], v51 offset:2560
  v_mfma_f32_16x16x32_bf16 v[104:107], a[64:67], a[52:55], v[104:107]
  ds_read_b64_tr_b16 a[22:23], v2 offset:18944
  v_mfma_f32_16x16x32_bf16 v[108:111], a[4:7], a[52:55], v[108:111]
  ds_read_b64_tr_b16 a[36:37], v4 offset:2560
  v_mfma_f32_16x16x32_bf16 v[112:115], a[4:7], a[68:71], v[112:115]
  ds_read_b64_tr_b16 a[38:39], v6 offset:18944
  v_mfma_f32_16x16x32_bf16 v[116:119], a[64:67], a[68:71], v[116:119]
  ds_read_b64_tr_b16 a[44:45], v52 offset:28672
  v_mfma_f32_16x16x32_bf16 v[36:39], a[64:67], a[0:3], v[36:39]
  ds_read_b64_tr_b16 a[46:47], v51 offset:45056
  buffer_load_dwordx4 v58, s[28:31], s54 offen offset:2048 lds
  v_mfma_f32_16x16x32_bf16 v[80:83], a[4:7], a[0:3], v[80:83]
  s_waitcnt lgkmcnt(15)
  ds_read_b64_tr_b16 a[48:49], v3 offset:28672
  v_mfma_f32_16x16x32_bf16 v[120:123], a[4:7], a[40:43], v[120:123]
  ds_read_b64_tr_b16 a[50:51], v4 offset:45056
  buffer_load_dwordx4 a[52:55], v62, s[36:39], s1 offen offset:0 sc1
  v_mfma_f32_16x16x32_bf16 v[124:127], a[64:67], a[40:43], v[124:127]
  ds_read_b64_tr_b16 a[68:69], v52 offset:29184
  v_mfma_f32_16x16x32_bf16 v[128:131], a[64:67], a[76:79], v[128:131]
  ds_read_b64_tr_b16 a[70:71], v51 offset:45568
  buffer_load_dwordx4 v59, s[28:31], s54 offen offset:3072 lds
  v_mfma_f32_16x16x32_bf16 v[132:135], a[4:7], a[76:79], v[132:135]
  s_add_u32 m0, s0, 0x4800
  s_add_u32 s34, s68, 0
  ds_read_b64_tr_b16 a[0:1], v3 offset:29184
  v_mfma_f32_16x16x32_bf16 v[136:139], a[4:7], a[56:59], v[136:139]
  ds_read_b64_tr_b16 a[2:3], v4 offset:45568
  buffer_load_dwordx4 a[120:123], v62, s[36:39], s1 offen offset:1024 sc1
  v_mfma_f32_16x16x32_bf16 v[140:143], a[64:67], a[56:59], v[140:143]
  ds_read_b64_tr_b16 a[40:41], v51 offset:4096
  v_mfma_f32_16x16x32_bf16 v[144:147], a[64:67], a[80:83], v[144:147]
  ds_read_b64_tr_b16 a[42:43], v2 offset:20480
  v_mfma_f32_16x16x32_bf16 v[148:151], a[4:7], a[80:83], v[148:151]
  ds_read_b64_tr_b16 a[76:77], v4 offset:4096
  v_mfma_f32_16x16x32_bf16 v[40:43], a[28:31], a[84:87], v[40:43]
  ds_read_b64_tr_b16 a[78:79], v6 offset:20480
  v_mfma_f32_16x16x32_bf16 v[44:47], a[72:75], a[84:87], v[44:47]
  ds_read_b64_tr_b16 a[124:125], v51 offset:4608
  v_mfma_f32_16x16x32_bf16 v[72:75], a[72:75], a[88:91], v[72:75]
  ds_read_b64_tr_b16 a[126:127], v2 offset:20992
  v_mfma_f32_16x16x32_bf16 v[76:79], a[28:31], a[88:91], v[76:79]
  ds_read_b64_tr_b16 a[56:57], v4 offset:4608
  v_mfma_f32_16x16x32_bf16 v[84:87], a[28:31], a[96:99], v[84:87]
  ds_read_b64_tr_b16 a[58:59], v6 offset:20992
  v_mfma_f32_16x16x32_bf16 v[88:91], a[72:75], a[96:99], v[88:91]
  s_waitcnt lgkmcnt(15)
  s_barrier
  v_mfma_f32_16x16x32_bf16 v[92:95], a[72:75], a[100:103], v[92:95]
  ds_read_b64_tr_b16 a[4:5], v52 offset:8192
  v_mfma_f32_16x16x32_bf16 v[96:99], a[28:31], a[100:103], v[96:99]
  ds_read_b64_tr_b16 a[6:7], v51 offset:24576
  buffer_load_dwordx4 a[64:67], v62, s[36:39], s1 offen offset:2048 sc1
  v_mfma_f32_16x16x32_bf16 v[100:103], a[28:31], a[108:111], v[100:103]
  ds_read_b64_tr_b16 a[80:81], v3 offset:8192
  v_mfma_f32_16x16x32_bf16 v[32:35], a[72:75], a[108:111], v[32:35]
  ds_read_b64_tr_b16 a[82:83], v4 offset:24576
  buffer_load_dwordx4 a[84:87], v62, s[36:39], s1 offen offset:3072 sc1
  v_mfma_f32_16x16x32_bf16 v[104:107], a[72:75], a[112:115], v[104:107]
  s_add_u32 s1, s53, 0x1000
  ds_read_b64_tr_b16 a[88:89], v52 offset:8704
  v_mfma_f32_16x16x32_bf16 v[108:111], a[28:31], a[112:115], v[108:111]
  ds_read_b64_tr_b16 a[90:91], v51 offset:25088
  v_mfma_f32_16x16x32_bf16 v[112:115], a[28:31], a[116:119], v[112:115]
  ds_read_b64_tr_b16 a[96:97], v3 offset:8704
  v_mfma_f32_16x16x32_bf16 v[116:119], a[72:75], a[116:119], v[116:119]
  ds_read_b64_tr_b16 a[98:99], v4 offset:25088
  v_mfma_f32_16x16x32_bf16 v[36:39], a[72:75], a[12:15], v[36:39]
  ds_read_b64_tr_b16 a[100:101], v52 offset:30720
  v_mfma_f32_16x16x32_bf16 v[80:83], a[28:31], a[12:15], v[80:83]
  ds_read_b64_tr_b16 a[102:103], v51 offset:47104
  v_mfma_f32_16x16x32_bf16 v[120:123], a[28:31], a[8:11], v[120:123]
  ds_read_b64_tr_b16 a[108:109], v3 offset:30720
  v_mfma_f32_16x16x32_bf16 v[124:127], a[72:75], a[8:11], v[124:127]
  ds_read_b64_tr_b16 a[110:111], v4 offset:47104
  v_mfma_f32_16x16x32_bf16 v[128:131], a[72:75], a[16:19], v[128:131]
  ds_read_b64_tr_b16 a[112:113], v52 offset:31232
  v_mfma_f32_16x16x32_bf16 v[132:135], a[28:31], a[16:19], v[132:135]
  ds_read_b64_tr_b16 a[114:115], v51 offset:47616
  v_mfma_f32_16x16x32_bf16 v[136:139], a[28:31], a[20:23], v[136:139]
  ds_read_b64_tr_b16 a[12:13], v3 offset:31232
  v_mfma_f32_16x16x32_bf16 v[140:143], a[72:75], a[20:23], v[140:143]
  ds_read_b64_tr_b16 a[14:15], v4 offset:47616
  v_mfma_f32_16x16x32_bf16 v[144:147], a[72:75], a[36:39], v[144:147]
  ds_read_b64_tr_b16 a[116:117], v51 offset:6144
  v_mfma_f32_16x16x32_bf16 v[148:151], a[28:31], a[36:39], v[148:151]
  s_waitcnt lgkmcnt(15)
  ds_read_b64_tr_b16 a[118:119], v2 offset:22528
  buffer_load_dwordx4 a[8:11], v62, s[36:39], s1 offen offset:0 sc1
  v_mfma_f32_16x16x32_bf16 v[40:43], a[128:131], a[44:47], v[40:43]
  ds_read_b64_tr_b16 a[16:17], v4 offset:6144
  v_mfma_f32_16x16x32_bf16 v[44:47], a[136:139], a[44:47], v[44:47]
  ds_read_b64_tr_b16 a[18:19], v6 offset:22528
  buffer_load_dwordx4 a[20:23], v62, s[36:39], s1 offen offset:1024 sc1
  v_mfma_f32_16x16x32_bf16 v[72:75], a[136:139], a[48:51], v[72:75]
  ds_read_b64_tr_b16 a[72:73], v51 offset:6656
  v_mfma_f32_16x16x32_bf16 v[76:79], a[128:131], a[48:51], v[76:79]
  ds_read_b64_tr_b16 a[74:75], v2 offset:23040
  v_mfma_f32_16x16x32_bf16 v[84:87], a[128:131], a[68:71], v[84:87]
  ds_read_b64_tr_b16 a[28:29], v4 offset:6656
  v_mfma_f32_16x16x32_bf16 v[88:91], a[136:139], a[68:71], v[88:91]
  ds_read_b64_tr_b16 a[30:31], v6 offset:23040
  v_mfma_f32_16x16x32_bf16 v[92:95], a[136:139], a[0:3], v[92:95]
  ds_read_b64_tr_b16 a[36:37], v52 offset:49152
  v_mul_u32_u24 v1, 0x1400, v5
  v_mfma_f32_16x16x32_bf16 v[96:99], a[128:131], a[0:3], v[96:99]
  ds_read_b64_tr_b16 a[38:39], v2 offset:0
  v_lshl_add_u32 v1, v48, 4, v1
  v_mfma_f32_16x16x32_bf16 v[100:103], a[128:131], a[40:43], v[100:103]
  s_lshl2_add_u32 s54, s41, s40
  s_lshl2_add_u32 s54, s54, s51
  ds_read_b64_tr_b16 a[44:45], v3 offset:49152
  v_mfma_f32_16x16x32_bf16 v[32:35], a[136:139], a[40:43], v[32:35]
  s_lshl2_add_u32 s56, s54, s3
  s_mul_i32 s56, s56, 0x3000
  ds_read_b64_tr_b16 a[46:47], v6 offset:0
  v_mfma_f32_16x16x32_bf16 v[104:107], a[136:139], a[76:79], v[104:107]
  s_add_u32 s67, s56, 0x600000
  s_add_u32 s68, s56, 0x601000
  ds_read_b64_tr_b16 a[0:1], v52 offset:49664
  v_mfma_f32_16x16x32_bf16 v[108:111], a[128:131], a[76:79], v[108:111]
  s_add_u32 s56, s56, 0x602000
  s_mul_i32 s54, s54, 0x5000
  ds_read_b64_tr_b16 a[2:3], v2 offset:512
  v_mfma_f32_16x16x32_bf16 v[112:115], a[128:131], a[124:127], v[112:115]
  s_lshl_b32 s8, s3, 8
  ds_read_b64_tr_b16 a[40:41], v3 offset:49664
  buffer_load_dwordx4 a[48:51], v62, s[36:39], s1 offen offset:2048 sc1
  v_mfma_f32_16x16x32_bf16 v[116:119], a[136:139], a[124:127], v[116:119]
  s_add_u32 s54, s54, s8
  s_add_u32 s8, s54, 0x1300000
  ds_read_b64_tr_b16 a[42:43], v6 offset:512
  v_mfma_f32_16x16x32_bf16 v[36:39], a[136:139], a[56:59], v[36:39]
  s_add_u32 s54, s54, 0x1300400
  s_lshr_b32 s9, s51, 1
  ds_read_b64_tr_b16 a[68:69], v52 offset:12288
  v_mfma_f32_16x16x32_bf16 v[80:83], a[128:131], a[56:59], v[80:83]
  s_waitcnt lgkmcnt(15)
  ds_read_b64_tr_b16 a[70:71], v51 offset:28672
  buffer_load_dwordx4 a[76:79], v62, s[36:39], s1 offen offset:3072 sc1
  v_mfma_f32_16x16x32_bf16 v[120:123], a[128:131], a[4:7], v[120:123]
  s_add_u32 s1, s70, 0
  s_lshl2_add_u32 s3, s9, s3
  ds_read_b64_tr_b16 a[124:125], v3 offset:12288
  v_mfma_f32_16x16x32_bf16 v[124:127], a[136:139], a[4:7], v[124:127]
  s_and_b32 s9, s51, 1
  s_lshl1_add_u32 s3, s3, s9
  ds_read_b64_tr_b16 a[126:127], v4 offset:28672
  v_mfma_f32_16x16x32_bf16 v[128:131], a[136:139], a[80:83], v[128:131]
  s_lshl_b32 s3, s3, 3
  s_lshl_b32 s41, s41, 7
  ds_read_b64_tr_b16 a[56:57], v52 offset:12800
  v_mfma_f32_16x16x32_bf16 v[132:135], a[128:131], a[80:83], v[132:135]
  s_add_u32 s9, s41, s3
  s_mul_i32 s9, s9, 0x480
  ds_read_b64_tr_b16 a[58:59], v51 offset:29184
  v_mfma_f32_16x16x32_bf16 v[136:139], a[128:131], a[88:91], v[136:139]
  s_lshl2_add_u32 s10, s40, s51
  ds_read_b64_tr_b16 a[4:5], v3 offset:12800
  buffer_load_dwordx4 v[24:27], v62, s[36:39], s66 offen offset:0 sc1
  v_mfma_f32_16x16x32_bf16 v[140:143], a[136:139], a[88:91], v[140:143]
  s_lshl_b32 s10, s10, 6
  s_lshl_b32 s40, s40, 5
  ds_read_b64_tr_b16 a[6:7], v4 offset:29184
  v_mfma_f32_16x16x32_bf16 v[144:147], a[136:139], a[96:99], v[144:147]
  s_add_u32 s40, s40, 0x400
  s_add_u32 s9, s9, s40
  ds_read_b64_tr_b16 a[80:81], v52 offset:53248
  v_mfma_f32_16x16x32_bf16 v[148:151], a[128:131], a[96:99], v[148:151]
  s_add_u32 s41, s41, s46
  ds_read_b64_tr_b16 a[82:83], v2 offset:4096
  v_mfma_f32_16x16x32_bf16 v[40:43], a[24:27], a[100:103], v[40:43]
  s_mul_i32 s41, s41, 0x480
  ds_read_b64_tr_b16 a[88:89], v3 offset:53248
  buffer_load_dwordx4 v[28:31], v62, s[36:39], s66 offen offset:1024 sc1
  v_mfma_f32_16x16x32_bf16 v[44:47], a[140:143], a[100:103], v[44:47]
  s_add_u32 s66, s11, 0x4000
  s_add_u32 s41, s41, s10
  ds_read_b64_tr_b16 a[90:91], v6 offset:4096
  v_mfma_f32_16x16x32_bf16 v[72:75], a[140:143], a[108:111], v[72:75]
  s_add_u32 s44, s41, 0x1200
  ds_read_b64_tr_b16 a[96:97], v52 offset:53760
  v_lshrrev_b32 v60, 3, v48
  v_mfma_f32_16x16x32_bf16 v[76:79], a[24:27], a[108:111], v[76:79]
  ds_read_b64_tr_b16 a[98:99], v2 offset:4608
  v_and_b32 v61, 3, v48
  v_mfma_f32_16x16x32_bf16 v[84:87], a[24:27], a[112:115], v[84:87]
  ds_read_b64_tr_b16 a[100:101], v3 offset:53760
  v_lshl_add_u32 v60, v60, 2, v61
  v_mfma_f32_16x16x32_bf16 v[88:91], a[140:143], a[112:115], v[88:91]
  ds_read_b64_tr_b16 a[102:103], v6 offset:4608
  buffer_load_dwordx4 a[128:131], v62, s[36:39], s1 offen offset:0 sc1
  v_mfma_f32_16x16x32_bf16 v[92:95], a[140:143], a[12:15], v[92:95]
  ds_read_b64_tr_b16 a[132:133], v52 offset:10240
  v_and_b32 v53, 1, v5
  v_mfma_f32_16x16x32_bf16 v[96:99], a[24:27], a[12:15], v[96:99]
  s_waitcnt lgkmcnt(15)
  ds_read_b64_tr_b16 a[134:135], v51 offset:26624
  v_lshrrev_b32 v54, 2, v48
  v_mfma_f32_16x16x32_bf16 v[100:103], a[24:27], a[116:119], v[100:103]
  ds_read_b64_tr_b16 a[108:109], v3 offset:10240
  v_lshlrev_b32 v55, 1, v48
  v_mfma_f32_16x16x32_bf16 v[32:35], a[140:143], a[116:119], v[32:35]
  ds_read_b64_tr_b16 a[110:111], v4 offset:26624
  buffer_load_ushort v152, v55, s[20:23], s10 offen offset:0
  v_mfma_f32_16x16x32_bf16 v[104:107], a[140:143], a[16:19], v[104:107]
  ds_read_b64_tr_b16 a[112:113], v52 offset:10752
  v_mfma_f32_16x16x32_bf16 v[108:111], a[24:27], a[16:19], v[108:111]
  ds_read_b64_tr_b16 a[114:115], v51 offset:27136
  buffer_load_ushort v153, v55, s[20:23], s10 offen offset:32
  v_mfma_f32_16x16x32_bf16 v[112:115], a[24:27], a[72:75], v[112:115]
  ds_read_b64_tr_b16 a[12:13], v3 offset:10752
  v_mfma_f32_16x16x32_bf16 v[116:119], a[140:143], a[72:75], v[116:119]
  ds_read_b64_tr_b16 a[14:15], v4 offset:27136
  buffer_load_dword v63, v7, s[36:39], s58 offen offset:0 sc1
  v_mfma_f32_16x16x32_bf16 v[36:39], a[140:143], a[28:31], v[36:39]
  ds_read_b64_tr_b16 a[116:117], v52 offset:51200
  v_mfma_f32_16x16x32_bf16 v[80:83], a[24:27], a[28:31], v[80:83]
  ds_read_b64_tr_b16 a[118:119], v2 offset:2048
  buffer_load_ushort v154, v55, s[20:23], s40 offen offset:0
  v_mfma_f32_16x16x32_bf16 v[120:123], a[24:27], a[36:39], v[120:123]
  ds_read_b64_tr_b16 a[16:17], v3 offset:51200
  v_mfma_f32_16x16x32_bf16 v[124:127], a[140:143], a[36:39], v[124:127]
  ds_read_b64_tr_b16 a[18:19], v6 offset:2048
  buffer_load_dwordx4 a[72:75], v62, s[36:39], s1 offen offset:1024 sc1
  v_mfma_f32_16x16x32_bf16 v[128:131], a[140:143], a[44:47], v[128:131]
  ds_read_b64_tr_b16 a[136:137], v52 offset:51712
  v_mfma_f32_16x16x32_bf16 v[132:135], a[24:27], a[44:47], v[132:135]
  ds_read_b64_tr_b16 a[138:139], v2 offset:2560
  buffer_load_dwordx4 v49, s[28:31], s34 offen offset:0 lds
  v_mfma_f32_16x16x32_bf16 v[136:139], a[24:27], a[0:3], v[136:139]
  ds_read_b64_tr_b16 a[28:29], v3 offset:51712
  v_mfma_f32_16x16x32_bf16 v[140:143], a[140:143], a[0:3], v[140:143]
  ds_read_b64_tr_b16 a[30:31], v6 offset:2560
  buffer_load_dwordx4 a[36:39], v62, s[36:39], s1 offen offset:2048 sc1
  v_mfma_f32_16x16x32_bf16 v[144:147], a[140:143], a[40:43], v[144:147]
  ds_read_b64_tr_b16 a[144:145], v52 offset:14336
  v_mfma_f32_16x16x32_bf16 v[148:151], a[24:27], a[40:43], v[148:151]
  s_waitcnt vmcnt(29) lgkmcnt(15)
  ds_read_b64_tr_b16 a[146:147], v51 offset:30720
  buffer_load_dwordx4 v50, s[28:31], s34 offen offset:1024 lds
  v_mfma_f32_16x16x32_bf16 v[40:43], a[32:35], a[68:71], v[40:43]
  s_waitcnt vmcnt(27)
  s_add_u32 m0, s0, 0
  s_add_u32 s10, s71, 0
  ds_read_b64_tr_b16 a[0:1], v3 offset:14336
  v_mfma_f32_16x16x32_bf16 v[44:47], a[60:63], a[68:71], v[44:47]
  ds_read_b64_tr_b16 a[2:3], v4 offset:30720
  buffer_load_dwordx4 a[44:47], v62, s[36:39], s1 offen offset:3072 sc1
  v_mfma_f32_16x16x32_bf16 v[72:75], a[60:63], a[124:127], v[72:75]
  s_add_u32 s1, s70, 0x1000
  ds_read_b64_tr_b16 a[24:25], v52 offset:14848
  v_mfma_f32_16x16x32_bf16 v[76:79], a[32:35], a[124:127], v[76:79]
  ds_read_b64_tr_b16 a[26:27], v51 offset:31232
  buffer_load_dwordx4 v49, s[28:31], s10 offen offset:0 lds
  v_mfma_f32_16x16x32_bf16 v[84:87], a[32:35], a[56:59], v[84:87]
  ds_read_b64_tr_b16 a[40:41], v3 offset:14848
  v_mfma_f32_16x16x32_bf16 v[88:91], a[60:63], a[56:59], v[88:91]
  ds_read_b64_tr_b16 a[42:43], v4 offset:31232
  v_mfma_f32_16x16x32_bf16 v[92:95], a[60:63], a[4:7], v[92:95]
  ds_read_b64_tr_b16 a[68:69], v52 offset:55296
  buffer_load_dwordx4 v50, s[28:31], s10 offen offset:1024 lds
  v_mfma_f32_16x16x32_bf16 v[96:99], a[32:35], a[4:7], v[96:99]
  ds_read_b64_tr_b16 a[70:71], v2 offset:6144
  v_mfma_f32_16x16x32_bf16 v[100:103], a[32:35], a[80:83], v[100:103]
  ds_read_b64_tr_b16 a[124:125], v3 offset:55296
  v_mfma_f32_16x16x32_bf16 v[32:35], a[60:63], a[80:83], v[32:35]
  ds_read_b64_tr_b16 a[126:127], v6 offset:6144
  buffer_load_dwordx4 v58, s[28:31], s10 offen offset:2048 lds
  v_mfma_f32_16x16x32_bf16 v[104:107], a[60:63], a[88:91], v[104:107]
  ds_read_b64_tr_b16 a[56:57], v52 offset:55808
  v_mfma_f32_16x16x32_bf16 v[108:111], a[32:35], a[88:91], v[108:111]
  s_waitcnt vmcnt(13)
  ds_read_b64_tr_b16 a[58:59], v2 offset:6656
  v_swap_b32 v26, v28
  v_mfma_f32_16x16x32_bf16 v[112:115], a[32:35], a[96:99], v[112:115]
  ds_read_b64_tr_b16 a[4:5], v3 offset:55808
  buffer_load_dwordx4 v59, s[28:31], s10 offen offset:3072 lds
  v_mfma_f32_16x16x32_bf16 v[116:119], a[60:63], a[96:99], v[116:119]
  s_add_u32 m0, s0, 0x6000
  s_add_u32 s10, s71, 0x12000
  ds_read_b64_tr_b16 a[6:7], v6 offset:6656
  v_mfma_f32_16x16x32_bf16 v[36:39], a[60:63], a[100:103], v[36:39]
  v_swap_b32 v27, v29
  v_mfma_f32_16x16x32_bf16 v[80:83], a[32:35], a[100:103], v[80:83]
  s_waitcnt lgkmcnt(15)
  buffer_load_dwordx4 v49, s[28:31], s10 offen offset:0 lds
  v_mfma_f32_16x16x32_bf16 v[120:123], a[32:35], a[132:135], v[120:123]
  v_mfma_f32_16x16x32_bf16 v[124:127], a[60:63], a[132:135], v[124:127]
  v_mfma_f32_16x16x32_bf16 v[128:131], a[60:63], a[108:111], v[128:131]
  s_waitcnt lgkmcnt(0)
  s_barrier
  v_mfma_f32_16x16x32_bf16 v[132:135], a[32:35], a[108:111], v[132:135]
  ds_read_b64_tr_b16 a[80:81], v52 offset:16384
  buffer_load_dwordx4 v50, s[28:31], s10 offen offset:1024 lds
  v_mfma_f32_16x16x32_bf16 v[136:139], a[32:35], a[112:115], v[136:139]
  ds_read_b64_tr_b16 a[82:83], v51 offset:32768
  v_mfma_f32_16x16x32_bf16 v[140:143], a[60:63], a[112:115], v[140:143]
  ds_read_b64_tr_b16 a[88:89], v3 offset:16384
  v_mfma_f32_16x16x32_bf16 v[144:147], a[60:63], a[12:15], v[144:147]
  ds_read_b64_tr_b16 a[90:91], v4 offset:32768
  buffer_load_dwordx4 v58, s[28:31], s10 offen offset:2048 lds
  v_mfma_f32_16x16x32_bf16 v[148:151], a[32:35], a[12:15], v[148:151]
  ds_read_b64_tr_b16 a[96:97], v52 offset:16896
  v_mfma_f32_16x16x32_bf16 v[120:123], a[92:95], a[116:119], v[120:123]
  ds_read_b64_tr_b16 a[98:99], v51 offset:33280
  v_mfma_f32_16x16x32_bf16 v[124:127], a[104:107], a[116:119], v[124:127]
  ds_read_b64_tr_b16 a[100:101], v3 offset:16896
  buffer_load_dwordx4 v59, s[28:31], s10 offen offset:3072 lds
  v_mfma_f32_16x16x32_bf16 v[128:131], a[104:107], a[16:19], v[128:131]
  s_add_u32 m0, s0, 0x2000
  s_add_u32 s10, s77, 0
  ds_read_b64_tr_b16 a[102:103], v4 offset:33280
  v_mfma_f32_16x16x32_bf16 v[132:135], a[92:95], a[16:19], v[132:135]
  ds_read_b64_tr_b16 a[12:13], v52 offset:57344
  v_mfma_f32_16x16x32_bf16 v[136:139], a[92:95], a[136:139], v[136:139]
  ds_read_b64_tr_b16 a[14:15], v2 offset:8192
  v_cvt_pk_bf16_f32 v156, v120, v121
  v_mfma_f32_16x16x32_bf16 v[140:143], a[104:107], a[136:139], v[140:143]
  ds_read_b64_tr_b16 a[32:33], v3 offset:57344
  v_cvt_pk_bf16_f32 v157, v122, v123
  v_mfma_f32_16x16x32_bf16 v[144:147], a[104:107], a[28:31], v[144:147]
  ds_read_b64_tr_b16 a[34:35], v6 offset:8192
  v_cvt_pk_bf16_f32 v158, v124, v125
  v_mfma_f32_16x16x32_bf16 v[148:151], a[92:95], a[28:31], v[148:151]
  ds_read_b64_tr_b16 a[16:17], v52 offset:57856
  buffer_load_dwordx4 a[60:63], v62, s[36:39], s1 offen offset:0 sc1
  v_mfma_f32_16x16x32_bf16 v[40:43], a[92:95], a[144:147], v[40:43]
  ds_read_b64_tr_b16 a[18:19], v2 offset:8704
  v_cvt_pk_bf16_f32 v159, v126, v127
  v_mfma_f32_16x16x32_bf16 v[44:47], a[104:107], a[144:147], v[44:47]
  ds_read_b64_tr_b16 a[108:109], v3 offset:57856
  v_cvt_pk_bf16_f32 v120, v132, v133
  v_mfma_f32_16x16x32_bf16 v[72:75], a[104:107], a[0:3], v[72:75]
  ds_read_b64_tr_b16 a[110:111], v6 offset:8704
  buffer_store_dwordx4 v[156:159], v62, s[36:39], s35 offen offset:1024 sc1
  v_mfma_f32_16x16x32_bf16 v[76:79], a[92:95], a[0:3], v[76:79]
  s_waitcnt vmcnt(16)
  s_xor_b32 s40, s32, 1
  ds_read_b64_tr_b16 a[28:29], v52 offset:4096
  v_cmp_gt_i32 vcc, 2, v63
  v_mfma_f32_16x16x32_bf16 v[84:87], a[92:95], a[24:27], v[84:87]
  s_nop 3
  ds_read_b64_tr_b16 a[30:31], v51 offset:20480
  buffer_load_dwordx4 a[112:115], v62, s[36:39], s1 offen offset:1024 sc1
  v_mfma_f32_16x16x32_bf16 v[88:91], a[104:107], a[24:27], v[88:91]
  s_and_b64 vcc, vcc, s[42:43]
  s_mul_i32 s40, s40, 0x14000
  ds_read_b64_tr_b16 a[116:117], v3 offset:4096
  v_mfma_f32_16x16x32_bf16 v[92:95], a[104:107], a[40:43], v[92:95]
  s_cbranch_vccnz L_rf2
L_bf2:
  s_add_u32 s71, s40, s78
  ds_read_b64_tr_b16 a[118:119], v4 offset:20480
  v_mfma_f32_16x16x32_bf16 v[96:99], a[92:95], a[40:43], v[96:99]
  ds_read_b64_tr_b16 a[0:1], v52 offset:4608
  buffer_load_dwordx4 v[124:127], v62, s[36:39], s67 offen offset:0 sc1
  v_mfma_f32_16x16x32_bf16 v[100:103], a[92:95], a[68:71], v[100:103]
  ds_read_b64_tr_b16 a[2:3], v51 offset:20992
  v_cvt_pk_bf16_f32 v121, v134, v135
  v_mfma_f32_16x16x32_bf16 v[32:35], a[104:107], a[68:71], v[32:35]
  ds_read_b64_tr_b16 a[24:25], v3 offset:4608
  v_cvt_pk_bf16_f32 v122, v128, v129
  v_mfma_f32_16x16x32_bf16 v[104:107], a[104:107], a[124:127], v[104:107]
  ds_read_b64_tr_b16 a[26:27], v4 offset:20992
  v_cvt_pk_bf16_f32 v123, v130, v131
  v_mfma_f32_16x16x32_bf16 v[108:111], a[92:95], a[124:127], v[108:111]
  ds_read_b64_tr_b16 a[40:41], v52 offset:45056
  v_cvt_pk_bf16_f32 v156, v136, v137
  v_mfma_f32_16x16x32_bf16 v[112:115], a[92:95], a[56:59], v[112:115]
  ds_read_b64_tr_b16 a[42:43], v51 offset:61440
  v_cvt_pk_bf16_f32 v157, v138, v139
  v_mfma_f32_16x16x32_bf16 v[116:119], a[104:107], a[56:59], v[116:119]
  ds_read_b64_tr_b16 a[68:69], v3 offset:45056
  v_cvt_pk_bf16_f32 v158, v140, v141
  v_mfma_f32_16x16x32_bf16 v[36:39], a[104:107], a[4:7], v[36:39]
  ds_read_b64_tr_b16 a[70:71], v4 offset:61440
  v_cvt_pk_bf16_f32 v159, v142, v143
  v_mfma_f32_16x16x32_bf16 v[80:83], a[92:95], a[4:7], v[80:83]
  s_waitcnt lgkmcnt(15)
  ds_read_b64_tr_b16 a[124:125], v52 offset:45568
  buffer_load_dwordx4 a[132:135], v62, s[36:39], s1 offen offset:2048 sc1
  v_mfma_f32_16x16x32_bf16 v[40:43], v[64:67], a[80:83], v[40:43]
  ds_read_b64_tr_b16 a[126:127], v51 offset:61952
  v_cvt_pk_bf16_f32 v128, v148, v149
  v_mfma_f32_16x16x32_bf16 v[44:47], v[68:71], a[80:83], v[44:47]
  ds_read_b64_tr_b16 a[56:57], v3 offset:45568
  buffer_load_dwordx4 a[104:107], v62, s[36:39], s1 offen offset:3072 sc1
  v_mfma_f32_16x16x32_bf16 v[72:75], v[68:71], a[88:91], v[72:75]
  s_add_u32 s1, s11, 0
  ds_read_b64_tr_b16 a[58:59], v4 offset:61952
  v_cvt_pk_bf16_f32 v129, v150, v151
  v_mfma_f32_16x16x32_bf16 v[76:79], v[64:67], a[88:91], v[76:79]
  ds_read_b64_tr_b16 a[4:5], v52 offset:6144
  v_cvt_pk_bf16_f32 v130, v144, v145
  v_mfma_f32_16x16x32_bf16 v[84:87], v[64:67], a[96:99], v[84:87]
  ds_read_b64_tr_b16 a[6:7], v51 offset:22528
  buffer_store_dwordx4 v[120:123], v62, s[36:39], s71 offen offset:1024 sc1
  v_mfma_f32_16x16x32_bf16 v[88:91], v[68:71], a[96:99], v[88:91]
  s_xor_b32 s71, s32, 2
  s_mul_i32 s71, s71, 0x14000
  ds_read_b64_tr_b16 a[80:81], v3 offset:6144
  v_mfma_f32_16x16x32_bf16 v[92:95], v[68:71], a[100:103], v[92:95]
  s_add_u32 s71, s71, s78
  ds_read_b64_tr_b16 a[82:83], v4 offset:22528
  v_cvt_pk_bf16_f32 v131, v146, v147
  v_mfma_f32_16x16x32_bf16 v[96:99], v[64:67], a[100:103], v[96:99]
  s_waitcnt lgkmcnt(15)
  ds_read_b64_tr_b16 a[88:89], v52 offset:6656
  buffer_load_dwordx4 v[120:123], v62, s[36:39], s67 offen offset:1024 sc1
  v_mfma_f32_16x16x32_bf16 v[100:103], v[64:67], a[12:15], v[100:103]
  ds_read_b64_tr_b16 a[90:91], v51 offset:23040
  v_mfma_f32_16x16x32_bf16 v[32:35], v[68:71], a[12:15], v[32:35]
  ds_read_b64_tr_b16 a[92:93], v3 offset:6656
  v_mfma_f32_16x16x32_bf16 v[104:107], v[68:71], a[32:35], v[104:107]
  ds_read_b64_tr_b16 a[94:95], v4 offset:23040
  v_mfma_f32_16x16x32_bf16 v[108:111], v[64:67], a[32:35], v[108:111]
  ds_read_b64_tr_b16 a[96:97], v52 offset:47104
  v_mfma_f32_16x16x32_bf16 v[112:115], v[64:67], a[16:19], v[112:115]
  ds_read_b64_tr_b16 a[98:99], v51 offset:63488
  v_mfma_f32_16x16x32_bf16 v[116:119], v[68:71], a[16:19], v[116:119]
  ds_read_b64_tr_b16 a[100:101], v3 offset:47104
  v_mfma_f32_16x16x32_bf16 v[36:39], v[68:71], a[108:111], v[36:39]
  ds_read_b64_tr_b16 a[102:103], v4 offset:63488
  v_mfma_f32_16x16x32_bf16 v[80:83], v[64:67], a[108:111], v[80:83]
  s_waitcnt lgkmcnt(15)
  ds_read_b64_tr_b16 a[12:13], v52 offset:47616
  buffer_load_dwordx4 v[132:135], v62, s[36:39], s66 offen offset:0 sc1
  v_mfma_f32_16x16x32_bf16 v[40:43], a[52:55], a[28:31], v[40:43]
  ds_read_b64_tr_b16 a[14:15], v51 offset:64000
  v_mfma_f32_16x16x32_bf16 v[44:47], a[120:123], a[28:31], v[44:47]
  ds_read_b64_tr_b16 a[32:33], v3 offset:47616
  buffer_load_dwordx4 v[136:139], v62, s[36:39], s66 offen offset:1024 sc1
  v_mfma_f32_16x16x32_bf16 v[72:75], a[120:123], a[116:119], v[72:75]
  ds_read_b64_tr_b16 a[34:35], v4 offset:64000
  v_mfma_f32_16x16x32_bf16 v[76:79], a[52:55], a[116:119], v[76:79]
  ds_read_b64_tr_b16 a[16:17], v52 offset:20480
  v_mfma_f32_16x16x32_bf16 v[84:87], a[52:55], a[0:3], v[84:87]
  ds_read_b64_tr_b16 a[18:19], v51 offset:36864
  buffer_store_dwordx4 v[156:159], v62, s[36:39], s71 offen offset:1024 sc1
  v_mfma_f32_16x16x32_bf16 v[88:91], a[120:123], a[0:3], v[88:91]
  s_xor_b32 s66, s32, 3
  s_mul_i32 s66, s66, 0x14000
  ds_read_b64_tr_b16 a[28:29], v3 offset:20480
  v_mfma_f32_16x16x32_bf16 v[92:95], a[120:123], a[24:27], v[92:95]
  s_add_u32 s66, s66, s78
  ds_read_b64_tr_b16 a[30:31], v4 offset:36864
  v_mfma_f32_16x16x32_bf16 v[96:99], a[52:55], a[24:27], v[96:99]
  s_waitcnt lgkmcnt(15)
  ds_read_b64_tr_b16 a[108:109], v52 offset:20992
  buffer_load_dwordx4 v[64:67], v62, s[36:39], s68 offen offset:0 sc1
  v_mfma_f32_16x16x32_bf16 v[100:103], a[52:55], a[40:43], v[100:103]
  ds_read_b64_tr_b16 a[110:111], v51 offset:37376
  v_mfma_f32_16x16x32_bf16 v[32:35], a[120:123], a[40:43], v[32:35]
  ds_read_b64_tr_b16 a[0:1], v3 offset:20992
  v_mfma_f32_16x16x32_bf16 v[104:107], a[120:123], a[68:71], v[104:107]
  ds_read_b64_tr_b16 a[2:3], v4 offset:37376
  v_mfma_f32_16x16x32_bf16 v[108:111], a[52:55], a[68:71], v[108:111]
  ds_read_b64_tr_b16 a[116:117], v52 offset:61440
  v_mfma_f32_16x16x32_bf16 v[112:115], a[52:55], a[124:127], v[112:115]
  ds_read_b64_tr_b16 a[118:119], v2 offset:12288
  v_mfma_f32_16x16x32_bf16 v[116:119], a[120:123], a[124:127], v[116:119]
  ds_read_b64_tr_b16 a[24:25], v3 offset:61440
  v_mfma_f32_16x16x32_bf16 v[36:39], a[120:123], a[56:59], v[36:39]
  ds_read_b64_tr_b16 a[26:27], v6 offset:12288
  v_mfma_f32_16x16x32_bf16 v[80:83], a[52:55], a[56:59], v[80:83]
  s_waitcnt lgkmcnt(15)
  ds_read_b64_tr_b16 a[40:41], v52 offset:61952
  buffer_load_dwordx4 v[68:71], v62, s[36:39], s1 offen offset:0 sc1
  v_mfma_f32_16x16x32_bf16 v[40:43], a[64:67], a[4:7], v[40:43]
  ds_read_b64_tr_b16 a[42:43], v2 offset:12800
  v_mfma_f32_16x16x32_bf16 v[44:47], a[84:87], a[4:7], v[44:47]
  ds_read_b64_tr_b16 a[68:69], v3 offset:61952
  buffer_load_dwordx4 v[140:143], v62, s[36:39], s1 offen offset:1024 sc1
  v_mfma_f32_16x16x32_bf16 v[72:75], a[84:87], a[80:83], v[72:75]
  ds_read_b64_tr_b16 a[70:71], v6 offset:12800
  v_mfma_f32_16x16x32_bf16 v[76:79], a[64:67], a[80:83], v[76:79]
  ds_read_b64_tr_b16 a[52:53], v52 offset:22528
  buffer_store_dwordx4 v[128:131], v62, s[36:39], s66 offen offset:1024 sc1
  v_mfma_f32_16x16x32_bf16 v[84:87], a[64:67], a[88:91], v[84:87]
  ds_read_b64_tr_b16 a[54:55], v51 offset:38912
  v_mfma_f32_16x16x32_bf16 v[88:91], a[84:87], a[88:91], v[88:91]
  ds_read_b64_tr_b16 a[56:57], v3 offset:22528
  v_mfma_f32_16x16x32_bf16 v[92:95], a[84:87], a[92:95], v[92:95]
  ds_read_b64_tr_b16 a[58:59], v4 offset:38912
  v_mfma_f32_16x16x32_bf16 v[96:99], a[64:67], a[92:95], v[96:99]
  s_waitcnt lgkmcnt(15)
  ds_read_b64_tr_b16 a[4:5], v52 offset:23040
  buffer_load_dwordx4 v[144:147], v62, s[36:39], s68 offen offset:1024 sc1
  v_mfma_f32_16x16x32_bf16 v[100:103], a[64:67], a[96:99], v[100:103]
  ds_read_b64_tr_b16 a[6:7], v51 offset:39424
  v_mfma_f32_16x16x32_bf16 v[32:35], a[84:87], a[96:99], v[32:35]
  ds_read_b64_tr_b16 a[80:81], v3 offset:23040
  buffer_load_dwordx4 v49, s[28:31], s10 offen offset:0 lds
  v_mfma_f32_16x16x32_bf16 v[104:107], a[84:87], a[100:103], v[104:107]
  ds_read_b64_tr_b16 a[82:83], v4 offset:39424
  v_mfma_f32_16x16x32_bf16 v[108:111], a[64:67], a[100:103], v[108:111]
  ds_read_b64_tr_b16 a[88:89], v52 offset:63488
  v_mfma_f32_16x16x32_bf16 v[112:115], a[64:67], a[12:15], v[112:115]
  ds_read_b64_tr_b16 a[90:91], v2 offset:14336
  buffer_load_dwordx4 v50, s[28:31], s10 offen offset:1024 lds
  v_mfma_f32_16x16x32_bf16 v[116:119], a[84:87], a[12:15], v[116:119]
  s_add_u32 m0, s0, 0x3000
  s_add_u32 s10, s79, 0
  ds_read_b64_tr_b16 a[92:93], v3 offset:63488
  v_mfma_f32_16x16x32_bf16 v[36:39], a[84:87], a[32:35], v[36:39]
  ds_read_b64_tr_b16 a[94:95], v6 offset:14336
  v_mfma_f32_16x16x32_bf16 v[80:83], a[64:67], a[32:35], v[80:83]
  s_waitcnt lgkmcnt(15)
  ds_read_b64_tr_b16 a[96:97], v52 offset:64000
  buffer_load_dwordx4 v49, s[28:31], s10 offen offset:0 lds
  v_mfma_f32_16x16x32_bf16 v[40:43], a[8:11], a[16:19], v[40:43]
  ds_read_b64_tr_b16 a[98:99], v2 offset:14848
  v_mfma_f32_16x16x32_bf16 v[44:47], a[20:23], a[16:19], v[44:47]
  ds_read_b64_tr_b16 a[12:13], v3 offset:64000
  buffer_load_dwordx4 v[128:131], v62, s[36:39], s1 offen offset:2048 sc1
  v_mfma_f32_16x16x32_bf16 v[72:75], a[20:23], a[28:31], v[72:75]
  ds_read_b64_tr_b16 a[14:15], v6 offset:14848
  v_mov_b32 v55, 3
  v_mfma_f32_16x16x32_bf16 v[76:79], a[8:11], a[28:31], v[76:79]
  buffer_load_dwordx4 v50, s[28:31], s10 offen offset:1024 lds
  v_mfma_f32_16x16x32_bf16 v[84:87], a[8:11], a[108:111], v[84:87]
  s_waitcnt vmcnt(11)
  v_swap_b32 v134, v136
  v_swap_b32 v135, v137
  v_mfma_f32_16x16x32_bf16 v[88:91], a[20:23], a[108:111], v[88:91]
  buffer_load_dwordx4 v[148:151], v62, s[36:39], s1 offen offset:3072 sc1
  s_add_u32 s1, s11, 0x1000
  v_mfma_f32_16x16x32_bf16 v[92:95], a[20:23], a[0:3], v[92:95]
  v_mfma_f32_16x16x32_bf16 v[96:99], a[8:11], a[0:3], v[96:99]
  s_waitcnt vmcnt(7) lgkmcnt(0)
  s_barrier
  v_mfma_f32_16x16x32_bf16 v[100:103], a[8:11], a[116:119], v[100:103]
  ds_read_b64_tr_b16 a[16:17], v52 offset:18432
  v_mfma_f32_16x16x32_bf16 v[32:35], a[20:23], a[116:119], v[32:35]
  ds_read_b64_tr_b16 a[18:19], v51 offset:34816
  buffer_store_dword v55, v0, s[36:39], s59 offen offset:0 sc1
  v_mfma_f32_16x16x32_bf16 v[104:107], a[20:23], a[24:27], v[104:107]
  ds_read_b64_tr_b16 a[28:29], v3 offset:18432
  v_mfma_f32_16x16x32_bf16 v[108:111], a[8:11], a[24:27], v[108:111]
  ds_read_b64_tr_b16 a[30:31], v4 offset:34816
  buffer_load_dwordx4 v[156:159], v62, s[36:39], s56 offen offset:0 sc1
  v_mfma_f32_16x16x32_bf16 v[112:115], a[8:11], a[40:43], v[112:115]
  ds_read_b64_tr_b16 a[0:1], v52 offset:18944
  v_mfma_f32_16x16x32_bf16 v[116:119], a[20:23], a[40:43], v[116:119]
  ds_read_b64_tr_b16 a[2:3], v51 offset:35328
  buffer_load_dwordx4 v58, s[28:31], s10 offen offset:2048 lds
  v_mfma_f32_16x16x32_bf16 v[36:39], a[20:23], a[68:71], v[36:39]
  ds_read_b64_tr_b16 a[32:33], v3 offset:18944
  v_mfma_f32_16x16x32_bf16 v[80:83], a[8:11], a[68:71], v[80:83]
  ds_read_b64_tr_b16 a[34:35], v4 offset:35328
  buffer_load_dwordx4 v[160:163], v62, s[36:39], s1 offen offset:0 sc1
  v_mfma_f32_16x16x32_bf16 v[40:43], a[48:51], a[52:55], v[40:43]
  ds_read_b64_tr_b16 a[24:25], v52 offset:59392
  v_mfma_f32_16x16x32_bf16 v[44:47], a[76:79], a[52:55], v[44:47]
  ds_read_b64_tr_b16 a[26:27], v2 offset:10240
  buffer_load_dwordx4 v59, s[28:31], s10 offen offset:3072 lds
  v_mfma_f32_16x16x32_bf16 v[72:75], a[76:79], a[56:59], v[72:75]
  s_add_u32 m0, s0, 0x7000
  s_add_u32 s10, s79, 0x12000
  ds_read_b64_tr_b16 a[8:9], v3 offset:59392
  v_mfma_f32_16x16x32_bf16 v[76:79], a[48:51], a[56:59], v[76:79]
  ds_read_b64_tr_b16 a[10:11], v6 offset:10240
  buffer_load_dwordx4 v[164:167], v62, s[36:39], s1 offen offset:1024 sc1
  v_mfma_f32_16x16x32_bf16 v[84:87], a[48:51], a[4:7], v[84:87]
  ds_read_b64_tr_b16 a[20:21], v52 offset:59904
  v_mfma_f32_16x16x32_bf16 v[88:91], a[76:79], a[4:7], v[88:91]
  ds_read_b64_tr_b16 a[22:23], v2 offset:10752
  buffer_load_dwordx4 v49, s[28:31], s10 offen offset:0 lds
  v_mfma_f32_16x16x32_bf16 v[92:95], a[76:79], a[80:83], v[92:95]
  ds_read_b64_tr_b16 a[40:41], v3 offset:59904
  v_mfma_f32_16x16x32_bf16 v[96:99], a[48:51], a[80:83], v[96:99]
  ds_read_b64_tr_b16 a[42:43], v6 offset:10752
  v_mfma_f32_16x16x32_bf16 v[100:103], a[48:51], a[88:91], v[100:103]
  ds_read_b64_tr_b16 a[52:53], v52 offset:0
  buffer_load_dwordx4 v50, s[28:31], s10 offen offset:1024 lds
  v_mfma_f32_16x16x32_bf16 v[32:35], a[76:79], a[88:91], v[32:35]
  ds_read_b64_tr_b16 a[54:55], v51 offset:16384
  v_mfma_f32_16x16x32_bf16 v[104:107], a[76:79], a[92:95], v[104:107]
  ds_read_b64_tr_b16 a[4:5], v3 offset:0
  v_mfma_f32_16x16x32_bf16 v[108:111], a[48:51], a[92:95], v[108:111]
  ds_read_b64_tr_b16 a[6:7], v4 offset:16384
  buffer_load_dwordx4 v[168:171], v62, s[36:39], s56 offen offset:1024 sc1
  v_mfma_f32_16x16x32_bf16 v[112:115], a[48:51], a[96:99], v[112:115]
  ds_read_b64_tr_b16 a[56:57], v52 offset:512
  v_mfma_f32_16x16x32_bf16 v[116:119], a[76:79], a[96:99], v[116:119]
  ds_read_b64_tr_b16 a[58:59], v51 offset:16896
  buffer_load_dwordx4 v58, s[28:31], s10 offen offset:2048 lds
  v_mfma_f32_16x16x32_bf16 v[36:39], a[76:79], a[12:15], v[36:39]
  ds_read_b64_tr_b16 a[64:65], v3 offset:512
  v_mfma_f32_16x16x32_bf16 v[80:83], a[48:51], a[12:15], v[80:83]
  s_waitcnt lgkmcnt(15)
  ds_read_b64_tr_b16 a[66:67], v4 offset:16896
  buffer_load_dwordx4 v[172:175], v62, s[36:39], s1 offen offset:2048 sc1
  v_mfma_f32_16x16x32_bf16 v[40:43], v[24:27], a[16:19], v[40:43]
  ds_read_b64_tr_b16 a[68:69], v52 offset:40960
  v_mfma_f32_16x16x32_bf16 v[44:47], v[28:31], a[16:19], v[44:47]
  ds_read_b64_tr_b16 a[70:71], v51 offset:57344
  buffer_load_dwordx4 v59, s[28:31], s10 offen offset:3072 lds
  v_mfma_f32_16x16x32_bf16 v[72:75], v[28:31], a[28:31], v[72:75]
  s_add_u32 m0, s0, 0x1000
  s_add_u32 s10, s52, 0x24000
  ds_read_b64_tr_b16 a[12:13], v3 offset:40960
  v_mfma_f32_16x16x32_bf16 v[76:79], v[24:27], a[28:31], v[76:79]
  ds_read_b64_tr_b16 a[14:15], v4 offset:57344
  buffer_load_dwordx4 v[176:179], v62, s[36:39], s1 offen offset:3072 sc1
  v_mfma_f32_16x16x32_bf16 v[84:87], v[24:27], a[0:3], v[84:87]
  s_add_u32 s1, s53, 0x2000
  ds_read_b64_tr_b16 a[16:17], v52 offset:41472
  v_mfma_f32_16x16x32_bf16 v[88:91], v[28:31], a[0:3], v[88:91]
  ds_read_b64_tr_b16 a[18:19], v51 offset:57856
  v_mfma_f32_16x16x32_bf16 v[92:95], v[28:31], a[32:35], v[92:95]
  ds_read_b64_tr_b16 a[48:49], v3 offset:41472
  v_mfma_f32_16x16x32_bf16 v[96:99], v[24:27], a[32:35], v[96:99]
  s_waitcnt lgkmcnt(15)
  ds_read_b64_tr_b16 a[50:51], v4 offset:57856
  v_mfma_f32_16x16x32_bf16 v[100:103], v[24:27], a[24:27], v[100:103]
  ds_read_b64_tr_b16 a[28:29], v52 offset:2048
  v_mfma_f32_16x16x32_bf16 v[32:35], v[28:31], a[24:27], v[32:35]
  ds_read_b64_tr_b16 a[30:31], v51 offset:18432
  v_mfma_f32_16x16x32_bf16 v[104:107], v[28:31], a[8:11], v[104:107]
  ds_read_b64_tr_b16 a[0:1], v3 offset:2048
  v_mfma_f32_16x16x32_bf16 v[108:111], v[24:27], a[8:11], v[108:111]
  ds_read_b64_tr_b16 a[2:3], v4 offset:18432
  v_mfma_f32_16x16x32_bf16 v[112:115], v[24:27], a[20:23], v[112:115]
  ds_read_b64_tr_b16 a[32:33], v52 offset:2560
  v_mfma_f32_16x16x32_bf16 v[116:119], v[28:31], a[20:23], v[116:119]
  ds_read_b64_tr_b16 a[34:35], v51 offset:18944
  v_mfma_f32_16x16x32_bf16 v[36:39], v[28:31], a[40:43], v[36:39]
  ds_read_b64_tr_b16 a[76:77], v3 offset:2560
  v_mfma_f32_16x16x32_bf16 v[80:83], v[24:27], a[40:43], v[80:83]
  s_waitcnt lgkmcnt(15)
  ds_read_b64_tr_b16 a[78:79], v4 offset:18944
  buffer_load_dwordx4 a[24:27], v62, s[36:39], s1 offen offset:0 sc1
  v_mfma_f32_16x16x32_bf16 v[40:43], a[128:131], a[52:55], v[40:43]
  ds_read_b64_tr_b16 a[8:9], v52 offset:43008
  v_mfma_f32_16x16x32_bf16 v[44:47], a[72:75], a[52:55], v[44:47]
  ds_read_b64_tr_b16 a[10:11], v51 offset:59392
  buffer_load_dwordx4 a[20:23], v62, s[36:39], s1 offen offset:1024 sc1
  v_mfma_f32_16x16x32_bf16 v[72:75], a[72:75], a[4:7], v[72:75]
  ds_read_b64_tr_b16 a[80:81], v3 offset:43008
  v_mfma_f32_16x16x32_bf16 v[76:79], a[128:131], a[4:7], v[76:79]
  ds_read_b64_tr_b16 a[82:83], v4 offset:59392
  buffer_load_dwordx4 a[40:43], v62, s[36:39], s1 offen offset:2048 sc1
  v_mfma_f32_16x16x32_bf16 v[84:87], a[128:131], a[56:59], v[84:87]
  ds_read_b64_tr_b16 a[84:85], v52 offset:43520
  v_mfma_f32_16x16x32_bf16 v[88:91], a[72:75], a[56:59], v[88:91]
  ds_read_b64_tr_b16 a[86:87], v51 offset:59904
  buffer_load_dwordx4 a[52:55], v62, s[36:39], s1 offen offset:3072 sc1
  v_mfma_f32_16x16x32_bf16 v[92:95], a[72:75], a[64:67], v[92:95]
  s_add_u32 s1, s53, 0x3000
  ds_read_b64_tr_b16 a[88:89], v3 offset:43520
  v_mfma_f32_16x16x32_bf16 v[96:99], a[128:131], a[64:67], v[96:99]
  s_waitcnt lgkmcnt(15)
  ds_read_b64_tr_b16 a[90:91], v4 offset:59904
  buffer_load_dwordx4 a[4:7], v62, s[36:39], s1 offen offset:0 sc1
  v_mfma_f32_16x16x32_bf16 v[100:103], a[128:131], a[68:71], v[100:103]
  ds_read_b64_tr_b16 a[92:93], v52 offset:24576
  v_mfma_f32_16x16x32_bf16 v[32:35], a[72:75], a[68:71], v[32:35]
  ds_read_b64_tr_b16 a[94:95], v51 offset:40960
  buffer_load_dwordx4 a[56:59], v62, s[36:39], s1 offen offset:1024 sc1
  v_mfma_f32_16x16x32_bf16 v[104:107], a[72:75], a[12:15], v[104:107]
  ds_read_b64_tr_b16 a[96:97], v3 offset:24576
  v_mfma_f32_16x16x32_bf16 v[108:111], a[128:131], a[12:15], v[108:111]
  ds_read_b64_tr_b16 a[98:99], v4 offset:40960
  buffer_load_dwordx4 a[64:67], v62, s[36:39], s1 offen offset:2048 sc1
  v_mfma_f32_16x16x32_bf16 v[112:115], a[128:131], a[16:19], v[112:115]
  ds_read_b64_tr_b16 a[100:101], v52 offset:25088
  v_mfma_f32_16x16x32_bf16 v[116:119], a[72:75], a[16:19], v[116:119]
  ds_read_b64_tr_b16 a[102:103], v51 offset:41472
  buffer_load_dwordx4 a[68:71], v62, s[36:39], s1 offen offset:3072 sc1
  v_mfma_f32_16x16x32_bf16 v[36:39], a[72:75], a[48:51], v[36:39]
  s_add_u32 s1, s70, 0x2000
  ds_read_b64_tr_b16 a[108:109], v3 offset:25088
  v_mfma_f32_16x16x32_bf16 v[80:83], a[128:131], a[48:51], v[80:83]
  s_waitcnt lgkmcnt(15)
  ds_read_b64_tr_b16 a[110:111], v4 offset:41472
  buffer_load_dwordx4 a[12:15], v62, s[36:39], s1 offen offset:0 sc1
  v_mfma_f32_16x16x32_bf16 v[40:43], a[36:39], a[28:31], v[40:43]
  ds_read_b64_tr_b16 a[116:117], v51 offset:0
  v_mfma_f32_16x16x32_bf16 v[44:47], a[44:47], a[28:31], v[44:47]
  ds_read_b64_tr_b16 a[118:119], v2 offset:16384
  buffer_load_dwordx4 a[16:19], v62, s[36:39], s1 offen offset:1024 sc1
  v_mfma_f32_16x16x32_bf16 v[72:75], a[44:47], a[0:3], v[72:75]
  ds_read_b64_tr_b16 a[72:73], v4 offset:0
  v_mfma_f32_16x16x32_bf16 v[76:79], a[36:39], a[0:3], v[76:79]
  ds_read_b64_tr_b16 a[74:75], v6 offset:16384
  buffer_load_dwordx4 a[48:51], v62, s[36:39], s1 offen offset:2048 sc1
  v_mfma_f32_16x16x32_bf16 v[84:87], a[36:39], a[32:35], v[84:87]
  ds_read_b64_tr_b16 a[120:121], v51 offset:512
  v_mfma_f32_16x16x32_bf16 v[88:91], a[44:47], a[32:35], v[88:91]
  ds_read_b64_tr_b16 a[122:123], v2 offset:16896
  buffer_load_dwordx4 a[28:31], v62, s[36:39], s1 offen offset:3072 sc1
  v_mfma_f32_16x16x32_bf16 v[92:95], a[44:47], a[76:79], v[92:95]
  s_add_u32 s1, s70, 0x3000
  ds_read_b64_tr_b16 a[124:125], v4 offset:512
  v_mfma_f32_16x16x32_bf16 v[96:99], a[36:39], a[76:79], v[96:99]
  s_waitcnt lgkmcnt(15)
  ds_read_b64_tr_b16 a[126:127], v6 offset:16896
  buffer_load_dwordx4 a[0:3], v62, s[36:39], s1 offen offset:0 sc1
  v_mfma_f32_16x16x32_bf16 v[100:103], a[36:39], a[8:11], v[100:103]
  ds_read_b64_tr_b16 a[128:129], v52 offset:26624
  v_mfma_f32_16x16x32_bf16 v[32:35], a[44:47], a[8:11], v[32:35]
  ds_read_b64_tr_b16 a[130:131], v51 offset:43008
  buffer_load_dwordx4 a[32:35], v62, s[36:39], s1 offen offset:1024 sc1
  v_mfma_f32_16x16x32_bf16 v[104:107], a[44:47], a[80:83], v[104:107]
  ds_read_b64_tr_b16 a[136:137], v3 offset:26624
  v_mfma_f32_16x16x32_bf16 v[108:111], a[36:39], a[80:83], v[108:111]
  ds_read_b64_tr_b16 a[138:139], v4 offset:43008
  buffer_load_dwordx4 a[76:79], v62, s[36:39], s1 offen offset:2048 sc1
  v_mfma_f32_16x16x32_bf16 v[112:115], a[36:39], a[84:87], v[112:115]
  ds_read_b64_tr_b16 a[140:141], v52 offset:27136
  v_mfma_f32_16x16x32_bf16 v[116:119], a[44:47], a[84:87], v[116:119]
  ds_read_b64_tr_b16 a[142:143], v51 offset:43520
  buffer_load_dwordx4 a[8:11], v62, s[36:39], s1 offen offset:3072 sc1
  v_mfma_f32_16x16x32_bf16 v[36:39], a[44:47], a[88:91], v[36:39]
  s_add_u32 s1, s11, 0x2000
  ds_read_b64_tr_b16 a[144:145], v3 offset:27136
  v_mfma_f32_16x16x32_bf16 v[80:83], a[36:39], a[88:91], v[80:83]
  s_waitcnt lgkmcnt(15)
  ds_read_b64_tr_b16 a[146:147], v4 offset:43520
  buffer_load_dwordx4 v49, s[28:31], s10 offen offset:0 lds
  v_mfma_f32_16x16x32_bf16 v[40:43], a[60:63], a[92:95], v[40:43]
  ds_read_b64_tr_b16 a[80:81], v51 offset:2048
  v_mfma_f32_16x16x32_bf16 v[44:47], a[112:115], a[92:95], v[44:47]
  ds_read_b64_tr_b16 a[82:83], v2 offset:18432
  buffer_load_dwordx4 a[84:87], v62, s[36:39], s1 offen offset:0 sc1
  v_mfma_f32_16x16x32_bf16 v[72:75], a[112:115], a[96:99], v[72:75]
  ds_read_b64_tr_b16 a[44:45], v4 offset:2048
  v_mfma_f32_16x16x32_bf16 v[76:79], a[60:63], a[96:99], v[76:79]
  ds_read_b64_tr_b16 a[46:47], v6 offset:18432
  buffer_load_dwordx4 v50, s[28:31], s10 offen offset:1024 lds
  v_mfma_f32_16x16x32_bf16 v[84:87], a[60:63], a[100:103], v[84:87]
  ds_read_b64_tr_b16 a[36:37], v51 offset:2560
  v_mfma_f32_16x16x32_bf16 v[88:91], a[112:115], a[100:103], v[88:91]
  ds_read_b64_tr_b16 a[38:39], v2 offset:18944
  buffer_load_dwordx4 a[88:91], v62, s[36:39], s1 offen offset:1024 sc1
  v_mfma_f32_16x16x32_bf16 v[92:95], a[112:115], a[108:111], v[92:95]
  ds_read_b64_tr_b16 a[92:93], v4 offset:2560
  v_mfma_f32_16x16x32_bf16 v[96:99], a[60:63], a[108:111], v[96:99]
  s_waitcnt lgkmcnt(15)
  ds_read_b64_tr_b16 a[94:95], v6 offset:18944
  buffer_load_dwordx4 v56, s[28:31], s10 offen offset:2048 lds
  v_mfma_f32_16x16x32_bf16 v[100:103], a[60:63], a[116:119], v[100:103]
  v_mfma_f32_16x16x32_bf16 v[32:35], a[112:115], a[116:119], v[32:35]
  buffer_load_dwordx4 a[96:99], v62, s[36:39], s1 offen offset:2048 sc1
  v_mfma_f32_16x16x32_bf16 v[104:107], a[112:115], a[72:75], v[104:107]
  v_mfma_f32_16x16x32_bf16 v[108:111], a[60:63], a[72:75], v[108:111]
  buffer_load_dwordx4 v57, s[28:31], s10 offen offset:3072 lds
  s_add_u32 m0, s0, 0x5000
  v_mfma_f32_16x16x32_bf16 v[112:115], a[60:63], a[120:123], v[112:115]
  s_waitcnt vmcnt(24) lgkmcnt(0)
  s_barrier
  v_mfma_f32_16x16x32_bf16 v[116:119], a[112:115], a[120:123], v[116:119]
  s_add_u32 s10, s69, 0x24000
  ds_read_b64_tr_b16 a[100:101], v52 offset:8192
  buffer_load_dwordx4 a[108:111], v62, s[36:39], s1 offen offset:3072 sc1
  v_mfma_f32_16x16x32_bf16 v[36:39], a[112:115], a[124:127], v[36:39]
  s_add_u32 s1, s11, 0x3000
  ds_read_b64_tr_b16 a[102:103], v51 offset:24576
  v_mfma_f32_16x16x32_bf16 v[80:83], a[60:63], a[124:127], v[80:83]
  ds_read_b64_tr_b16 a[72:73], v3 offset:8192
  buffer_load_dwordx4 v49, s[28:31], s10 offen offset:0 lds
  v_mfma_f32_16x16x32_bf16 v[40:43], a[132:135], a[128:131], v[40:43]
  ds_read_b64_tr_b16 a[74:75], v4 offset:24576
  v_mfma_f32_16x16x32_bf16 v[44:47], a[104:107], a[128:131], v[44:47]
  ds_read_b64_tr_b16 a[116:117], v52 offset:8704
  buffer_load_dwordx4 a[120:123], v62, s[36:39], s1 offen offset:0 sc1
  v_mfma_f32_16x16x32_bf16 v[72:75], a[104:107], a[136:139], v[72:75]
  ds_read_b64_tr_b16 a[118:119], v51 offset:25088
  v_mfma_f32_16x16x32_bf16 v[76:79], a[132:135], a[136:139], v[76:79]
  ds_read_b64_tr_b16 a[60:61], v3 offset:8704
  buffer_load_dword v63, v7, s[36:39], s58 offen offset:0 sc1
  v_mfma_f32_16x16x32_bf16 v[84:87], a[132:135], a[140:143], v[84:87]
  ds_read_b64_tr_b16 a[62:63], v4 offset:25088
  v_mfma_f32_16x16x32_bf16 v[88:91], a[104:107], a[140:143], v[88:91]
  ds_read_b64_tr_b16 a[112:113], v52 offset:49152
  buffer_load_dwordx4 v50, s[28:31], s10 offen offset:1024 lds
  v_mfma_f32_16x16x32_bf16 v[92:95], a[104:107], a[144:147], v[92:95]
  ds_read_b64_tr_b16 a[114:115], v2 offset:0
  v_mfma_f32_16x16x32_bf16 v[96:99], a[132:135], a[144:147], v[96:99]
  ds_read_b64_tr_b16 a[124:125], v3 offset:49152
  buffer_load_dwordx4 a[128:131], v62, s[36:39], s1 offen offset:1024 sc1
  v_mfma_f32_16x16x32_bf16 v[100:103], a[132:135], a[80:83], v[100:103]
  ds_read_b64_tr_b16 a[126:127], v6 offset:0
  v_mfma_f32_16x16x32_bf16 v[32:35], a[104:107], a[80:83], v[32:35]
  ds_read_b64_tr_b16 a[136:137], v52 offset:49664
  buffer_load_dwordx4 v56, s[28:31], s10 offen offset:2048 lds
  v_mfma_f32_16x16x32_bf16 v[104:107], a[104:107], a[44:47], v[104:107]
  ds_read_b64_tr_b16 a[138:139], v2 offset:512
  v_mfma_f32_16x16x32_bf16 v[108:111], a[132:135], a[44:47], v[108:111]
  ds_read_b64_tr_b16 a[140:141], v3 offset:49664
  buffer_load_dwordx4 a[144:147], v62, s[36:39], s1 offen offset:2048 sc1
  v_mfma_f32_16x16x32_bf16 v[112:115], a[132:135], a[36:39], v[112:115]
  ds_read_b64_tr_b16 a[142:143], v6 offset:512
  v_mfma_f32_16x16x32_bf16 v[116:119], a[104:107], a[36:39], v[116:119]
  ds_read_b64_tr_b16 a[148:149], v52 offset:12288
  buffer_load_dwordx4 v57, s[28:31], s10 offen offset:3072 lds
  v_mfma_f32_16x16x32_bf16 v[36:39], a[104:107], a[92:95], v[36:39]
  s_add_u32 m0, s0, 0
  s_add_u32 s59, s33, 0x24000
  ds_read_b64_tr_b16 a[150:151], v51 offset:28672
  v_mfma_f32_16x16x32_bf16 v[80:83], a[132:135], a[92:95], v[80:83]
  s_waitcnt lgkmcnt(10)
  ds_read_b64_tr_b16 a[44:45], v3 offset:12288
  buffer_load_dwordx4 a[80:83], v62, s[36:39], s1 offen offset:3072 sc1
  v_mfma_f32_16x16x32_bf16 v[40:43], v[132:135], a[100:103], v[40:43]
  ds_read_b64_tr_b16 a[46:47], v4 offset:28672
  v_mfma_f32_16x16x32_bf16 v[44:47], v[136:139], a[100:103], v[44:47]
  ds_read_b64_tr_b16 a[36:37], v52 offset:12800
  buffer_load_dwordx4 v49, s[28:31], s59 offen offset:0 lds
  v_mfma_f32_16x16x32_bf16 v[72:75], v[136:139], a[72:75], v[72:75]
  ds_read_b64_tr_b16 a[38:39], v51 offset:29184
  v_mfma_f32_16x16x32_bf16 v[76:79], v[132:135], a[72:75], v[76:79]
  ds_read_b64_tr_b16 a[92:93], v3 offset:12800
  v_mfma_f32_16x16x32_bf16 v[84:87], v[132:135], a[116:119], v[84:87]
  ds_read_b64_tr_b16 a[94:95], v4 offset:29184
  buffer_load_dwordx4 v50, s[28:31], s59 offen offset:1024 lds
  v_mfma_f32_16x16x32_bf16 v[88:91], v[136:139], a[116:119], v[88:91]
  ds_read_b64_tr_b16 a[104:105], v52 offset:53248
  v_mfma_f32_16x16x32_bf16 v[92:95], v[136:139], a[60:63], v[92:95]
  ds_read_b64_tr_b16 a[106:107], v2 offset:4096
  v_mfma_f32_16x16x32_bf16 v[96:99], v[132:135], a[60:63], v[96:99]
  s_waitcnt lgkmcnt(10)
  ds_read_b64_tr_b16 a[100:101], v3 offset:53248
  buffer_load_dwordx4 v56, s[28:31], s59 offen offset:2048 lds
  v_mfma_f32_16x16x32_bf16 v[100:103], v[132:135], a[112:115], v[100:103]
  ds_read_b64_tr_b16 a[102:103], v6 offset:4096
  v_mfma_f32_16x16x32_bf16 v[32:35], v[136:139], a[112:115], v[32:35]
  ds_read_b64_tr_b16 a[72:73], v52 offset:53760
  v_mfma_f32_16x16x32_bf16 v[104:107], v[136:139], a[124:127], v[104:107]
  ds_read_b64_tr_b16 a[74:75], v2 offset:4608
  buffer_load_dwordx4 v57, s[28:31], s59 offen offset:3072 lds
  v_mfma_f32_16x16x32_bf16 v[108:111], v[132:135], a[124:127], v[108:111]
  s_add_u32 m0, s0, 0x4000
  s_add_u32 s1, s55, 0x24000
  ds_read_b64_tr_b16 a[60:61], v3 offset:53760
  v_mfma_f32_16x16x32_bf16 v[112:115], v[132:135], a[136:139], v[112:115]
  ds_read_b64_tr_b16 a[62:63], v6 offset:4608
  v_mfma_f32_16x16x32_bf16 v[116:119], v[136:139], a[136:139], v[116:119]
  ds_read_b64_tr_b16 a[112:113], v52 offset:14336
  v_mfma_f32_16x16x32_bf16 v[36:39], v[136:139], a[140:143], v[36:39]
  ds_read_b64_tr_b16 a[114:115], v51 offset:30720
  v_mfma_f32_16x16x32_bf16 v[80:83], v[132:135], a[140:143], v[80:83]
  s_waitcnt lgkmcnt(10)
  ds_read_b64_tr_b16 a[116:117], v3 offset:14336
  v_mfma_f32_16x16x32_bf16 v[40:43], v[68:71], a[148:151], v[40:43]
  ds_read_b64_tr_b16 a[118:119], v4 offset:30720
  v_mfma_f32_16x16x32_bf16 v[44:47], v[140:143], a[148:151], v[44:47]
  ds_read_b64_tr_b16 a[124:125], v52 offset:14848
  v_mfma_f32_16x16x32_bf16 v[72:75], v[140:143], a[44:47], v[72:75]
  ds_read_b64_tr_b16 a[126:127], v51 offset:31232
  v_mfma_f32_16x16x32_bf16 v[76:79], v[68:71], a[44:47], v[76:79]
  ds_read_b64_tr_b16 a[132:133], v3 offset:14848
  v_mfma_f32_16x16x32_bf16 v[84:87], v[68:71], a[36:39], v[84:87]
  ds_read_b64_tr_b16 a[134:135], v4 offset:31232
  v_and_b32 v0, 16, v62
  v_mfma_f32_16x16x32_bf16 v[88:91], v[140:143], a[36:39], v[88:91]
  ds_read_b64_tr_b16 a[136:137], v52 offset:55296
  v_mov_b32 v55, 0x3f80
  v_mfma_f32_16x16x32_bf16 v[92:95], v[140:143], a[92:95], v[92:95]
  ds_read_b64_tr_b16 a[138:139], v2 offset:6144
  v_lshlrev_b32 v0, v0, v55
  v_mfma_f32_16x16x32_bf16 v[96:99], v[68:71], a[92:95], v[96:99]
  s_waitcnt lgkmcnt(10)
  ds_read_b64_tr_b16 a[44:45], v3 offset:55296
  v_lshrrev_b32 v55, 1, v60
  v_mfma_f32_16x16x32_bf16 v[100:103], v[68:71], a[104:107], v[100:103]
  ds_read_b64_tr_b16 a[46:47], v6 offset:6144
  v_and_b32 v60, 4, v48
  v_mfma_f32_16x16x32_bf16 v[32:35], v[140:143], a[104:107], v[32:35]
  ds_read_b64_tr_b16 a[36:37], v52 offset:55808
  v_add_u32 v55, v60, v55
  v_mfma_f32_16x16x32_bf16 v[104:107], v[140:143], a[100:103], v[104:107]
  ds_read_b64_tr_b16 a[38:39], v2 offset:6656
  v_cmp_eq_u32 s[10:11], 0, v55
  v_mfma_f32_16x16x32_bf16 v[108:111], v[68:71], a[100:103], v[108:111]
  ds_read_b64_tr_b16 a[92:93], v3 offset:55808
  v_cmp_eq_u32 s[42:43], 1, v55
  v_mfma_f32_16x16x32_bf16 v[112:115], v[68:71], a[72:75], v[112:115]
  ds_read_b64_tr_b16 a[94:95], v6 offset:6656
  v_cmp_eq_u32 s[52:53], 2, v55
  v_mfma_f32_16x16x32_bf16 v[116:119], v[140:143], a[72:75], v[116:119]
  ds_read_b64_tr_b16 a[104:105], v52 offset:28672
  v_cndmask_b32 v24, 0, v0, s[10:11]
  v_mfma_f32_16x16x32_bf16 v[36:39], v[140:143], a[60:63], v[36:39]
  ds_read_b64_tr_b16 a[106:107], v51 offset:45056
  v_cmp_eq_u32 s[10:11], 3, v55
  v_mfma_f32_16x16x32_bf16 v[80:83], v[68:71], a[60:63], v[80:83]
  s_waitcnt lgkmcnt(10)
  ds_read_b64_tr_b16 a[100:101], v3 offset:28672
  v_cndmask_b32 v25, 0, v0, s[42:43]
  v_mfma_f32_16x16x32_bf16 v[40:43], v[128:131], a[112:115], v[40:43]
  s_waitcnt vmcnt(10)
  ds_read_b64_tr_b16 a[102:103], v4 offset:45056
  v_cmp_gt_i32 vcc, 3, v63
  v_mfma_f32_16x16x32_bf16 v[44:47], v[148:151], a[112:115], v[44:47]
  s_cbranch_vccnz L_rf3
L_bf3:
  ds_read_b64_tr_b16 a[72:73], v52 offset:29184
  buffer_load_dwordx4 v49, s[28:31], s1 offen offset:0 lds
  v_mfma_f32_16x16x32_bf16 v[72:75], v[148:151], a[116:119], v[72:75]
  ds_read_b64_tr_b16 a[74:75], v51 offset:45568
  v_cndmask_b32 v26, 0, v0, s[52:53]
  v_mfma_f32_16x16x32_bf16 v[76:79], v[128:131], a[116:119], v[76:79]
  ds_read_b64_tr_b16 a[60:61], v3 offset:29184
  buffer_load_dwordx4 a[140:143], v1, s[36:39], s54 offen offset:0 sc1
  v_mfma_f32_16x16x32_bf16 v[84:87], v[128:131], a[124:127], v[84:87]
  ds_read_b64_tr_b16 a[62:63], v4 offset:45568
  v_cndmask_b32 v27, 0, v0, s[10:11]
  v_mfma_f32_16x16x32_bf16 v[88:91], v[148:151], a[124:127], v[88:91]
  ds_read_b64_tr_b16 a[112:113], v51 offset:4096
  v_lshrrev_b32 v7, 3, v48
  v_mfma_f32_16x16x32_bf16 v[92:95], v[148:151], a[132:135], v[92:95]
  ds_read_b64_tr_b16 a[114:115], v2 offset:20480
  buffer_load_dwordx4 v50, s[28:31], s1 offen offset:1024 lds
  v_mfma_f32_16x16x32_bf16 v[96:99], v[128:131], a[132:135], v[96:99]
  s_waitcnt lgkmcnt(10)
  ds_read_b64_tr_b16 a[116:117], v4 offset:4096
  v_xor_b32 v7, v7, v5
  v_mfma_f32_16x16x32_bf16 v[100:103], v[128:131], a[136:139], v[100:103]
  ds_read_b64_tr_b16 a[118:119], v6 offset:20480
  v_bfe_u32 v48, v48, 1, 2
  v_mfma_f32_16x16x32_bf16 v[32:35], v[148:151], a[136:139], v[32:35]
  ds_read_b64_tr_b16 a[124:125], v51 offset:4608
  v_lshl_add_u32 v48, v7, 1, v48
  v_mfma_f32_16x16x32_bf16 v[104:107], v[148:151], a[44:47], v[104:107]
  ds_read_b64_tr_b16 a[126:127], v2 offset:20992
  v_and_b32 v7, 1, v7
  v_mfma_f32_16x16x32_bf16 v[108:111], v[128:131], a[44:47], v[108:111]
  ds_read_b64_tr_b16 a[132:133], v4 offset:4608
  buffer_load_dwordx4 v56, s[28:31], s1 offen offset:2048 lds
  v_mfma_f32_16x16x32_bf16 v[112:115], v[128:131], a[36:39], v[112:115]
  ds_read_b64_tr_b16 a[134:135], v6 offset:20992
  v_lshl_add_u32 v7, v7, 4, v48
  v_mfma_f32_16x16x32_bf16 v[116:119], v[148:151], a[36:39], v[116:119]
  ds_read_b64_tr_b16 a[136:137], v52 offset:30720
  v_cmp_eq_u32 s[10:11], 0, v7
  v_mfma_f32_16x16x32_bf16 v[36:39], v[148:151], a[92:95], v[36:39]
  ds_read_b64_tr_b16 a[138:139], v51 offset:47104
  v_cmp_eq_u32 s[58:59], 1, v7
  v_mfma_f32_16x16x32_bf16 v[80:83], v[128:131], a[92:95], v[80:83]
  s_waitcnt lgkmcnt(10)
  ds_read_b64_tr_b16 a[44:45], v3 offset:30720
  buffer_load_dwordx4 v57, s[28:31], s1 offen offset:3072 lds
  v_mfma_f32_16x16x32_bf16 v[40:43], v[160:163], a[104:107], v[40:43]
  s_add_u32 m0, s0, 0x6000
  s_add_u32 s1, s76, 0x24000
  ds_read_b64_tr_b16 a[46:47], v4 offset:47104
  v_mfma_f32_16x16x32_bf16 v[44:47], v[164:167], a[104:107], v[44:47]
  ds_read_b64_tr_b16 a[36:37], v52 offset:31232
  v_cmp_eq_u32 s[42:43], 2, v7
  v_mfma_f32_16x16x32_bf16 v[72:75], v[164:167], a[100:103], v[72:75]
  ds_read_b64_tr_b16 a[38:39], v51 offset:47616
  v_cndmask_b32 v28, 0, v0, s[10:11]
  v_mfma_f32_16x16x32_bf16 v[76:79], v[160:163], a[100:103], v[76:79]
  ds_read_b64_tr_b16 a[92:93], v3 offset:31232
  buffer_load_dwordx4 a[148:151], v1, s[36:39], s54 offen offset:1024 sc1
  v_mfma_f32_16x16x32_bf16 v[84:87], v[160:163], a[72:75], v[84:87]
  ds_read_b64_tr_b16 a[94:95], v4 offset:47616
  v_cmp_eq_u32 s[10:11], 3, v7
  v_mfma_f32_16x16x32_bf16 v[88:91], v[164:167], a[72:75], v[88:91]
  ds_read_b64_tr_b16 a[104:105], v51 offset:6144
  v_cndmask_b32 v29, 0, v0, s[58:59]
  v_mfma_f32_16x16x32_bf16 v[92:95], v[164:167], a[60:63], v[92:95]
  ds_read_b64_tr_b16 a[106:107], v2 offset:22528
  v_cmp_eq_u32 s[58:59], 4, v7
  v_mfma_f32_16x16x32_bf16 v[96:99], v[160:163], a[60:63], v[96:99]
  s_waitcnt lgkmcnt(10)
  ds_read_b64_tr_b16 a[100:101], v4 offset:6144
  buffer_load_dwordx4 v49, s[28:31], s1 offen offset:0 lds
  v_mfma_f32_16x16x32_bf16 v[100:103], v[160:163], a[112:115], v[100:103]
  ds_read_b64_tr_b16 a[102:103], v6 offset:22528
  v_cndmask_b32 v30, 0, v0, s[42:43]
  v_mfma_f32_16x16x32_bf16 v[32:35], v[164:167], a[112:115], v[32:35]
  ds_read_b64_tr_b16 a[72:73], v51 offset:6656
  v_cmp_eq_u32 s[42:43], 5, v7
  v_mfma_f32_16x16x32_bf16 v[104:107], v[164:167], a[116:119], v[104:107]
  ds_read_b64_tr_b16 a[74:75], v2 offset:23040
  v_cndmask_b32 v31, 0, v0, s[10:11]
  v_mfma_f32_16x16x32_bf16 v[108:111], v[160:163], a[116:119], v[108:111]
  ds_read_b64_tr_b16 a[60:61], v4 offset:6656
  v_cmp_eq_u32 s[10:11], 6, v7
  v_mfma_f32_16x16x32_bf16 v[112:115], v[160:163], a[124:127], v[112:115]
  ds_read_b64_tr_b16 a[62:63], v6 offset:23040
  buffer_load_dwordx4 v50, s[28:31], s1 offen offset:1024 lds
  v_mfma_f32_16x16x32_bf16 v[116:119], v[164:167], a[124:127], v[116:119]
  v_cndmask_b32 v68, 0, v0, s[58:59]
  v_cmp_eq_u32 s[58:59], 7, v7
  v_mfma_f32_16x16x32_bf16 v[36:39], v[164:167], a[132:135], v[36:39]
  v_cndmask_b32 v69, 0, v0, s[42:43]
  v_cndmask_b32 v70, 0, v0, s[10:11]
  v_mfma_f32_16x16x32_bf16 v[80:83], v[160:163], a[132:135], v[80:83]
  s_waitcnt lgkmcnt(8)
  v_cndmask_b32 v71, 0, v0, s[58:59]
  v_xor_b32 v7, v54, v5
  v_mfma_f32_16x16x32_bf16 v[40:43], v[172:175], a[136:139], v[40:43]
  v_lshrrev_b32 v48, 1, v61
  v_lshl_add_u32 v7, v7, 1, v48
  v_mfma_f32_16x16x32_bf16 v[44:47], v[176:179], a[136:139], v[44:47]
  s_waitcnt vmcnt(8) lgkmcnt(0)
  s_barrier
  v_mfma_f32_16x16x32_bf16 v[72:75], v[176:179], a[44:47], v[72:75]
  ds_read_b64_tr_b16 a[112:113], v52 offset:4096
  v_mov_b32 v128, 0
  v_mfma_f32_16x16x32_bf16 v[76:79], v[172:175], a[44:47], v[76:79]
  ds_read_b64_tr_b16 a[114:115], v51 offset:20480
  buffer_load_dwordx4 a[116:119], v1, s[36:39], s54 offen offset:2048 sc1
  v_mfma_f32_16x16x32_bf16 v[84:87], v[172:175], a[36:39], v[84:87]
  ds_read_b64_tr_b16 a[124:125], v3 offset:4096
  v_mov_b32 v129, 0
  v_mfma_f32_16x16x32_bf16 v[88:91], v[176:179], a[36:39], v[88:91]
  ds_read_b64_tr_b16 a[126:127], v4 offset:20480
  v_mov_b32 v132, 0
  v_mfma_f32_16x16x32_bf16 v[92:95], v[176:179], a[92:95], v[92:95]
  ds_read_b64_tr_b16 a[132:133], v52 offset:45056
  v_mov_b32 v133, 0
  v_mfma_f32_16x16x32_bf16 v[96:99], v[172:175], a[92:95], v[96:99]
  ds_read_b64_tr_b16 a[134:135], v51 offset:61440
  buffer_load_dwordx4 v56, s[28:31], s1 offen offset:2048 lds
  v_mfma_f32_16x16x32_bf16 v[100:103], v[172:175], a[104:107], v[100:103]
  ds_read_b64_tr_b16 a[44:45], v3 offset:45056
  v_cmp_eq_u32 s[10:11], 0, v7
  v_mfma_f32_16x16x32_bf16 v[32:35], v[176:179], a[104:107], v[32:35]
  ds_read_b64_tr_b16 a[46:47], v4 offset:61440
  v_cmp_eq_u32 s[58:59], 1, v7
  v_mfma_f32_16x16x32_bf16 v[104:107], v[176:179], a[100:103], v[104:107]
  ds_read_b64_tr_b16 a[36:37], v52 offset:6144
  buffer_load_dwordx4 v57, s[28:31], s1 offen offset:3072 lds
  v_mfma_f32_16x16x32_bf16 v[108:111], v[172:175], a[100:103], v[108:111]
  s_add_u32 m0, s0, 0x2000
  s_add_u32 s1, s57, 0x24000
  ds_read_b64_tr_b16 a[38:39], v51 offset:22528
  v_mfma_f32_16x16x32_bf16 v[112:115], v[172:175], a[72:75], v[112:115]
  ds_read_b64_tr_b16 a[92:93], v3 offset:6144
  v_cndmask_b32 v130, 0, v0, s[10:11]
  v_mfma_f32_16x16x32_bf16 v[116:119], v[176:179], a[72:75], v[116:119]
  ds_read_b64_tr_b16 a[94:95], v4 offset:22528
  buffer_load_dwordx4 v49, s[28:31], s1 offen offset:0 lds
  v_mfma_f32_16x16x32_bf16 v[36:39], v[176:179], a[60:63], v[36:39]
  ds_read_b64_tr_b16 a[104:105], v52 offset:47104
  v_cndmask_b32 v131, 0, v0, s[58:59]
  v_mfma_f32_16x16x32_bf16 v[80:83], v[172:175], a[60:63], v[80:83]
  s_waitcnt lgkmcnt(5)
  ds_read_b64_tr_b16 a[106:107], v51 offset:63488
  v_add_u32 v0, s0, v62
  v_mfma_f32_16x16x32_bf16 v[40:43], a[24:27], a[112:115], v[40:43]
  ds_read_b64_tr_b16 a[100:101], v3 offset:47104
  buffer_load_dwordx4 v50, s[28:31], s1 offen offset:1024 lds
  v_mfma_f32_16x16x32_bf16 v[44:47], a[20:23], a[112:115], v[44:47]
  ds_read_b64_tr_b16 a[102:103], v4 offset:63488
  v_mfma_f32_16x16x32_bf16 v[72:75], a[20:23], a[124:127], v[72:75]
  ds_read_b64_tr_b16 a[72:73], v52 offset:20480
  v_mfma_f32_16x16x32_bf16 v[76:79], a[24:27], a[124:127], v[76:79]
  ds_read_b64_tr_b16 a[74:75], v51 offset:36864
  buffer_load_dwordx4 a[60:63], v1, s[36:39], s54 offen offset:3072 sc1
  v_mfma_f32_16x16x32_bf16 v[40:43], a[40:43], a[132:135], v[40:43]
  ds_read_b64_tr_b16 a[136:137], v3 offset:20480
  v_mfma_f32_16x16x32_bf16 v[44:47], a[52:55], a[132:135], v[44:47]
  ds_read_b64_tr_b16 a[138:139], v4 offset:36864
  buffer_load_dwordx4 v56, s[28:31], s1 offen offset:2048 lds
  v_mfma_f32_16x16x32_bf16 v[72:75], a[52:55], a[44:47], v[72:75]
  ds_read_b64_tr_b16 a[112:113], v52 offset:61440
  v_mfma_f32_16x16x32_bf16 v[76:79], a[40:43], a[44:47], v[76:79]
  s_waitcnt lgkmcnt(5)
  ds_read_b64_tr_b16 a[114:115], v2 offset:12288
  v_mfma_f32_16x16x32_bf16 v[40:43], a[4:7], a[36:39], v[40:43]
  ds_read_b64_tr_b16 a[124:125], v3 offset:61440
  buffer_load_dwordx4 v57, s[28:31], s1 offen offset:3072 lds
  v_mfma_f32_16x16x32_bf16 v[44:47], a[56:59], a[36:39], v[44:47]
  ds_read_b64_tr_b16 a[126:127], v6 offset:12288
  v_mfma_f32_16x16x32_bf16 v[72:75], a[56:59], a[92:95], v[72:75]
  ds_read_b64_tr_b16 a[132:133], v52 offset:22528
  v_mfma_f32_16x16x32_bf16 v[76:79], a[4:7], a[92:95], v[76:79]
  ds_read_b64_tr_b16 a[134:135], v51 offset:38912
  v_mfma_f32_16x16x32_bf16 v[40:43], a[64:67], a[104:107], v[40:43]
  ds_read_b64_tr_b16 a[44:45], v3 offset:22528
  v_mfma_f32_16x16x32_bf16 v[44:47], a[68:71], a[104:107], v[44:47]
  ds_read_b64_tr_b16 a[46:47], v4 offset:38912
  v_mfma_f32_16x16x32_bf16 v[72:75], a[68:71], a[100:103], v[72:75]
  ds_read_b64_tr_b16 a[152:153], v52 offset:63488
  v_mfma_f32_16x16x32_bf16 v[76:79], a[64:67], a[100:103], v[76:79]
  s_waitcnt lgkmcnt(5)
  ds_read_b64_tr_b16 a[154:155], v2 offset:14336
  v_mfma_f32_16x16x32_bf16 v[40:43], a[12:15], a[72:75], v[40:43]
  ds_read_b64_tr_b16 a[36:37], v3 offset:63488
  v_mfma_f32_16x16x32_bf16 v[44:47], a[16:19], a[72:75], v[44:47]
  ds_read_b64_tr_b16 a[38:39], v6 offset:14336
  v_mfma_f32_16x16x32_bf16 v[72:75], a[16:19], a[136:139], v[72:75]
  ds_read_b64_tr_b16 a[92:93], v52 offset:0
  v_mfma_f32_16x16x32_bf16 v[76:79], a[12:15], a[136:139], v[76:79]
  ds_read_b64_tr_b16 a[94:95], v51 offset:16384
  buffer_load_dwordx4 a[104:107], v1, s[36:39], s8 offen offset:0 sc1
  v_mfma_f32_16x16x32_bf16 v[40:43], a[48:51], a[112:115], v[40:43]
  ds_read_b64_tr_b16 a[100:101], v3 offset:0
  v_mfma_f32_16x16x32_bf16 v[44:47], a[28:31], a[112:115], v[44:47]
  ds_read_b64_tr_b16 a[102:103], v4 offset:16384
  v_mfma_f32_16x16x32_bf16 v[72:75], a[28:31], a[124:127], v[72:75]
  ds_read_b64_tr_b16 a[72:73], v52 offset:40960
  v_mfma_f32_16x16x32_bf16 v[76:79], a[48:51], a[124:127], v[76:79]
  s_waitcnt lgkmcnt(5)
  ds_read_b64_tr_b16 a[74:75], v51 offset:57344
  v_mfma_f32_16x16x32_bf16 v[40:43], a[0:3], a[132:135], v[40:43]
  ds_read_b64_tr_b16 a[136:137], v3 offset:40960
  v_mfma_f32_16x16x32_bf16 v[44:47], a[32:35], a[132:135], v[44:47]
  ds_read_b64_tr_b16 a[138:139], v4 offset:57344
  v_mfma_f32_16x16x32_bf16 v[72:75], a[32:35], a[44:47], v[72:75]
  ds_read_b64_tr_b16 a[112:113], v52 offset:2048
  v_mfma_f32_16x16x32_bf16 v[76:79], a[0:3], a[44:47], v[76:79]
  ds_read_b64_tr_b16 a[114:115], v51 offset:18432
  v_mfma_f32_16x16x32_bf16 v[40:43], a[76:79], a[152:155], v[40:43]
  ds_read_b64_tr_b16 a[124:125], v3 offset:2048
  v_mfma_f32_16x16x32_bf16 v[44:47], a[8:11], a[152:155], v[44:47]
  ds_read_b64_tr_b16 a[126:127], v4 offset:18432
  v_mfma_f32_16x16x32_bf16 v[72:75], a[8:11], a[36:39], v[72:75]
  ds_read_b64_tr_b16 a[156:157], v52 offset:43008
  v_mfma_f32_16x16x32_bf16 v[76:79], a[76:79], a[36:39], v[76:79]
  s_waitcnt lgkmcnt(5)
  ds_read_b64_tr_b16 a[158:159], v51 offset:59392
  v_mfma_f32_16x16x32_bf16 v[40:43], a[84:87], a[92:95], v[40:43]
  ds_read_b64_tr_b16 a[44:45], v3 offset:43008
  v_mfma_f32_16x16x32_bf16 v[44:47], a[88:91], a[92:95], v[44:47]
  ds_read_b64_tr_b16 a[46:47], v4 offset:59392
  v_mfma_f32_16x16x32_bf16 v[72:75], a[88:91], a[100:103], v[72:75]
  ds_read_b64_tr_b16 a[132:133], v52 offset:4608
  v_mfma_f32_16x16x32_bf16 v[76:79], a[84:87], a[100:103], v[76:79]
  ds_read_b64_tr_b16 a[134:135], v51 offset:20992
  v_mfma_f32_16x16x32_bf16 v[40:43], a[96:99], a[72:75], v[40:43]
  ds_read_b64_tr_b16 a[36:37], v3 offset:4608
  v_mfma_f32_16x16x32_bf16 v[44:47], a[108:111], a[72:75], v[44:47]
  ds_read_b64_tr_b16 a[38:39], v4 offset:20992
  v_mfma_f32_16x16x32_bf16 v[72:75], a[108:111], a[136:139], v[72:75]
  ds_read_b64_tr_b16 a[152:153], v52 offset:45568
  v_mfma_f32_16x16x32_bf16 v[76:79], a[96:99], a[136:139], v[76:79]
  s_waitcnt lgkmcnt(5)
  ds_read_b64_tr_b16 a[154:155], v51 offset:61952
  v_mfma_f32_16x16x32_bf16 v[40:43], a[120:123], a[112:115], v[40:43]
  ds_read_b64_tr_b16 a[92:93], v3 offset:45568
  v_mfma_f32_16x16x32_bf16 v[44:47], a[128:131], a[112:115], v[44:47]
  ds_read_b64_tr_b16 a[94:95], v4 offset:61952
  v_mfma_f32_16x16x32_bf16 v[72:75], a[128:131], a[124:127], v[72:75]
  ds_read_b64_tr_b16 a[72:73], v52 offset:6656
  v_mfma_f32_16x16x32_bf16 v[76:79], a[120:123], a[124:127], v[76:79]
  ds_read_b64_tr_b16 a[74:75], v51 offset:23040
  v_mfma_f32_16x16x32_bf16 v[40:43], a[144:147], a[156:159], v[40:43]
  ds_read_b64_tr_b16 a[100:101], v3 offset:6656
  v_mfma_f32_16x16x32_bf16 v[44:47], a[80:83], a[156:159], v[44:47]
  ds_read_b64_tr_b16 a[102:103], v4 offset:23040
  v_mfma_f32_16x16x32_bf16 v[72:75], a[80:83], a[44:47], v[72:75]
  ds_read_b64_tr_b16 a[136:137], v52 offset:47616
  v_mfma_f32_16x16x32_bf16 v[76:79], a[144:147], a[44:47], v[76:79]
  s_waitcnt lgkmcnt(5)
  ds_read_b64_tr_b16 a[138:139], v51 offset:64000
  v_mfma_f32_16x16x32_bf16 v[84:87], a[24:27], a[132:135], v[84:87]
  ds_read_b64_tr_b16 a[112:113], v3 offset:47616
  v_cvt_pk_bf16_f32 v56, v40, v41
  v_mfma_f32_16x16x32_bf16 v[88:91], a[20:23], a[132:135], v[88:91]
  ds_read_b64_tr_b16 a[114:115], v4 offset:64000
  v_cvt_pk_bf16_f32 v57, v42, v43
  v_mfma_f32_16x16x32_bf16 v[92:95], a[20:23], a[36:39], v[92:95]
  ds_read_b64_tr_b16 a[124:125], v52 offset:20992
  v_cvt_pk_bf16_f32 v58, v44, v45
  v_mfma_f32_16x16x32_bf16 v[96:99], a[24:27], a[36:39], v[96:99]
  ds_read_b64_tr_b16 a[126:127], v51 offset:37376
  v_cvt_pk_bf16_f32 v59, v46, v47
  v_mfma_f32_16x16x32_bf16 v[84:87], a[40:43], a[152:155], v[84:87]
  ds_read_b64_tr_b16 a[44:45], v3 offset:20992
  v_cvt_pk_bf16_f32 v136, v76, v77
  v_mfma_f32_16x16x32_bf16 v[88:91], a[52:55], a[152:155], v[88:91]
  ds_read_b64_tr_b16 a[46:47], v4 offset:37376
  buffer_store_dwordx4 v[56:59], v62, s[36:39], s64 offen offset:2048 sc1
  v_mfma_f32_16x16x32_bf16 v[92:95], a[52:55], a[92:95], v[92:95]
  ds_read_b64_tr_b16 a[132:133], v52 offset:61952
  v_cvt_pk_bf16_f32 v137, v78, v79
  v_mfma_f32_16x16x32_bf16 v[96:99], a[40:43], a[92:95], v[96:99]
  s_waitcnt lgkmcnt(5)
  ds_read_b64_tr_b16 a[134:135], v2 offset:12800
  v_cvt_pk_bf16_f32 v138, v72, v73
  v_mfma_f32_16x16x32_bf16 v[84:87], a[4:7], a[72:75], v[84:87]
  ds_read_b64_tr_b16 a[36:37], v3 offset:61952
  v_cvt_pk_bf16_f32 v139, v74, v75
  v_mfma_f32_16x16x32_bf16 v[88:91], a[56:59], a[72:75], v[88:91]
  ds_read_b64_tr_b16 a[38:39], v6 offset:12800
  v_mfma_f32_16x16x32_bf16 v[92:95], a[56:59], a[100:103], v[92:95]
  ds_read_b64_tr_b16 a[152:153], v52 offset:23040
  buffer_store_dwordx4 v[136:139], v62, s[36:39], s64 offen offset:3072 sc1
  v_mfma_f32_16x16x32_bf16 v[96:99], a[4:7], a[100:103], v[96:99]
  ds_read_b64_tr_b16 a[154:155], v51 offset:39424
  v_mfma_f32_16x16x32_bf16 v[84:87], a[64:67], a[136:139], v[84:87]
  ds_read_b64_tr_b16 a[92:93], v3 offset:23040
  v_mfma_f32_16x16x32_bf16 v[88:91], a[68:71], a[136:139], v[88:91]
  ds_read_b64_tr_b16 a[94:95], v4 offset:39424
  v_mfma_f32_16x16x32_bf16 v[92:95], a[68:71], a[112:115], v[92:95]
  ds_read_b64_tr_b16 a[72:73], v52 offset:64000
  v_mfma_f32_16x16x32_bf16 v[96:99], a[64:67], a[112:115], v[96:99]
  s_waitcnt lgkmcnt(5)
  ds_read_b64_tr_b16 a[74:75], v2 offset:14848
  v_mfma_f32_16x16x32_bf16 v[84:87], a[12:15], a[124:127], v[84:87]
  ds_read_b64_tr_b16 a[100:101], v3 offset:64000
  v_mfma_f32_16x16x32_bf16 v[88:91], a[16:19], a[124:127], v[88:91]
  ds_read_b64_tr_b16 a[102:103], v6 offset:14848
  v_mfma_f32_16x16x32_bf16 v[92:95], a[16:19], a[44:47], v[92:95]
  ds_read_b64_tr_b16 a[136:137], v52 offset:512
  v_mfma_f32_16x16x32_bf16 v[96:99], a[12:15], a[44:47], v[96:99]
  ds_read_b64_tr_b16 a[138:139], v51 offset:16896
  v_mfma_f32_16x16x32_bf16 v[84:87], a[48:51], a[132:135], v[84:87]
  ds_read_b64_tr_b16 a[112:113], v3 offset:512
  v_mfma_f32_16x16x32_bf16 v[88:91], a[28:31], a[132:135], v[88:91]
  ds_read_b64_tr_b16 a[114:115], v4 offset:16896
  v_mfma_f32_16x16x32_bf16 v[92:95], a[28:31], a[36:39], v[92:95]
  ds_read_b64_tr_b16 a[156:157], v52 offset:41472
  v_mfma_f32_16x16x32_bf16 v[96:99], a[48:51], a[36:39], v[96:99]
  s_waitcnt lgkmcnt(5)
  ds_read_b64_tr_b16 a[158:159], v51 offset:57856
  v_mfma_f32_16x16x32_bf16 v[84:87], a[0:3], a[152:155], v[84:87]
  ds_read_b64_tr_b16 a[44:45], v3 offset:41472
  v_mfma_f32_16x16x32_bf16 v[88:91], a[32:35], a[152:155], v[88:91]
  ds_read_b64_tr_b16 a[46:47], v4 offset:57856
  v_mfma_f32_16x16x32_bf16 v[92:95], a[32:35], a[92:95], v[92:95]
  ds_read_b64_tr_b16 a[124:125], v52 offset:2560
  v_mfma_f32_16x16x32_bf16 v[96:99], a[0:3], a[92:95], v[96:99]
  ds_read_b64_tr_b16 a[126:127], v51 offset:18944
  v_mfma_f32_16x16x32_bf16 v[84:87], a[76:79], a[72:75], v[84:87]
  ds_read_b64_tr_b16 a[36:37], v3 offset:2560
  v_mfma_f32_16x16x32_bf16 v[88:91], a[8:11], a[72:75], v[88:91]
  ds_read_b64_tr_b16 a[38:39], v4 offset:18944
  v_mfma_f32_16x16x32_bf16 v[92:95], a[8:11], a[100:103], v[92:95]
  ds_read_b64_tr_b16 a[132:133], v52 offset:43520
  v_mfma_f32_16x16x32_bf16 v[96:99], a[76:79], a[100:103], v[96:99]
  s_waitcnt lgkmcnt(5)
  ds_read_b64_tr_b16 a[134:135], v51 offset:59904
  v_mfma_f32_16x16x32_bf16 v[84:87], a[84:87], a[136:139], v[84:87]
  ds_read_b64_tr_b16 a[92:93], v3 offset:43520
  v_mfma_f32_16x16x32_bf16 v[88:91], a[88:91], a[136:139], v[88:91]
  ds_read_b64_tr_b16 a[94:95], v4 offset:59904
  v_mfma_f32_16x16x32_bf16 v[92:95], a[88:91], a[112:115], v[92:95]
  ds_read_b128 v[40:43], v0 offset:33792
  v_mfma_f32_16x16x32_bf16 v[96:99], a[84:87], a[112:115], v[96:99]
  ds_read_b128 v[44:47], v0 offset:34816
  v_mfma_f32_16x16x32_bf16 v[84:87], a[96:99], a[156:159], v[84:87]
  ds_read_b128 v[56:59], v0 offset:35840
  v_lshrrev_b32 v7, 1, v5
  v_mfma_f32_16x16x32_bf16 v[88:91], a[108:111], a[156:159], v[88:91]
  s_lshl_b32 s45, s3, 2
  v_lshl_add_u32 v155, v7, 4, s45
  s_lshl_b32 s64, s46, 2
  v_mfma_f32_16x16x32_bf16 v[92:95], a[108:111], a[44:47], v[92:95]
  v_lshl_add_u32 v5, v5, 6, s64
  v_add_u32 v0, 0xa000, v155
  v_mfma_f32_16x16x32_bf16 v[96:99], a[96:99], a[44:47], v[96:99]
  s_waitcnt lgkmcnt(3)
  v_add_u32 v1, 0xa000, v5
  v_mfma_f32_16x16x32_bf16 v[84:87], a[120:123], a[124:127], v[84:87]
  ds_read_b128 v[72:75], v5 offset:40448
  v_mfma_f32_16x16x32_bf16 v[88:91], a[128:131], a[124:127], v[88:91]
  ds_read_b128 v[76:79], v1 offset:40448
  v_mfma_f32_16x16x32_bf16 v[92:95], a[128:131], a[36:39], v[92:95]
  ds_read_b128 v[136:139], v5 offset:40464
  v_mfma_f32_16x16x32_bf16 v[96:99], a[120:123], a[36:39], v[96:99]
  s_waitcnt vmcnt(3)
  s_barrier
  v_mfma_f32_16x16x32_bf16 v[84:87], a[144:147], a[132:135], v[84:87]
  ds_read_b64_tr_b16 a[44:45], v52 offset:16384
  v_mfma_f32_16x16x32_bf16 v[88:91], a[80:83], a[132:135], v[88:91]
  ds_read_b64_tr_b16 a[46:47], v51 offset:32768
  v_mfma_f32_16x16x32_bf16 v[92:95], a[80:83], a[92:95], v[92:95]
  ds_read_b64_tr_b16 a[72:73], v52 offset:57344
  buffer_load_dwordx4 v[140:143], v62, s[36:39], s67 offen offset:2048 sc1
  v_mfma_f32_16x16x32_bf16 v[96:99], a[144:147], a[92:95], v[96:99]
  ds_read_b64_tr_b16 a[74:75], v2 offset:8192
  v_mfma_f32_16x16x32_bf16 v[148:151], v[24:27], a[140:143], 0
  s_waitcnt lgkmcnt(9)
  ds_read_b64_tr_b16 a[36:37], v52 offset:18432
  buffer_load_dwordx4 v[160:163], v62, s[36:39], s67 offen offset:3072 sc1
  v_mfma_f32_16x16x32_bf16 v[164:167], v[40:43], v[28:31], 0
  ds_read_b64_tr_b16 a[38:39], v51 offset:34816
  v_cvt_pk_bf16_f32 v172, v84, v85
  v_mfma_f32_16x16x32_bf16 v[148:151], v[24:27], a[148:151], v[148:151]
  s_waitcnt lgkmcnt(10)
  ds_read_b64_tr_b16 a[100:101], v52 offset:59392
  v_cvt_pk_bf16_f32 v173, v86, v87
  v_mfma_f32_16x16x32_bf16 v[176:179], v[44:47], v[28:31], 0
  ds_read_b64_tr_b16 a[102:103], v2 offset:10240
  v_cvt_pk_bf16_f32 v174, v88, v89
  v_mfma_f32_16x16x32_bf16 v[148:151], v[24:27], a[116:119], v[148:151]
  ds_read_b64_tr_b16 a[92:93], v52 offset:24576
  v_cvt_pk_bf16_f32 v175, v90, v91
  v_mfma_f32_16x16x32_bf16 v[180:183], v[40:43], v[68:71], 0
  ds_read_b64_tr_b16 a[94:95], v51 offset:40960
  v_cvt_pk_bf16_f32 v184, v96, v97
  v_mfma_f32_16x16x32_bf16 v[148:151], v[24:27], a[60:63], v[148:151]
  ds_read_b64_tr_b16 a[112:113], v51 offset:0
  buffer_store_dwordx4 v[172:175], v62, s[36:39], s65 offen offset:2048 sc1
  v_mfma_f32_16x16x32_bf16 v[84:87], v[44:47], v[68:71], 0
  s_waitcnt lgkmcnt(14)
  ds_read_b64_tr_b16 a[114:115], v2 offset:16384
  v_cvt_pk_bf16_f32 v185, v98, v99
  v_mfma_f32_16x16x32_bf16 v[188:191], v[56:59], v[28:31], 0
  s_waitcnt vmcnt(5)
  ds_read_b64_tr_b16 a[116:117], v52 offset:26624
  v_cvt_pk_bf16_f32 v186, v92, v93
  v_mfma_f32_16x16x32_bf16 v[40:43], v[24:27], a[104:107], 0
  s_waitcnt lgkmcnt(5)
  ds_read_b64_tr_b16 a[118:119], v51 offset:43008
  v_cvt_pk_bf16_f32 v187, v94, v95
  v_mfma_f32_16x16x32_bf16 v[100:103], a[24:27], a[44:47], v[100:103]
  ds_read_b64_tr_b16 a[60:61], v51 offset:2048
  v_mfma_f32_16x16x32_bf16 v[32:35], a[20:23], a[44:47], v[32:35]
  ds_read_b64_tr_b16 a[62:63], v2 offset:18432
  buffer_store_dwordx4 v[184:187], v62, s[36:39], s65 offen offset:3072 sc1
  v_mfma_f32_16x16x32_bf16 v[100:103], a[40:43], a[72:75], v[100:103]
  ds_read_b64_tr_b16 a[124:125], v52 offset:8192
  v_mfma_f32_16x16x32_bf16 v[32:35], a[52:55], a[72:75], v[32:35]
  ds_read_b64_tr_b16 a[126:127], v51 offset:24576
  v_mfma_f32_16x16x32_bf16 v[100:103], a[4:7], a[36:39], v[100:103]
  ds_read_b64_tr_b16 a[104:105], v52 offset:49152
  v_mfma_f32_16x16x32_bf16 v[32:35], a[56:59], a[36:39], v[32:35]
  ds_read_b64_tr_b16 a[106:107], v2 offset:0
  v_mfma_f32_16x16x32_bf16 v[100:103], a[64:67], a[100:103], v[100:103]
  ds_read_b64_tr_b16 a[44:45], v52 offset:10240
  v_mfma_f32_16x16x32_bf16 v[32:35], a[68:71], a[100:103], v[32:35]
  s_waitcnt lgkmcnt(5)
  ds_read_b64_tr_b16 a[46:47], v51 offset:26624
  v_mfma_f32_16x16x32_bf16 v[100:103], a[12:15], a[92:95], v[100:103]
  ds_read_b64_tr_b16 a[72:73], v52 offset:51200
  v_mfma_f32_16x16x32_bf16 v[32:35], a[16:19], a[92:95], v[32:35]
  ds_read_b64_tr_b16 a[74:75], v2 offset:2048
  v_mfma_f32_16x16x32_bf16 v[100:103], a[48:51], a[112:115], v[100:103]
  ds_read_b64_tr_b16 a[36:37], v3 offset:16384
  v_mfma_f32_16x16x32_bf16 v[32:35], a[28:31], a[112:115], v[32:35]
  ds_read_b64_tr_b16 a[38:39], v4 offset:32768
  v_mfma_f32_16x16x32_bf16 v[100:103], a[0:3], a[116:119], v[100:103]
  ds_read_b64_tr_b16 a[100:101], v3 offset:57344
  v_mfma_f32_16x16x32_bf16 v[32:35], a[32:35], a[116:119], v[32:35]
  ds_read_b64_tr_b16 a[102:103], v6 offset:8192
  v_mfma_f32_16x16x32_bf16 v[100:103], a[76:79], a[60:63], v[100:103]
  ds_read_b64_tr_b16 a[132:133], v3 offset:18432
  v_mfma_f32_16x16x32_bf16 v[32:35], a[8:11], a[60:63], v[32:35]
  s_waitcnt lgkmcnt(5)
  ds_read_b64_tr_b16 a[134:135], v4 offset:34816
  v_mfma_f32_16x16x32_bf16 v[100:103], a[84:87], a[124:127], v[100:103]
  ds_read_b64_tr_b16 a[92:93], v3 offset:59392
  v_mfma_f32_16x16x32_bf16 v[32:35], a[88:91], a[124:127], v[32:35]
  ds_read_b64_tr_b16 a[94:95], v6 offset:10240
  v_mfma_f32_16x16x32_bf16 v[100:103], a[96:99], a[104:107], v[100:103]
  ds_read_b64_tr_b16 a[112:113], v3 offset:24576
  v_mfma_f32_16x16x32_bf16 v[32:35], a[108:111], a[104:107], v[32:35]
  ds_read_b64_tr_b16 a[114:115], v4 offset:40960
  v_mfma_f32_16x16x32_bf16 v[100:103], a[120:123], a[44:47], v[100:103]
  s_waitcnt vmcnt(3)
  ds_read_b64_tr_b16 a[60:61], v4 offset:0
  v_max3_u32 v5, v140, v141, v142
  v_mfma_f32_16x16x32_bf16 v[32:35], a[128:131], a[44:47], v[32:35]
  s_waitcnt vmcnt(2)
  ds_read_b64_tr_b16 a[62:63], v6 offset:16384
  v_max3_u32 v5, v5, v143, v160
  v_mfma_f32_16x16x32_bf16 v[100:103], a[144:147], a[72:75], v[100:103]
  ds_read_b64_tr_b16 a[116:117], v3 offset:26624
  v_max3_u32 v5, v5, v161, v162
  v_mfma_f32_16x16x32_bf16 v[32:35], a[80:83], a[72:75], v[32:35]
  s_waitcnt lgkmcnt(5)
  ds_read_b64_tr_b16 a[118:119], v4 offset:43008
  v_max_u32 v5, v5, v163
  v_mfma_f32_16x16x32_bf16 v[104:107], a[20:23], a[36:39], v[104:107]
  ds_read_b64_tr_b16 a[104:105], v4 offset:2048
  v_cmp_eq_u32 vcc, -1, v5
  v_mfma_f32_16x16x32_bf16 v[108:111], a[24:27], a[36:39], v[108:111]
  s_cbranch_vccnz L_rd0
L_bd0:
  ds_read_b64_tr_b16 a[106:107], v6 offset:18432
  v_mfma_f32_16x16x32_bf16 v[104:107], a[52:55], a[100:103], v[104:107]
  ds_read_b64_tr_b16 a[44:45], v3 offset:8192
  v_cvt_pk_bf16_f32 v24, v100, v101
  v_mfma_f32_16x16x32_bf16 v[108:111], a[40:43], a[100:103], v[108:111]
  ds_read_b64_tr_b16 a[46:47], v4 offset:24576
  v_cvt_pk_bf16_f32 v25, v102, v103
  v_mfma_f32_16x16x32_bf16 v[104:107], a[56:59], a[132:135], v[104:107]
  ds_read_b64_tr_b16 a[36:37], v3 offset:49152
  v_cvt_pk_bf16_f32 v26, v32, v33
  v_mfma_f32_16x16x32_bf16 v[108:111], a[4:7], a[132:135], v[108:111]
  ds_read_b64_tr_b16 a[38:39], v6 offset:0
  v_cvt_pk_bf16_f32 v27, v34, v35
  v_mfma_f32_16x16x32_bf16 v[104:107], a[68:71], a[92:95], v[104:107]
  ds_read_b64_tr_b16 a[72:73], v3 offset:10240
  v_mfma_f32_16x16x32_bf16 v[108:111], a[64:67], a[92:95], v[108:111]
  s_waitcnt lgkmcnt(5)
  ds_read_b64_tr_b16 a[74:75], v4 offset:26624
  buffer_store_dwordx4 v[24:27], v62, s[36:39], s61 offen offset:2048 sc1
  v_mfma_f32_16x16x32_bf16 v[104:107], a[16:19], a[112:115], v[104:107]
  ds_read_b64_tr_b16 a[100:101], v3 offset:51200
  v_mfma_f32_16x16x32_bf16 v[108:111], a[12:15], a[112:115], v[108:111]
  ds_read_b64_tr_b16 a[102:103], v6 offset:2048
  v_mfma_f32_16x16x32_bf16 v[104:107], a[28:31], a[60:63], v[104:107]
  ds_read_b128 v[28:31], v1 offset:40464
  v_mfma_f32_16x16x32_bf16 v[108:111], a[48:51], a[60:63], v[108:111]
  ds_read_b128 v[32:35], v155 offset:40448
  v_mfma_f32_16x16x32_bf16 v[104:107], a[32:35], a[116:119], v[104:107]
  ds_read_b128 v[44:47], v0 offset:40448
  v_bfe_u32 v155, v62, 2, 7
  v_mfma_f32_16x16x32_bf16 v[108:111], a[0:3], a[116:119], v[108:111]
  buffer_load_dwordx4 v[24:27], v62, s[36:39], s68 offen offset:2048 sc1
  v_mul_u32_u24 v7, 0x2400, v7
  v_mfma_f32_16x16x32_bf16 v[104:107], a[8:11], a[104:107], v[104:107]
  v_add_u32 v0, v155, v7
  v_lshl_add_u32 v0, v53, 30, v0
  v_mfma_f32_16x16x32_bf16 v[108:111], a[76:79], a[104:107], v[108:111]
  s_waitcnt lgkmcnt(3)
  buffer_load_dwordx4 v[56:59], v62, s[36:39], s68 offen offset:3072 sc1
  v_lshl_add_u32 v1, v7, 3, v155
  v_mfma_f32_16x16x32_bf16 v[104:107], a[88:91], a[44:47], v[104:107]
  v_add_u32 v7, 0x9000, v1
  s_lshl_b32 s0, s41, 1
  v_mfma_f32_16x16x32_bf16 v[108:111], a[84:87], a[44:47], v[108:111]
  s_lshl1_add_u32 s1, s41, 0x1200
  s_lshl_b32 s3, s44, 1
  s_lshl1_add_u32 s8, s44, 0x1200
  v_mfma_f32_16x16x32_bf16 v[104:107], a[108:111], a[36:39], v[104:107]
  s_lshl_b32 s10, s9, 1
  s_lshl1_add_u32 s9, s9, 0x1200
  s_mov_b32 s11, 0xbfb8aa3b
  v_mfma_f32_16x16x32_bf16 v[108:111], a[96:99], a[36:39], v[108:111]
  v_mul_f32 v76, v76, v72
  v_mul_f32 v68, s11, v72
  v_mfma_f32_16x16x32_bf16 v[104:107], a[128:131], a[72:75], v[104:107]
  v_mul_f32 v77, v77, v73
  v_mul_f32 v69, s11, v73
  v_mfma_f32_16x16x32_bf16 v[108:111], a[120:123], a[72:75], v[108:111]
  v_mul_f32 v78, v78, v74
  v_mul_f32 v70, s11, v74
  v_mfma_f32_16x16x32_bf16 v[104:107], a[80:83], a[100:103], v[104:107]
  s_waitcnt lgkmcnt(2)
  ds_read_b64_tr_b16 a[44:45], v52 offset:16896
  v_mul_f32 v79, v79, v75
  v_mul_f32 v71, s11, v75
  v_mul_f32 v68, v68, v72
  v_mul_f32 v69, v69, v73
  v_mul_f32 v70, v70, v74
  v_mul_f32 v71, v71, v75
  v_lshlrev_b32 v152, 16, v152
  v_mul_f32 v28, v28, v136
  v_mul_f32 v88, s11, v136
  v_mul_f32 v29, v29, v137
  v_mul_f32 v89, s11, v137
  v_mul_f32 v30, v30, v138
  v_mul_f32 v90, s11, v138
  v_mul_f32 v31, v31, v139
  v_mul_f32 v91, s11, v139
  v_mul_f32 v88, v88, v136
  v_mul_f32 v89, v89, v137
  v_mul_f32 v90, v90, v138
  v_mul_f32 v91, v91, v139
  v_lshlrev_b32 v153, 16, v153
  s_waitcnt lgkmcnt(1)
  v_mul_f32 v44, v44, v32
  v_mul_f32 v92, s11, v32
  v_mul_f32 v45, v45, v33
  v_mul_f32 v93, s11, v33
  v_mul_f32 v46, v46, v34
  v_mul_f32 v94, s11, v34
  v_mul_f32 v47, v47, v35
  v_mul_f32 v95, s11, v35
  v_mul_f32 v92, v92, v32
  v_mul_f32 v93, v93, v33
  v_mul_f32 v94, v94, v34
  v_mul_f32 v95, v95, v35
  v_lshlrev_b32 v154, 16, v154
  v_fma_f32 v155, v164, v72, v76
  v_fma_f32 v48, v165, v73, v77
  v_fma_f32 v49, v166, v74, v78
  v_fma_f32 v50, v167, v75, v79
  v_fmac_f32 v16, v155, v152
  v_fmac_f32 v17, v48, v152
  v_fmac_f32 v18, v49, v152
  v_fmac_f32 v19, v50, v152
  v_fma_f32 v155, v176, v136, v28
  v_fma_f32 v48, v177, v137, v29
  v_fma_f32 v49, v178, v138, v30
  v_fma_f32 v50, v179, v139, v31
  v_fmac_f32 v20, v155, v152
  v_fmac_f32 v21, v48, v152
  v_fmac_f32 v22, v49, v152
  v_fmac_f32 v23, v50, v152
  v_fma_f32 v152, v180, v72, v76
  v_fma_f32 v155, v181, v73, v77
  v_fma_f32 v48, v182, v74, v78
  v_fma_f32 v49, v183, v75, v79
  v_fmac_f32 v8, v152, v153
  v_fmac_f32 v9, v155, v153
  v_fmac_f32 v10, v48, v153
  v_fmac_f32 v11, v49, v153
  v_fma_f32 v152, v84, v136, v28
  v_fma_f32 v155, v85, v137, v29
  v_fma_f32 v48, v86, v138, v30
  v_fma_f32 v49, v87, v139, v31
  v_fmac_f32 v12, v152, v153
  v_fmac_f32 v13, v155, v153
  v_fmac_f32 v14, v48, v153
  v_fmac_f32 v15, v49, v153
  v_mfma_f32_16x16x32_bf16 v[108:111], a[144:147], a[100:103], v[108:111]
  ds_read_b64_tr_b16 a[46:47], v51 offset:33280
  v_fma_f32 v48, v188, v32, v44
  v_mfma_f32_16x16x32_bf16 v[16:19], v[130:133], v[124:127], v[16:19]
  ds_read_b64_tr_b16 a[36:37], v52 offset:57856
  v_fma_f32 v49, v189, v33, v45
  v_mfma_f32_16x16x32_bf16 v[20:23], v[128:131], v[124:127], v[20:23]
  ds_read_b64_tr_b16 a[38:39], v2 offset:8704
  v_fma_f32 v50, v190, v34, v46
  v_mfma_f32_16x16x32_bf16 v[8:11], v[130:133], v[120:123], v[8:11]
  ds_read_b64_tr_b16 a[60:61], v52 offset:18944
  v_cvt_pk_bf16_f32 v28, v108, v109
  v_mfma_f32_16x16x32_bf16 v[12:15], v[128:131], v[120:123], v[12:15]
  ds_read_b64_tr_b16 a[62:63], v51 offset:35328
  v_cvt_pk_bf16_f32 v29, v110, v111
  v_mfma_f32_16x16x32_bf16 v[16:19], v[130:133], v[64:67], v[16:19]
  ds_read_b64_tr_b16 a[72:73], v52 offset:59904
  v_cvt_pk_bf16_f32 v30, v104, v105
  v_mfma_f32_16x16x32_bf16 v[20:23], v[128:131], v[64:67], v[20:23]
  ds_read_b64_tr_b16 a[74:75], v2 offset:10752
  v_cvt_pk_bf16_f32 v31, v106, v107
  v_mfma_f32_16x16x32_bf16 v[8:11], v[130:133], v[144:147], v[8:11]
  ds_read_b64_tr_b16 a[92:93], v52 offset:25088
  v_fma_f32 v53, v191, v35, v47
  v_mfma_f32_16x16x32_bf16 v[12:15], v[128:131], v[144:147], v[12:15]
  ds_read_b64_tr_b16 a[94:95], v51 offset:41472
  buffer_store_dwordx4 v[28:31], v62, s[36:39], s61 offen offset:3072 sc1
  v_mfma_f32_16x16x32_bf16 v[16:19], v[130:133], v[156:159], v[16:19]
  ds_read_b64_tr_b16 a[100:101], v51 offset:512
  v_fmac_f32 v40, v48, v154
  v_mfma_f32_16x16x32_bf16 v[20:23], v[128:131], v[156:159], v[20:23]
  ds_read_b64_tr_b16 a[102:103], v2 offset:16896
  v_fmac_f32 v41, v49, v154
  v_mfma_f32_16x16x32_bf16 v[8:11], v[130:133], v[168:171], v[8:11]
  ds_read_b64_tr_b16 a[104:105], v52 offset:27136
  v_fmac_f32 v42, v50, v154
  v_mfma_f32_16x16x32_bf16 v[12:15], v[128:131], v[168:171], v[12:15]
  s_waitcnt lgkmcnt(5)
  ds_read_b64_tr_b16 a[106:107], v51 offset:43520
  v_fmac_f32 v43, v53, v154
  v_mfma_f32_16x16x32_bf16 v[112:115], a[24:27], a[44:47], v[112:115]
  ds_read_b64_tr_b16 a[112:113], v51 offset:2560
  v_mul_f32 v148, v92, v148
  v_mfma_f32_16x16x32_bf16 v[116:119], a[20:23], a[44:47], v[116:119]
  ds_read_b64_tr_b16 a[114:115], v2 offset:18944
  v_mul_f32 v149, v93, v149
  v_mfma_f32_16x16x32_bf16 v[112:115], a[40:43], a[36:39], v[112:115]
  ds_read_b64_tr_b16 a[116:117], v52 offset:8704
  v_mul_f32 v150, v94, v150
  v_mfma_f32_16x16x32_bf16 v[116:119], a[52:55], a[36:39], v[116:119]
  ds_read_b64_tr_b16 a[118:119], v51 offset:25088
  v_mul_f32 v151, v95, v151
  v_mfma_f32_16x16x32_bf16 v[112:115], a[4:7], a[60:63], v[112:115]
  ds_read_b64_tr_b16 a[124:125], v52 offset:49664
  v_mfma_f32_16x16x32_bf16 v[116:119], a[56:59], a[60:63], v[116:119]
  ds_read_b64_tr_b16 a[126:127], v2 offset:512
  v_exp_f32 v48, v148
  v_mfma_f32_16x16x32_bf16 v[112:115], a[64:67], a[72:75], v[112:115]
  ds_read_b64_tr_b16 a[44:45], v52 offset:10752
  v_mfma_f32_16x16x32_bf16 v[116:119], a[68:71], a[72:75], v[116:119]
  s_waitcnt lgkmcnt(5)
  ds_read_b64_tr_b16 a[46:47], v51 offset:27136
  v_exp_f32 v49, v149
  v_mfma_f32_16x16x32_bf16 v[112:115], a[12:15], a[92:95], v[112:115]
  ds_read_b64_tr_b16 a[36:37], v52 offset:51712
  v_mfma_f32_16x16x32_bf16 v[116:119], a[16:19], a[92:95], v[116:119]
  s_waitcnt vmcnt(2)
  ds_read_b64_tr_b16 a[38:39], v2 offset:2560
  v_max3_u32 v5, v24, v25, v26
  v_mfma_f32_16x16x32_bf16 v[112:115], a[48:51], a[100:103], v[112:115]
  s_waitcnt vmcnt(1)
  ds_read_b64_tr_b16 a[60:61], v3 offset:16896
  v_max3_u32 v5, v5, v27, v56
  v_mfma_f32_16x16x32_bf16 v[116:119], a[28:31], a[100:103], v[116:119]
  ds_read_b64_tr_b16 a[62:63], v4 offset:33280
  v_max3_u32 v5, v5, v57, v58
  v_mfma_f32_16x16x32_bf16 v[112:115], a[0:3], a[104:107], v[112:115]
  ds_read_b64_tr_b16 a[72:73], v3 offset:57856
  v_max_u32 v5, v5, v59
  v_mfma_f32_16x16x32_bf16 v[116:119], a[32:35], a[104:107], v[116:119]
  ds_read_b64_tr_b16 a[74:75], v6 offset:8704
  v_cmp_eq_u32 vcc, -1, v5
  v_mfma_f32_16x16x32_bf16 v[112:115], a[76:79], a[112:115], v[112:115]
  s_cbranch_vccnz L_rd1
L_bd1:
  ds_read_b64_tr_b16 a[92:93], v3 offset:18944
  v_exp_f32 v2, v150
  v_mfma_f32_16x16x32_bf16 v[116:119], a[8:11], a[112:115], v[116:119]
  s_waitcnt lgkmcnt(5)
  ds_read_b64_tr_b16 a[94:95], v4 offset:35328
  v_mfma_f32_16x16x32_bf16 v[112:115], a[84:87], a[116:119], v[112:115]
  ds_read_b64_tr_b16 a[100:101], v3 offset:59904
  v_exp_f32 v50, v151
  v_mfma_f32_16x16x32_bf16 v[116:119], a[88:91], a[116:119], v[116:119]
  ds_read_b64_tr_b16 a[102:103], v6 offset:10752
  v_mul_f32 v148, v148, v40
  v_mfma_f32_16x16x32_bf16 v[112:115], a[96:99], a[124:127], v[112:115]
  ds_read_b64_tr_b16 a[104:105], v3 offset:25088
  v_mul_f32 v149, v149, v41
  v_mfma_f32_16x16x32_bf16 v[116:119], a[108:111], a[124:127], v[116:119]
  ds_read_b64_tr_b16 a[106:107], v4 offset:41472
  v_mul_f32 v150, v150, v42
  v_mfma_f32_16x16x32_bf16 v[112:115], a[120:123], a[44:47], v[112:115]
  ds_read_b64_tr_b16 a[112:113], v4 offset:512
  v_mul_f32 v151, v151, v43
  v_mfma_f32_16x16x32_bf16 v[116:119], a[128:131], a[44:47], v[116:119]
  ds_read_b64_tr_b16 a[114:115], v6 offset:16896
  v_fma_f32 v48, v48, s11, s11
  v_mfma_f32_16x16x32_bf16 v[112:115], a[144:147], a[36:39], v[112:115]
  ds_read_b64_tr_b16 a[116:117], v3 offset:27136
  v_fma_f32 v49, v49, s11, s11
  v_mfma_f32_16x16x32_bf16 v[116:119], a[80:83], a[36:39], v[116:119]
  s_waitcnt lgkmcnt(5)
  ds_read_b64_tr_b16 a[118:119], v4 offset:43520
  v_fma_f32 v2, v2, s11, s11
  v_mfma_f32_16x16x32_bf16 v[36:39], a[20:23], a[60:63], v[36:39]
  ds_read_b64_tr_b16 a[124:125], v4 offset:2560
  v_fma_f32 v50, v50, s11, s11
  v_mfma_f32_16x16x32_bf16 v[80:83], a[24:27], a[60:63], v[80:83]
  ds_read_b64_tr_b16 a[126:127], v6 offset:18944
  v_mfma_f32_16x16x32_bf16 v[36:39], a[52:55], a[72:75], v[36:39]
  ds_read_b64_tr_b16 a[44:45], v3 offset:8704
  v_rcp_f32 v48, v48
  v_mfma_f32_16x16x32_bf16 v[80:83], a[40:43], a[72:75], v[80:83]
  ds_read_b64_tr_b16 a[46:47], v4 offset:25088
  v_mfma_f32_16x16x32_bf16 v[36:39], a[56:59], a[92:95], v[36:39]
  ds_read_b64_tr_b16 a[36:37], v3 offset:49664
  v_rcp_f32 v49, v49
  v_mfma_f32_16x16x32_bf16 v[80:83], a[4:7], a[92:95], v[80:83]
  ds_read_b64_tr_b16 a[38:39], v6 offset:512
  v_mfma_f32_16x16x32_bf16 v[36:39], a[68:71], a[100:103], v[36:39]
  ds_read_b64_tr_b16 a[20:21], v3 offset:10752
  v_rcp_f32 v2, v2
  v_mfma_f32_16x16x32_bf16 v[80:83], a[64:67], a[100:103], v[80:83]
  s_waitcnt lgkmcnt(5)
  ds_read_b64_tr_b16 a[22:23], v4 offset:27136
  buffer_load_dwordx4 v[28:31], v62, s[36:39], s56 offen offset:2048 sc1
  v_mfma_f32_16x16x32_bf16 v[36:39], a[16:19], a[104:107], v[36:39]
  ds_read_b64_tr_b16 a[24:25], v3 offset:51712
  v_rcp_f32 v50, v50
  v_mfma_f32_16x16x32_bf16 v[80:83], a[12:15], a[104:107], v[80:83]
  ds_read_b64_tr_b16 a[26:27], v6 offset:2560
  buffer_load_dwordx4 v[32:35], v62, s[36:39], s56 offen offset:3072 sc1
  v_mfma_f32_16x16x32_bf16 v[36:39], a[28:31], a[112:115], v[36:39]
  v_fmac_f32 v188, v148, v48
  v_fmac_f32 v189, v149, v49
  v_mfma_f32_16x16x32_bf16 v[80:83], a[48:51], a[112:115], v[80:83]
  v_fmac_f32 v190, v150, v2
  v_fmac_f32 v191, v151, v50
  v_mfma_f32_16x16x32_bf16 v[36:39], a[32:35], a[116:119], v[36:39]
  buffer_store_dword v188, v0, s[16:19], s10 offen offset:0 sc1
  v_mfma_f32_16x16x32_bf16 v[80:83], a[0:3], a[116:119], v[80:83]
  v_mfma_f32_16x16x32_bf16 v[36:39], a[8:11], a[124:127], v[36:39]
  buffer_store_dword v189, v0, s[16:19], s10 offen offset:2304 sc1
  v_mfma_f32_16x16x32_bf16 v[80:83], a[76:79], a[124:127], v[80:83]
  s_waitcnt lgkmcnt(0)
  v_mfma_f32_16x16x32_bf16 v[36:39], a[88:91], a[44:47], v[36:39]
  buffer_store_dword v190, v0, s[16:19], s9 offen offset:0 sc1
  v_mfma_f32_16x16x32_bf16 v[80:83], a[84:87], a[44:47], v[80:83]
  v_mfma_f32_16x16x32_bf16 v[36:39], a[108:111], a[36:39], v[36:39]
  buffer_store_dword v191, v0, s[16:19], s9 offen offset:2304 sc1
  v_mfma_f32_16x16x32_bf16 v[80:83], a[96:99], a[36:39], v[80:83]
  v_mfma_f32_16x16x32_bf16 v[36:39], a[128:131], a[20:23], v[36:39]
  v_mfma_f32_16x16x32_bf16 v[80:83], a[120:123], a[20:23], v[80:83]
  v_mfma_f32_16x16x32_bf16 v[36:39], a[80:83], a[24:27], v[36:39]
  v_mfma_f32_16x16x32_bf16 v[80:83], a[144:147], a[24:27], v[80:83]
  v_mfma_f32_16x16x32_bf16 v[112:115], v[130:133], v[140:143], v[112:115]
  v_mfma_f32_16x16x32_bf16 v[116:119], v[128:131], v[140:143], v[116:119]
  v_mfma_f32_16x16x32_bf16 v[80:83], v[130:133], v[160:163], v[80:83]
  v_mfma_f32_16x16x32_bf16 v[36:39], v[128:131], v[160:163], v[36:39]
  v_mfma_f32_16x16x32_bf16 v[112:115], v[130:133], v[24:27], v[112:115]
  v_mfma_f32_16x16x32_bf16 v[116:119], v[128:131], v[24:27], v[116:119]
  v_mfma_f32_16x16x32_bf16 v[80:83], v[130:133], v[56:59], v[80:83]
  v_mfma_f32_16x16x32_bf16 v[36:39], v[128:131], v[56:59], v[36:39]
  s_waitcnt vmcnt(4)
  v_max3_u32 v5, v28, v29, v30
  v_max3_u32 v5, v5, v31, v32
  v_max3_u32 v5, v5, v33, v34
  v_max_u32 v5, v5, v35
  v_cmp_eq_u32 vcc, -1, v5
  s_nop 0
  s_cbranch_vccnz L_rd2
L_bd2:
  v_mfma_f32_16x16x32_bf16 v[112:115], v[130:133], v[28:31], v[112:115]
  v_mfma_f32_16x16x32_bf16 v[80:83], v[130:133], v[32:35], v[80:83]
  v_mfma_f32_16x16x32_bf16 v[116:119], v[128:131], v[28:31], v[116:119]
  v_mfma_f32_16x16x32_bf16 v[36:39], v[128:131], v[32:35], v[36:39]
  s_nop 4
  v_mul_f32 v112, v68, v112
  v_mul_f32 v113, v69, v113
  v_mul_f32 v114, v70, v114
  v_mul_f32 v115, v71, v115
  v_mul_f32 v80, v68, v80
  v_mul_f32 v81, v69, v81
  v_mul_f32 v82, v70, v82
  v_mul_f32 v83, v71, v83
  v_exp_f32 v0, v112
  v_exp_f32 v2, v113
  v_exp_f32 v3, v114
  v_exp_f32 v4, v115
  v_exp_f32 v5, v80
  v_exp_f32 v6, v81
  v_exp_f32 v24, v82
  v_exp_f32 v25, v83
  v_mul_f32 v112, v112, v16
  v_mul_f32 v113, v113, v17
  v_mul_f32 v114, v114, v18
  v_mul_f32 v115, v115, v19
  v_mul_f32 v80, v80, v8
  v_mul_f32 v81, v81, v9
  v_mul_f32 v82, v82, v10
  v_mul_f32 v83, v83, v11
  v_fma_f32 v0, v0, s11, s11
  v_fma_f32 v2, v2, s11, s11
  v_fma_f32 v3, v3, s11, s11
  v_fma_f32 v4, v4, s11, s11
  v_fma_f32 v5, v5, s11, s11
  v_fma_f32 v6, v6, s11, s11
  v_fma_f32 v24, v24, s11, s11
  v_fma_f32 v25, v25, s11, s11
  v_rcp_f32 v0, v0
  v_rcp_f32 v2, v2
  v_rcp_f32 v3, v3
  v_rcp_f32 v4, v4
  v_rcp_f32 v5, v5
  v_rcp_f32 v6, v6
  v_rcp_f32 v24, v24
  v_rcp_f32 v25, v25
  v_fmac_f32 v164, v112, v0
  v_fmac_f32 v165, v113, v2
  v_fmac_f32 v166, v114, v3
  v_fmac_f32 v167, v115, v4
  v_fmac_f32 v180, v80, v5
  v_fmac_f32 v181, v81, v6
  v_fmac_f32 v182, v82, v24
  v_fmac_f32 v183, v83, v25
  v_permlane16_swap_b32 v164, v180
  v_permlane16_swap_b32 v165, v181
  v_permlane16_swap_b32 v166, v182
  v_permlane16_swap_b32 v167, v183
  buffer_store_dword v164, v1, s[16:19], s0 offen offset:0 sc1
  buffer_store_dword v180, v7, s[16:19], s0 offen offset:0 sc1
  buffer_store_dword v165, v1, s[16:19], s0 offen offset:2304 sc1
  buffer_store_dword v181, v7, s[16:19], s0 offen offset:2304 sc1
  buffer_store_dword v166, v1, s[16:19], s1 offen offset:0 sc1
  buffer_store_dword v182, v7, s[16:19], s1 offen offset:0 sc1
  buffer_store_dword v167, v1, s[16:19], s1 offen offset:2304 sc1
  buffer_store_dword v183, v7, s[16:19], s1 offen offset:2304 sc1
  v_mul_f32 v116, v88, v116
  v_mul_f32 v117, v89, v117
  v_mul_f32 v118, v90, v118
  v_mul_f32 v119, v91, v119
  v_mul_f32 v36, v88, v36
  v_mul_f32 v37, v89, v37
  v_mul_f32 v38, v90, v38
  v_mul_f32 v39, v91, v39
  v_exp_f32 v0, v116
  v_exp_f32 v2, v117
  v_exp_f32 v3, v118
  v_exp_f32 v4, v119
  v_exp_f32 v5, v36
  v_exp_f32 v6, v37
  v_exp_f32 v8, v38
  v_exp_f32 v9, v39
  v_mul_f32 v116, v116, v20
  v_mul_f32 v117, v117, v21
  v_mul_f32 v118, v118, v22
  v_mul_f32 v119, v119, v23
  v_mul_f32 v36, v36, v12
  v_mul_f32 v37, v37, v13
  v_mul_f32 v38, v38, v14
  v_mul_f32 v39, v39, v15
  v_fma_f32 v0, v0, s11, s11
  v_fma_f32 v2, v2, s11, s11
  v_fma_f32 v3, v3, s11, s11
  v_fma_f32 v4, v4, s11, s11
  v_fma_f32 v5, v5, s11, s11
  v_fma_f32 v6, v6, s11, s11
  v_fma_f32 v8, v8, s11, s11
  v_fma_f32 v9, v9, s11, s11
  v_rcp_f32 v0, v0
  v_rcp_f32 v2, v2
  v_rcp_f32 v3, v3
  v_rcp_f32 v4, v4
  v_rcp_f32 v5, v5
  v_rcp_f32 v6, v6
  v_rcp_f32 v8, v8
  v_rcp_f32 v9, v9
  v_fmac_f32 v176, v116, v0
  v_fmac_f32 v177, v117, v2
  v_fmac_f32 v178, v118, v3
  v_fmac_f32 v179, v119, v4
  v_fmac_f32 v84, v36, v5
  v_fmac_f32 v85, v37, v6
  v_fmac_f32 v86, v38, v8
  v_fmac_f32 v87, v39, v9
  v_permlane16_swap_b32 v176, v84
  v_permlane16_swap_b32 v177, v85
  v_permlane16_swap_b32 v178, v86
  v_permlane16_swap_b32 v179, v87
  buffer_store_dword v176, v1, s[16:19], s3 offen offset:0 sc1
  buffer_store_dword v84, v7, s[16:19], s3 offen offset:0 sc1
  buffer_store_dword v177, v1, s[16:19], s3 offen offset:2304 sc1
  buffer_store_dword v85, v7, s[16:19], s3 offen offset:2304 sc1
  buffer_store_dword v178, v1, s[16:19], s8 offen offset:0 sc1
  buffer_store_dword v86, v7, s[16:19], s8 offen offset:0 sc1
  buffer_store_dword v179, v1, s[16:19], s8 offen offset:2304 sc1
  buffer_store_dword v87, v7, s[16:19], s8 offen offset:2304 sc1
L_end:
  s_endpgm
L_rc:
  buffer_load_dword v2, v71, s[32:35], 0 offen sc1
  s_waitcnt vmcnt(0)
  v_cmp_gt_u32 vcc, 0x80, v2
  s_sub_u32 s72, s72, 1
  s_cbranch_scc1 L_xc
  s_cbranch_vccnz L_rc
  s_branch L_bc
L_xc:
  s_mov_b32 s72, 0
  s_branch L_bc
L_ra:
  buffer_load_dwordx2 v[58:59], v3, s[4:7], s55 offen offset:128 sc1
  buffer_load_dword v2, v49, s[8:11], s60 offen offset:128 sc1
  buffer_load_dwordx2 v[60:61], v3, s[4:7], s55 offen offset:256 sc1
  buffer_load_dword v71, v49, s[8:11], s60 offen offset:256 sc1
  buffer_load_dwordx2 v[180:181], v3, s[4:7], s55 offen offset:384 sc1
  buffer_load_dword v4, v49, s[8:11], s60 offen offset:384 sc1
  buffer_load_dwordx2 v[54:55], v3, s[4:7], s55 offen offset:512 sc1
  buffer_load_dword v6, v49, s[8:11], s60 offen offset:512 sc1
  buffer_load_dwordx2 v[80:81], v3, s[4:7], s55 offen offset:640 sc1
  buffer_load_dword v53, v49, s[8:11], s60 offen offset:640 sc1
  buffer_load_dwordx2 v[96:97], v3, s[4:7], s55 offen offset:768 sc1
  buffer_load_dword v82, v49, s[8:11], s60 offen offset:768 sc1
  buffer_load_dwordx2 v[98:99], v3, s[4:7], s55 offen offset:896 sc1
  buffer_load_dword v65, v49, s[8:11], s60 offen offset:896 sc1
  buffer_load_dwordx2 v[128:129], v3, s[4:7], s55 offen offset:1024 sc1
  buffer_load_dword v66, v49, s[8:11], s60 offen offset:1024 sc1
  s_waitcnt vmcnt(0)
  v_max3_u32 v134, v58, v59, v2
  v_max3_u32 v134, v134, v60, v61
  v_max3_u32 v134, v134, v71, v180
  v_max3_u32 v134, v134, v181, v4
  v_max3_u32 v134, v134, v54, v55
  v_max3_u32 v134, v134, v6, v80
  v_max3_u32 v134, v134, v81, v53
  v_max3_u32 v134, v134, v96, v97
  v_max3_u32 v134, v134, v82, v98
  v_max3_u32 v134, v134, v99, v65
  v_max3_u32 v134, v134, v128, v129
  v_max_u32 v134, v134, v66
  v_cmp_eq_u32 vcc, -1, v134
  s_sub_u32 s72, s72, 1
  s_cbranch_scc1 L_xa
  s_cbranch_vccnz L_ra
  s_branch L_ba
L_xa:
  s_mov_b32 s72, 0
  s_branch L_ba
L_rf1:
  buffer_load_dword v63, v7, s[36:39], s58 offen offset:0 sc1
  s_waitcnt vmcnt(0)
  v_cmp_gt_i32 vcc, 1, v63
  s_nop 3
  s_and_b64 vcc, vcc, s[42:43]
  s_sub_u32 s72, s72, 1
  s_cbranch_scc1 L_xf1
  s_cbranch_vccnz L_rf1
  s_branch L_bf1
L_xf1:
  s_mov_b32 s72, 0
  s_branch L_bf1
L_rf2:
  buffer_load_dword v63, v7, s[36:39], s58 offen offset:0 sc1
  s_waitcnt vmcnt(0)
  v_cmp_gt_i32 vcc, 2, v63
  s_nop 3
  s_and_b64 vcc, vcc, s[42:43]
  s_sub_u32 s72, s72, 1
  s_cbranch_scc1 L_xf2
  s_cbranch_vccnz L_rf2
  s_branch L_bf2
L_xf2:
  s_mov_b32 s72, 0
  s_branch L_bf2
L_rf3:
  buffer_load_dword v63, v7, s[36:39], s58 offen offset:0 sc1
  s_waitcnt vmcnt(0)
  v_cmp_gt_i32 vcc, 3, v63
  s_sub_u32 s72, s72, 1
  s_cbranch_scc1 L_xf3
  s_cbranch_vccnz L_rf3
  s_branch L_bf3
L_xf3:
  s_mov_b32 s72, 0
  s_branch L_bf3
L_rd0:
  buffer_load_dwordx4 v[140:143], v62, s[36:39], s67 offen offset:2048 sc1
  buffer_load_dwordx4 v[160:163], v62, s[36:39], s67 offen offset:3072 sc1
  s_waitcnt vmcnt(0)
  v_max3_u32 v5, v140, v141, v142
  v_max3_u32 v5, v5, v143, v160
  v_max3_u32 v5, v5, v161, v162
  v_max_u32 v5, v5, v163
  v_cmp_eq_u32 vcc, -1, v5
  s_sub_u32 s72, s72, 1
  s_cbranch_scc1 L_xd0
  s_cbranch_vccnz L_rd0
  s_branch L_bd0
L_xd0:
  s_mov_b32 s72, 0
  s_branch L_bd0
L_rd1:
  buffer_load_dwordx4 v[24:27], v62, s[36:39], s68 offen offset:2048 sc1
  buffer_load_dwordx4 v[56:59], v62, s[36:39], s68 offen offset:3072 sc1
  s_waitcnt vmcnt(0)
  v_max3_u32 v5, v24, v25, v26
  v_max3_u32 v5, v5, v27, v56
  v_max3_u32 v5, v5, v57, v58
  v_max_u32 v5, v5, v59
  v_cmp_eq_u32 vcc, -1, v5
  s_sub_u32 s72, s72, 1
  s_cbranch_scc1 L_xd1
  s_cbranch_vccnz L_rd1
  s_branch L_bd1
L_xd1:
  s_mov_b32 s72, 0
  s_branch L_bd1
L_rd2:
  buffer_load_dwordx4 v[28:31], v62, s[36:39], s56 offen offset:2048 sc1
  buffer_load_dwordx4 v[32:35], v62, s[36:39], s56 offen offset:3072 sc1
  s_waitcnt vmcnt(0)
  v_max3_u32 v5, v28, v29, v30
  v_max3_u32 v5, v5, v31, v32
  v_max3_u32 v5, v5, v33, v34
  v_max_u32 v5, v5, v35
  v_cmp_eq_u32 vcc, -1, v5
  s_nop 0
  s_sub_u32 s72, s72, 1
  s_cbranch_scc1 L_xd2
  s_cbranch_vccnz L_rd2
  s_branch L_bd2
L_xd2:
  s_mov_b32 s72, 0
  s_branch L_bd2
  s_endpgm
L_fin:
.section .rodata,"a"
.p2align 6
.amdhsa_kernel recurrent_scan__ssm_conv_s5__glu_gated_bilinear__prompt_kernel
  .amdhsa_next_free_vgpr 508
  .amdhsa_next_free_sgpr 102
  .amdhsa_accum_offset 252
  .amdhsa_group_segment_fixed_size 0
  .amdhsa_kernarg_size 128
  .amdhsa_user_sgpr_count 2
  .amdhsa_user_sgpr_kernarg_segment_ptr 1
  .amdhsa_system_sgpr_workgroup_id_x 1
.end_amdhsa_kernel
```
